```python
import torch

def _softmax(x, axis=-1):
    return torch.softmax(x, dim=axis)
def _gelu(x):
    return torch.nn.functional.gelu(x, approximate="tanh")
def _silu(x):
    return torch.nn.functional.silu(x)
def _sigmoid(x):
    return torch.sigmoid(x)
def _layernorm(x, axis=-1, eps=1e-5):
    m = x.mean(dim=axis, keepdim=True)
    v = x.var(dim=axis, keepdim=True, unbiased=False)
    return (x - m) / torch.sqrt(v + eps)
def _scatter_add(tgt, idx, src, axis=0):
    return tgt.clone().index_add_(axis, idx, src)
def _segment_sum(src, seg, n):
    out = torch.zeros((n,) + src.shape[1:], dtype=src.dtype)
    return out.index_add_(0, seg, src)
def _pad(x, pw):
    flat = tuple(v for pair in reversed(pw) for v in pair)
    return torch.nn.functional.pad(x, flat)

kernel_name = 'concat_heads__spectral_fnet__mha_block__prompt'

def setup_inputs():

    _w = (lambda a: (lambda t: t.to(torch.bfloat16) if t.is_floating_point() else t)(torch.as_tensor(a)))
    def _A_setup():
        B, S, D = 1, 2048, 1024
        ns = torch.arange(S)[:, None] * torch.arange(S)[None, :]
        nd = torch.arange(D)[:, None] * torch.arange(D)[None, :]
        Ws_re = torch.cos(-2.0 * torch.pi * ns / S).to(float)
        Ws_im = torch.sin(-2.0 * torch.pi * ns / S).to(float)
        Wd_re = torch.cos(-2.0 * torch.pi * nd / D).to(float)
        Wd_im = torch.sin(-2.0 * torch.pi * nd / D).to(float)
        return {
            "x": _w((lambda *s: torch.randn(*s, dtype=torch.bfloat16) * 0.05)(B, S, D)),
            "dft_seq_re": _w(Ws_re),
            "dft_seq_im": _w(Ws_im),
            "dft_hid_re": _w(Wd_re),
            "dft_hid_im": _w(Wd_im),
        }
    _A_in = _A_setup()

    def _B_setup():
        B, S, D, H = 1, 2048, 1024, 32
        return {
            "x": _w((lambda *s: torch.randn(*s, dtype=torch.bfloat16) * 0.2)(B, S, D)),
            "wqkv": _w((lambda *s: torch.randn(*s, dtype=torch.bfloat16) * 0.8)(D, 3 * D)),
            "wo": _w((lambda *s: torch.randn(*s, dtype=torch.bfloat16) * 0.2)(D, D)),
        }
    _B_in = _B_setup()

    return {
        "A_x": _A_in["x"],
        "A_dft_seq_re": _A_in["dft_seq_re"],
        "A_dft_seq_im": _A_in["dft_seq_im"],
        "A_dft_hid_re": _A_in["dft_hid_re"],
        "A_dft_hid_im": _A_in["dft_hid_im"],
        "B_x": _B_in["x"],
        "B_wqkv": _B_in["wqkv"],
        "B_wo": _B_in["wo"],
    }

def reference(A_x, A_dft_seq_re, A_dft_seq_im, A_dft_hid_re, A_dft_hid_im, B_x, B_wqkv, B_wo):
    def _A_ref(x, dft_seq_re, dft_seq_im, dft_hid_re, dft_hid_im):
        a = torch.einsum("bsd,ed->bse", x, dft_hid_re)
        b = torch.einsum("bsd,ed->bse", x, dft_hid_im)
        y = torch.einsum("ts,bse->bte", dft_seq_re, a) - torch.einsum("ts,bse->bte", dft_seq_im, b)
        return y

    def _B_ref(x, wqkv, wo):
        B, S, D = x.shape
        H = 32
        Dh = D // H
        qkv = (lambda x, *d: x.permute(*d))((x @ wqkv).reshape(B, S, 3, H, Dh), 2, 0, 3, 1, 4)
        q, k, v = qkv[0], qkv[1], qkv[2]
        scores = torch.einsum("bhqd,bhkd->bhqk", q, k) * (Dh ** -0.5)
        p = _softmax(scores, axis=-1)
        o = torch.einsum("bhqk,bhkd->bhqd", p, v)
        return (lambda x, *d: x.permute(*d))(o, 0, 2, 1, 3).reshape(B, S, D) @ wo

    a = _A_ref(A_x, A_dft_seq_re, A_dft_seq_im, A_dft_hid_re, A_dft_hid_im)
    b = _B_ref(B_x, B_wqkv, B_wo)
    return torch.concatenate([a, b], axis=-1)
```

```asm
; @launch kernel=f_kernel grid=(256,1,1) block=(768,1,1) lds=163840
.amdgcn_target "amdgcn-amd-amdhsa--gfx950"
.text
.p2align 8
.globl f_kernel
.type f_kernel,@function
f_kernel:
    s_cmp_ge_u32 s2, 256
    s_cbranch_scc1 f_kernel_end
    s_load_dwordx16 s[8:23], s[0:1], 0
    s_load_dwordx2 s[24:25], s[0:1], 64
    s_load_dwordx2 s[26:27], s[0:1], 80
    v_lshrrev_b32 v1, 6, v0
    v_and_b32 v0, 63, v0
    v_readfirstlane_b32 s3, v1
    s_and_b32 s4, s2, 7
    s_lshr_b32 s5, s2, 3
    s_xor_b32 s4, s4, 1
    s_lshr_b32 s28, s4, 1
    s_lshr_b32 s33, s5, 3
    s_lshl2_add_u32 s6, s28, s33
    s_and_b32 s30, s4, 1
    s_and_b32 s29, s5, 7
    s_lshl3_add_u32 s7, s30, s29
    s_and_b32 s31, s5, 3
    s_lshl2_add_u32 s28, s28, s31
    s_lshr_b32 s29, s5, 2
    s_add_u32 s31, s5, s29
    s_add_u32 s33, s33, s5
    s_cmp_lt_u32 s3, 8
    s_cbranch_scc1 f_kernel_comp
    s_sub_u32 s48, s3, 8
    s_lshr_b32 s51, s48, 1
    s_and_b32 s50, s48, 1
    s_lshl2_add_u32 s49, s7, s48
    s_lshl_b32 s49, s49, 5
    v_lshrrev_b32 v3, 3, v0
    v_add_u32 v1, s49, v3
    v_lshlrev_b32 v1, 11, v1
    v_lshrrev_b32 v2, 4, v0
    v_xor_b32 v2, v2, v0
    v_and_b32 v2, 7, v2
    v_lshl_add_u32 v1, v2, 4, v1
    v_xor_b32 v2, 64, v1
    v_add_u32 v5, 0, v1
    v_add_u32 v6, 15360, v2
    v_add_u32 v7, 30720, v1
    v_add_u32 v8, 46080, v2
    s_mul_i32 s52, s51, 6
    s_add_u32 s52, s52, s50
    s_lshl_b32 s52, s52, 12
    s_add_u32 s53, s52, 49152
    s_lshl_b32 s54, s48, 11
    s_add_u32 s54, s54, 98304
    s_lshl4_add_u32 s62, s51, s6
    s_lshl_b32 s62, s62, 7
    s_lshl_b32 s49, s50, 5
    v_lshrrev_b32 v1, 3, v0
    v_add_u32 v1, s49, v1
    v_mul_u32_u24 v1, 6144, v1
    v_lshrrev_b32 v2, 2, v0
    v_and_b32 v2, 4, v2
    v_xor_b32 v2, v2, v0
    v_and_b32 v2, 7, v2
    v_lshl_add_u32 v1, v2, 4, v1
    v_xor_b32 v2, 32, v1
    v_add_u32 v9, 0, v1
    v_add_u32 v10, 48128, v2
    v_add_u32 v11, 96256, v1
    v_add_u32 v12, 144384, v2
    s_mov_b32 s64, s62
    s_lshl_b32 s55, s48, 4
    s_sub_u32 s55, s55, s49
    s_mul_i32 s55, s55, 6144
    s_lshl_b32 s49, s51, 11
    s_sub_u32 s55, s55, s49
    s_add_u32 s55, s55, 4096
    v_add_u32 v13, s55, v9
    v_add_u32 v14, s55, v10
    s_mov_b32 s57, 0
    s_mov_b32 s58, 0
    s_mov_b32 s59, 0
    s_mov_b32 s60, 0
    s_mov_b32 s38, 4194304
    s_mov_b32 s39, 0x00020000
    s_mov_b32 s42, 6291456
    s_mov_b32 s43, 0x00020000
    s_waitcnt lgkmcnt(0)
    s_mov_b64 s[36:37], s[18:19]
    s_mov_b64 s[40:41], s[20:21]
    s_mov_b32 s60, 8192
    s_add_u32 s55, s57, s33
    s_and_b32 s55, s55, 3
    s_andn2_b32 s49, s57, 3
    s_or_b32 s55, s55, s49
    s_lshl_b32 s56, s55, 7
    s_lshl1_add_u32 s59, s58, s60
    s_add_u32 m0, s52, s59
    s_nop 0
    buffer_load_dwordx4 v5, s[36:39], s56 offen offset:0 lds
    buffer_load_dwordx4 v6, s[36:39], s56 offen offset:1024 lds
    buffer_load_dwordx4 v7, s[36:39], s56 offen offset:2048 lds
    buffer_load_dwordx4 v8, s[36:39], s56 offen offset:3072 lds
    s_mul_i32 s56, s55, 393216
    s_add_u32 s56, s56, s62
    s_add_u32 s59, s58, s60
    s_add_u32 m0, s53, s59
    s_nop 0
    buffer_load_dwordx4 v9, s[40:43], s56 offen offset:0 lds
    buffer_load_dwordx4 v10, s[40:43], s56 offen offset:1024 lds
    buffer_load_dwordx4 v11, s[40:43], s56 offen offset:2048 lds
    buffer_load_dwordx4 v12, s[40:43], s56 offen offset:3072 lds
    s_add_u32 m0, s54, s60
    s_nop 0
    buffer_load_dwordx4 v13, s[40:43], s56 offen offset:0 lds
    buffer_load_dwordx4 v14, s[40:43], s56 offen offset:1024 lds
    s_add_u32 s57, s57, 1
    s_lshl_b32 s49, s57, 3
    s_lshr_b32 s60, 83886593, s49
    s_and_b32 s60, s60, 255
    s_lshl_b32 s60, s60, 13
    s_cmp_eq_u32 s60, 40960
    s_cselect_b32 s58, s60, 0
    s_mov_b64 s[44:45], s[26:27]
    s_mov_b32 s46, 29380608
    s_mov_b32 s47, 0x00020000
    s_lshl4_add_u32 s66, s30, s28
    s_lshl1_add_u32 s66, s66, s51
    s_lshl_b32 s66, s66, 6
    s_add_u32 s66, s66, 29364224
    s_lshl1_add_u32 s67, s6, s51
    s_lshl_b32 s65, s67, 7
    s_add_u32 s65, s65, 29360128
    v_and_b32 v1, 15, v0
    v_lshl_add_u32 v1, v1, 2, s66
    v_lshl_add_u32 v2, v0, 2, s65
    v_cmp_gt_u32 vcc, 32, v0
    s_nop 1
    v_cndmask_b32 v16, v1, v2, vcc
    v_lshlrev_b32 v15, 4, v0
    buffer_load_dword v18, v16, s[44:47], 0 offen sc1
    s_lshl_b32 s49, s28, 8
    s_add_u32 s49, s49, 29368320
    s_add_u32 s66, s66, 2048
    s_cmp_eq_u32 s30, 1
    s_cselect_b32 s49, s49, s66
    s_cselect_b32 s66, 63, 7
    s_cselect_b32 vcc_hi, -1, 0
    v_and_b32 v19, s66, v0
    v_lshl_add_u32 v19, v19, 2, s49
    s_lshl3_add_u32 s73, s28, s29
    s_lshl2_add_u32 s73, s73, s48
    s_lshl_b32 s49, s73, 2
    s_add_u32 s49, s49, 29372416
    v_mov_b32 v1, s49
    v_cndmask_b32 v19, v1, v19, vcc
    buffer_load_dword v20, v19, s[44:47], 0 offen sc1
    s_lshr_b32 s49, s7, 3
    s_lshl1_add_u32 s65, s67, s49
    s_lshl_b32 s65, s65, 6
    s_add_u32 s65, s65, s50
    s_lshl_b32 s65, s65, 11
    s_lshl_b32 s49, s49, 4
    s_lshl_b32 s68, 0xffff, s49
    s_add_u32 s66, s7, 1
    s_and_b32 s66, s66, 7
    s_lshl1_add_u32 s49, s66, s49
    s_lshl_b32 s67, 3, s49
    s_lshl_b32 s66, s66, 14
    s_add_u32 s61, s50, 3
    s_lshl_b32 s61, s61, 12
    s_lshl_b32 s70, s28, 2
    s_add_u32 s70, s70, s48
    s_lshl_b32 s49, s70, 5
    v_lshrrev_b32 v1, 3, v0
    v_add_u32 v1, s49, v1
    v_lshlrev_b32 v1, 12, v1
    v_lshrrev_b32 v2, 4, v0
    v_xor_b32 v2, v2, v0
    v_and_b32 v2, 7, v2
    v_lshl_add_u32 v2, v2, 4, v1
    v_xor_b32 v3, 0, v2
    v_add_u32 v21, 0, v3
    v_xor_b32 v3, 64, v2
    v_add_u32 v22, 31744, v3
    v_xor_b32 v3, 32, v2
    v_add_u32 v23, 63488, v3
    v_xor_b32 v3, 96, v2
    v_add_u32 v24, 95232, v3
    s_mov_b32 s63, 0
    s_lshl_b32 s70, s70, 17
    s_add_u32 s70, s70, 16777216
    s_lshl_b32 s69, s29, 1
    s_add_u32 s69, s69, s51
    s_lshl_b32 s69, s69, 7
    s_lshl_b32 s49, s50, 5
    v_lshrrev_b32 v1, 3, v0
    v_add_u32 v1, s49, v1
    v_mul_u32_u24 v1, 2048, v1
    v_lshrrev_b32 v2, 2, v0
    v_and_b32 v2, 4, v2
    v_xor_b32 v2, v2, v0
    v_and_b32 v2, 7, v2
    v_lshl_add_u32 v1, v2, 4, v1
    v_xor_b32 v2, 32, v1
    v_add_u32 v25, 0, v1
    v_add_u32 v26, 15360, v2
    v_add_u32 v27, 30720, v1
    v_add_u32 v28, 46080, v2
    s_mov_b32 s63, s69
    s_lshl_b32 s49, s29, 2
    s_add_u32 s49, s49, s48
    s_lshl_b32 s49, s49, 5
    v_lshrrev_b32 v1, 3, v0
    v_add_u32 v1, s49, v1
    v_lshlrev_b32 v1, 11, v1
    v_lshrrev_b32 v2, 4, v0
    v_xor_b32 v2, v2, v0
    v_and_b32 v2, 7, v2
    v_lshl_add_u32 v2, v2, 4, v1
    v_xor_b32 v3, 0, v2
    v_add_u32 v29, 0, v3
    v_xor_b32 v3, 64, v2
    v_add_u32 v30, 15360, v3
    v_xor_b32 v3, 32, v2
    v_add_u32 v31, 30720, v3
    v_xor_b32 v3, 96, v2
    v_add_u32 v32, 46080, v3
    s_mov_b32 s64, 0
    s_add_u32 s55, s57, s33
    s_and_b32 s55, s55, 3
    s_andn2_b32 s49, s57, 3
    s_or_b32 s55, s55, s49
    s_lshl_b32 s56, s55, 7
    s_lshl1_add_u32 s59, s58, s60
    s_add_u32 m0, s52, s59
    s_nop 0
    buffer_load_dwordx4 v5, s[36:39], s56 offen offset:0 lds
    buffer_load_dwordx4 v6, s[36:39], s56 offen offset:1024 lds
    buffer_load_dwordx4 v7, s[36:39], s56 offen offset:2048 lds
    buffer_load_dwordx4 v8, s[36:39], s56 offen offset:3072 lds
    s_mul_i32 s56, s55, 393216
    s_add_u32 s56, s56, s62
    s_add_u32 s59, s58, s60
    s_add_u32 m0, s53, s59
    s_nop 0
    buffer_load_dwordx4 v9, s[40:43], s56 offen offset:0 lds
    buffer_load_dwordx4 v10, s[40:43], s56 offen offset:1024 lds
    buffer_load_dwordx4 v11, s[40:43], s56 offen offset:2048 lds
    buffer_load_dwordx4 v12, s[40:43], s56 offen offset:3072 lds
    s_add_u32 m0, s54, s60
    s_nop 0
    buffer_load_dwordx4 v13, s[40:43], s56 offen offset:0 lds
    buffer_load_dwordx4 v14, s[40:43], s56 offen offset:1024 lds
    s_add_u32 s57, s57, 1
    s_lshl_b32 s49, s57, 3
    s_lshr_b32 s60, 83886593, s49
    s_and_b32 s60, s60, 255
    s_lshl_b32 s60, s60, 13
    s_cmp_eq_u32 s60, 40960
    s_cselect_b32 s58, s60, 0
    s_waitcnt vmcnt(12)
    s_barrier
    s_add_u32 s55, s57, s33
    s_and_b32 s55, s55, 3
    s_andn2_b32 s49, s57, 3
    s_or_b32 s55, s55, s49
    s_lshl_b32 s56, s55, 7
    s_lshl1_add_u32 s59, s58, s60
    s_add_u32 m0, s52, s59
    s_nop 0
    buffer_load_dwordx4 v5, s[36:39], s56 offen offset:0 lds
    buffer_load_dwordx4 v6, s[36:39], s56 offen offset:1024 lds
    buffer_load_dwordx4 v7, s[36:39], s56 offen offset:2048 lds
    buffer_load_dwordx4 v8, s[36:39], s56 offen offset:3072 lds
    s_mul_i32 s56, s55, 393216
    s_add_u32 s56, s56, s62
    s_add_u32 s59, s58, s60
    s_add_u32 m0, s53, s59
    s_nop 0
    buffer_load_dwordx4 v9, s[40:43], s56 offen offset:0 lds
    buffer_load_dwordx4 v10, s[40:43], s56 offen offset:1024 lds
    buffer_load_dwordx4 v11, s[40:43], s56 offen offset:2048 lds
    buffer_load_dwordx4 v12, s[40:43], s56 offen offset:3072 lds
    s_add_u32 m0, s54, s60
    s_nop 0
    buffer_load_dwordx4 v13, s[40:43], s56 offen offset:0 lds
    buffer_load_dwordx4 v14, s[40:43], s56 offen offset:1024 lds
    s_add_u32 s57, s57, 1
    s_lshl_b32 s49, s57, 3
    s_lshr_b32 s60, 83886593, s49
    s_and_b32 s60, s60, 255
    s_lshl_b32 s60, s60, 13
    s_cmp_eq_u32 s60, 40960
    s_cselect_b32 s58, s60, 0
    s_add_u32 s55, s57, s33
    s_and_b32 s55, s55, 3
    s_andn2_b32 s49, s57, 3
    s_or_b32 s55, s55, s49
    s_lshl_b32 s56, s55, 7
    s_lshl1_add_u32 s59, s58, s60
    s_add_u32 m0, s52, s59
    s_nop 0
    buffer_load_dwordx4 v5, s[36:39], s56 offen offset:0 lds
    buffer_load_dwordx4 v6, s[36:39], s56 offen offset:1024 lds
    buffer_load_dwordx4 v7, s[36:39], s56 offen offset:2048 lds
    buffer_load_dwordx4 v8, s[36:39], s56 offen offset:3072 lds
    s_mul_i32 s56, s55, 393216
    s_add_u32 s56, s56, s62
    s_add_u32 s59, s58, s60
    s_add_u32 m0, s53, s59
    s_nop 0
    buffer_load_dwordx4 v9, s[40:43], s56 offen offset:0 lds
    buffer_load_dwordx4 v10, s[40:43], s56 offen offset:1024 lds
    buffer_load_dwordx4 v11, s[40:43], s56 offen offset:2048 lds
    buffer_load_dwordx4 v12, s[40:43], s56 offen offset:3072 lds
    s_add_u32 m0, s54, s60
    s_nop 0
    buffer_load_dwordx4 v13, s[40:43], s56 offen offset:0 lds
    buffer_load_dwordx4 v14, s[40:43], s56 offen offset:1024 lds
    s_add_u32 s57, s57, 1
    s_lshl_b32 s49, s57, 3
    s_lshr_b32 s60, 83886593, s49
    s_and_b32 s60, s60, 255
    s_lshl_b32 s60, s60, 13
    s_cmp_eq_u32 s60, 40960
    s_cselect_b32 s58, s60, 0
    s_mov_b32 s71, 11
ld_loop1:
    s_waitcnt vmcnt(20)
    s_barrier
    s_add_u32 s55, s57, s33
    s_and_b32 s55, s55, 3
    s_andn2_b32 s49, s57, 3
    s_or_b32 s55, s55, s49
    s_lshl_b32 s56, s55, 7
    s_lshl1_add_u32 s59, s58, s60
    s_add_u32 m0, s52, s59
    s_nop 0
    buffer_load_dwordx4 v5, s[36:39], s56 offen offset:0 lds
    buffer_load_dwordx4 v6, s[36:39], s56 offen offset:1024 lds
    buffer_load_dwordx4 v7, s[36:39], s56 offen offset:2048 lds
    buffer_load_dwordx4 v8, s[36:39], s56 offen offset:3072 lds
    s_mul_i32 s56, s55, 393216
    s_add_u32 s56, s56, s62
    s_add_u32 s59, s58, s60
    s_add_u32 m0, s53, s59
    s_nop 0
    buffer_load_dwordx4 v9, s[40:43], s56 offen offset:0 lds
    buffer_load_dwordx4 v10, s[40:43], s56 offen offset:1024 lds
    buffer_load_dwordx4 v11, s[40:43], s56 offen offset:2048 lds
    buffer_load_dwordx4 v12, s[40:43], s56 offen offset:3072 lds
    s_add_u32 m0, s54, s60
    s_nop 0
    buffer_load_dwordx4 v13, s[40:43], s56 offen offset:0 lds
    buffer_load_dwordx4 v14, s[40:43], s56 offen offset:1024 lds
    s_add_u32 s57, s57, 1
    s_lshl_b32 s49, s57, 3
    s_lshr_b32 s60, 83886593, s49
    s_and_b32 s60, s60, 255
    s_lshl_b32 s60, s60, 13
    s_cmp_eq_u32 s60, 40960
    s_cselect_b32 s58, s60, 0
    s_sub_u32 s71, s71, 1
    s_cbranch_scc0 ld_loop1
    s_waitcnt vmcnt(20)
    s_barrier
    s_cmp_eq_u32 s30, 1
    s_cselect_b64 s[36:37], s[12:13], s[10:11]
    s_mov_b32 s38, 8388608
    s_mov_b32 s57, 0
    s_mov_b64 s[40:41], s[8:9]
    s_mov_b32 s42, 4194304
    s_mov_b32 s58, 0
    s_mov_b32 s59, 8192
    s_lshl4_add_u32 s54, s51, s50
    s_lshl_b32 s54, s54, 11
    s_add_u32 s54, s54, 98304
    s_add_u32 s55, s57, s31
    s_and_b32 s55, s55, 3
    s_andn2_b32 s49, s57, 3
    s_or_b32 s55, s55, s49
    s_lshl_b32 s56, s55, 7
    s_add_u32 m0, s52, s59
    s_nop 0
    buffer_load_dwordx4 v21, s[36:39], s56 offen offset:0 lds
    buffer_load_dwordx4 v22, s[36:39], s56 offen offset:1024 lds
    buffer_load_dwordx4 v23, s[36:39], s56 offen offset:2048 lds
    buffer_load_dwordx4 v24, s[36:39], s56 offen offset:3072 lds
    s_add_u32 s57, s57, 1
    s_add_u32 s59, s59, 8192
    s_cmp_eq_u32 s59, 24576
    s_cselect_b32 s59, 0, s59
    s_lshl_b32 s56, s55, 17
    s_add_u32 s56, s56, s69
    s_add_u32 m0, s53, s60
    s_nop 0
    buffer_load_dwordx4 v25, s[40:43], s56 offen offset:0 lds
    buffer_load_dwordx4 v26, s[40:43], s56 offen offset:1024 lds
    buffer_load_dwordx4 v27, s[40:43], s56 offen offset:2048 lds
    buffer_load_dwordx4 v28, s[40:43], s56 offen offset:3072 lds
    s_add_u32 s58, s58, 1
    s_add_u32 s60, s60, 8192
    s_cmp_eq_u32 s60, 24576
    s_cselect_b32 s60, 0, s60
    s_waitcnt vmcnt(18)
    s_barrier
    s_add_u32 s55, s57, s31
    s_and_b32 s55, s55, 3
    s_andn2_b32 s49, s57, 3
    s_or_b32 s55, s55, s49
    s_lshl_b32 s56, s55, 7
    s_add_u32 m0, s52, s59
    s_nop 0
    buffer_load_dwordx4 v21, s[36:39], s56 offen offset:0 lds
    buffer_load_dwordx4 v22, s[36:39], s56 offen offset:1024 lds
    buffer_load_dwordx4 v23, s[36:39], s56 offen offset:2048 lds
    buffer_load_dwordx4 v24, s[36:39], s56 offen offset:3072 lds
    s_add_u32 s57, s57, 1
    s_add_u32 s59, s59, 8192
    s_cmp_eq_u32 s59, 24576
    s_cselect_b32 s59, 0, s59
    s_lshl_b32 s56, s55, 17
    s_add_u32 s56, s56, s69
    s_add_u32 m0, s53, s60
    s_nop 0
    buffer_load_dwordx4 v25, s[40:43], s56 offen offset:0 lds
    buffer_load_dwordx4 v26, s[40:43], s56 offen offset:1024 lds
    buffer_load_dwordx4 v27, s[40:43], s56 offen offset:2048 lds
    buffer_load_dwordx4 v28, s[40:43], s56 offen offset:3072 lds
    s_add_u32 s58, s58, 1
    s_add_u32 s60, s60, 8192
    s_cmp_eq_u32 s60, 24576
    s_cselect_b32 s60, 0, s60
    s_waitcnt vmcnt(16)
    s_barrier
    s_add_u32 s55, s57, s31
    s_and_b32 s55, s55, 3
    s_andn2_b32 s49, s57, 3
    s_or_b32 s55, s55, s49
    s_lshl_b32 s56, s55, 7
    s_add_u32 m0, s52, s59
    s_nop 0
    buffer_load_dwordx4 v21, s[36:39], s56 offen offset:0 lds
    buffer_load_dwordx4 v22, s[36:39], s56 offen offset:1024 lds
    buffer_load_dwordx4 v23, s[36:39], s56 offen offset:2048 lds
    buffer_load_dwordx4 v24, s[36:39], s56 offen offset:3072 lds
    s_add_u32 s57, s57, 1
    s_add_u32 s59, s59, 8192
    s_cmp_eq_u32 s59, 24576
    s_cselect_b32 s59, 0, s59
    s_lshl_b32 s56, s55, 17
    s_add_u32 s56, s56, s69
    s_add_u32 m0, s53, s60
    s_nop 0
    buffer_load_dwordx4 v25, s[40:43], s56 offen offset:0 lds
    buffer_load_dwordx4 v26, s[40:43], s56 offen offset:1024 lds
    buffer_load_dwordx4 v27, s[40:43], s56 offen offset:2048 lds
    buffer_load_dwordx4 v28, s[40:43], s56 offen offset:3072 lds
    s_add_u32 s58, s58, 1
    s_add_u32 s60, s60, 8192
    s_cmp_eq_u32 s60, 24576
    s_cselect_b32 s60, 0, s60
    s_waitcnt vmcnt(16)
    s_barrier
    s_mov_b32 s71, 4
ld_loop2:
    s_waitcnt vmcnt(8)
    s_barrier
    s_add_u32 s55, s57, s31
    s_and_b32 s55, s55, 3
    s_andn2_b32 s49, s57, 3
    s_or_b32 s55, s55, s49
    s_lshl_b32 s56, s55, 7
    s_add_u32 m0, s52, s59
    s_nop 0
    buffer_load_dwordx4 v21, s[36:39], s56 offen offset:0 lds
    buffer_load_dwordx4 v22, s[36:39], s56 offen offset:1024 lds
    buffer_load_dwordx4 v23, s[36:39], s56 offen offset:2048 lds
    buffer_load_dwordx4 v24, s[36:39], s56 offen offset:3072 lds
    s_add_u32 s57, s57, 1
    s_add_u32 s59, s59, 8192
    s_cmp_eq_u32 s59, 24576
    s_cselect_b32 s59, 0, s59
    s_lshl_b32 s56, s55, 17
    s_add_u32 s56, s56, s69
    s_add_u32 m0, s53, s60
    s_nop 0
    buffer_load_dwordx4 v25, s[40:43], s56 offen offset:0 lds
    buffer_load_dwordx4 v26, s[40:43], s56 offen offset:1024 lds
    buffer_load_dwordx4 v27, s[40:43], s56 offen offset:2048 lds
    buffer_load_dwordx4 v28, s[40:43], s56 offen offset:3072 lds
    s_add_u32 s58, s58, 1
    s_add_u32 s60, s60, 8192
    s_cmp_eq_u32 s60, 24576
    s_cselect_b32 s60, 0, s60
    s_sub_u32 s71, s71, 1
    s_cbranch_scc0 ld_loop2
    s_waitcnt vmcnt(8)
    s_barrier
    buffer_load_dword v17, v16, s[44:47], 0 offen sc1
    s_add_u32 s55, s57, s31
    s_and_b32 s55, s55, 3
    s_andn2_b32 s49, s57, 3
    s_or_b32 s55, s55, s49
    s_lshl_b32 s56, s55, 7
    s_add_u32 m0, s52, s59
    s_nop 0
    buffer_load_dwordx4 v21, s[36:39], s56 offen offset:0 lds
    buffer_load_dwordx4 v22, s[36:39], s56 offen offset:1024 lds
    buffer_load_dwordx4 v23, s[36:39], s56 offen offset:2048 lds
    buffer_load_dwordx4 v24, s[36:39], s56 offen offset:3072 lds
    s_add_u32 s57, s57, 1
    s_add_u32 s59, s59, 8192
    s_cmp_eq_u32 s59, 24576
    s_cselect_b32 s59, 0, s59
    s_lshl_b32 s56, s55, 17
    s_add_u32 s56, s56, s69
    s_add_u32 m0, s53, s60
    s_nop 0
    buffer_load_dwordx4 v25, s[40:43], s56 offen offset:0 lds
    buffer_load_dwordx4 v26, s[40:43], s56 offen offset:1024 lds
    buffer_load_dwordx4 v27, s[40:43], s56 offen offset:2048 lds
    buffer_load_dwordx4 v28, s[40:43], s56 offen offset:3072 lds
    s_add_u32 s58, s58, 1
    s_add_u32 s60, s60, 8192
    s_cmp_eq_u32 s60, 24576
    s_cselect_b32 s60, 0, s60
    s_waitcnt vmcnt(9)
    s_barrier
    s_waitcnt vmcnt(8)
    s_mov_b32 s72, 65536
ld0_poll:
    v_cmp_ne_u32 vcc, v18, v17
    s_nop 0
    s_andn2_b32 s49, s67, vcc_lo
    s_cmp_eq_u32 s49, 0
    s_cbranch_scc1 ld0_polled
    s_sleep 1
    buffer_load_dword v17, v16, s[44:47], 0 offen sc1
    s_sub_u32 s72, s72, 1
    s_cmp_lg_u32 s72, 0
    s_waitcnt vmcnt(0)
    s_cbranch_scc1 ld0_poll
ld0_polled:
    s_add_u32 s56, s66, s65
    s_add_u32 m0, s54, s61
    s_nop 0
    buffer_load_dwordx4 v15, s[44:47], s56 offen offset:0 sc1 lds
    buffer_load_dwordx4 v15, s[44:47], s56 offen offset:1024 sc1 lds
    s_add_u32 s66, s66, 4096
    s_and_b32 s66, s66, 131071
    s_add_u32 s61, s61, 4096
    s_and_b32 s61, s61, 32767
    s_add_u32 s56, s66, s65
    s_add_u32 m0, s54, s61
    s_nop 0
    buffer_load_dwordx4 v15, s[44:47], s56 offen offset:0 sc1 lds
    buffer_load_dwordx4 v15, s[44:47], s56 offen offset:1024 sc1 lds
    s_add_u32 s66, s66, 4096
    s_and_b32 s66, s66, 131071
    s_add_u32 s61, s61, 4096
    s_and_b32 s61, s61, 32767
    s_add_u32 s56, s66, s65
    s_add_u32 m0, s54, s61
    s_nop 0
    buffer_load_dwordx4 v15, s[44:47], s56 offen offset:0 sc1 lds
    buffer_load_dwordx4 v15, s[44:47], s56 offen offset:1024 sc1 lds
    s_add_u32 s66, s66, 4096
    s_and_b32 s66, s66, 131071
    s_add_u32 s61, s61, 4096
    s_and_b32 s61, s61, 32767
    s_add_u32 s55, s57, s31
    s_and_b32 s55, s55, 3
    s_andn2_b32 s49, s57, 3
    s_or_b32 s55, s55, s49
    s_lshl_b32 s56, s55, 7
    s_add_u32 m0, s52, s59
    s_nop 0
    buffer_load_dwordx4 v21, s[36:39], s56 offen offset:0 lds
    buffer_load_dwordx4 v22, s[36:39], s56 offen offset:1024 lds
    buffer_load_dwordx4 v23, s[36:39], s56 offen offset:2048 lds
    buffer_load_dwordx4 v24, s[36:39], s56 offen offset:3072 lds
    s_add_u32 s57, s57, 1
    s_add_u32 s59, s59, 8192
    s_cmp_eq_u32 s59, 24576
    s_cselect_b32 s59, 0, s59
    s_lshl_b32 s56, s55, 17
    s_add_u32 s56, s56, s69
    s_add_u32 m0, s53, s60
    s_nop 0
    buffer_load_dwordx4 v25, s[40:43], s56 offen offset:0 lds
    buffer_load_dwordx4 v26, s[40:43], s56 offen offset:1024 lds
    buffer_load_dwordx4 v27, s[40:43], s56 offen offset:2048 lds
    buffer_load_dwordx4 v28, s[40:43], s56 offen offset:3072 lds
    s_add_u32 s58, s58, 1
    s_add_u32 s60, s60, 8192
    s_cmp_eq_u32 s60, 24576
    s_cselect_b32 s60, 0, s60
    s_waitcnt vmcnt(14)
    s_barrier
    buffer_load_dword v17, v16, s[44:47], 0 offen sc1
    s_add_u32 s56, s66, s65
    s_add_u32 m0, s54, s61
    s_nop 0
    buffer_load_dwordx4 v15, s[44:47], s56 offen offset:0 sc1 lds
    buffer_load_dwordx4 v15, s[44:47], s56 offen offset:1024 sc1 lds
    s_add_u32 s66, s66, 4096
    s_and_b32 s66, s66, 131071
    s_add_u32 s61, s61, 4096
    s_and_b32 s61, s61, 32767
    s_add_u32 s55, s57, s31
    s_and_b32 s55, s55, 3
    s_andn2_b32 s49, s57, 3
    s_or_b32 s55, s55, s49
    s_lshl_b32 s56, s55, 7
    s_add_u32 m0, s52, s59
    s_nop 0
    buffer_load_dwordx4 v21, s[36:39], s56 offen offset:0 lds
    buffer_load_dwordx4 v22, s[36:39], s56 offen offset:1024 lds
    buffer_load_dwordx4 v23, s[36:39], s56 offen offset:2048 lds
    buffer_load_dwordx4 v24, s[36:39], s56 offen offset:3072 lds
    s_add_u32 s57, s57, 1
    s_add_u32 s59, s59, 8192
    s_cmp_eq_u32 s59, 24576
    s_cselect_b32 s59, 0, s59
    s_lshl_b32 s56, s55, 17
    s_add_u32 s56, s56, s69
    s_add_u32 m0, s53, s60
    s_nop 0
    buffer_load_dwordx4 v25, s[40:43], s56 offen offset:0 lds
    buffer_load_dwordx4 v26, s[40:43], s56 offen offset:1024 lds
    buffer_load_dwordx4 v27, s[40:43], s56 offen offset:2048 lds
    buffer_load_dwordx4 v28, s[40:43], s56 offen offset:3072 lds
    s_add_u32 s58, s58, 1
    s_add_u32 s60, s60, 8192
    s_cmp_eq_u32 s60, 24576
    s_cselect_b32 s60, 0, s60
    s_waitcnt vmcnt(11)
    s_barrier
    s_waitcnt vmcnt(10)
    s_mov_b32 s72, 65536
ld1_poll:
    v_cmp_ne_u32 vcc, v18, v17
    s_nop 0
    s_andn2_b32 s49, s68, vcc_lo
    s_cmp_eq_u32 s49, 0
    s_cbranch_scc1 ld1_polled
    s_sleep 1
    buffer_load_dword v17, v16, s[44:47], 0 offen sc1
    s_sub_u32 s72, s72, 1
    s_cmp_lg_u32 s72, 0
    s_waitcnt vmcnt(0)
    s_cbranch_scc1 ld1_poll
ld1_polled:
    s_add_u32 s56, s66, s65
    s_add_u32 m0, s54, s61
    s_nop 0
    buffer_load_dwordx4 v15, s[44:47], s56 offen offset:0 sc1 lds
    buffer_load_dwordx4 v15, s[44:47], s56 offen offset:1024 sc1 lds
    s_add_u32 s66, s66, 4096
    s_and_b32 s66, s66, 131071
    s_add_u32 s61, s61, 4096
    s_and_b32 s61, s61, 32767
    s_add_u32 s56, s66, s65
    s_add_u32 m0, s54, s61
    s_nop 0
    buffer_load_dwordx4 v15, s[44:47], s56 offen offset:0 sc1 lds
    buffer_load_dwordx4 v15, s[44:47], s56 offen offset:1024 sc1 lds
    s_add_u32 s66, s66, 4096
    s_and_b32 s66, s66, 131071
    s_add_u32 s61, s61, 4096
    s_and_b32 s61, s61, 32767
    s_add_u32 s56, s66, s65
    s_add_u32 m0, s54, s61
    s_nop 0
    buffer_load_dwordx4 v15, s[44:47], s56 offen offset:0 sc1 lds
    buffer_load_dwordx4 v15, s[44:47], s56 offen offset:1024 sc1 lds
    s_add_u32 s66, s66, 4096
    s_and_b32 s66, s66, 131071
    s_add_u32 s61, s61, 4096
    s_and_b32 s61, s61, 32767
    s_add_u32 s55, s57, s31
    s_and_b32 s55, s55, 3
    s_andn2_b32 s49, s57, 3
    s_or_b32 s55, s55, s49
    s_lshl_b32 s56, s55, 7
    s_add_u32 m0, s52, s59
    s_nop 0
    buffer_load_dwordx4 v21, s[36:39], s56 offen offset:0 lds
    buffer_load_dwordx4 v22, s[36:39], s56 offen offset:1024 lds
    buffer_load_dwordx4 v23, s[36:39], s56 offen offset:2048 lds
    buffer_load_dwordx4 v24, s[36:39], s56 offen offset:3072 lds
    s_add_u32 s57, s57, 1
    s_add_u32 s59, s59, 8192
    s_cmp_eq_u32 s59, 24576
    s_cselect_b32 s59, 0, s59
    s_lshl_b32 s56, s55, 17
    s_add_u32 s56, s56, s69
    s_add_u32 m0, s53, s60
    s_nop 0
    buffer_load_dwordx4 v25, s[40:43], s56 offen offset:0 lds
    buffer_load_dwordx4 v26, s[40:43], s56 offen offset:1024 lds
    buffer_load_dwordx4 v27, s[40:43], s56 offen offset:2048 lds
    buffer_load_dwordx4 v28, s[40:43], s56 offen offset:3072 lds
    s_add_u32 s58, s58, 1
    s_add_u32 s60, s60, 8192
    s_cmp_eq_u32 s60, 24576
    s_cselect_b32 s60, 0, s60
    s_waitcnt vmcnt(14)
    s_barrier
    s_add_u32 s56, s66, s65
    s_add_u32 m0, s54, s61
    s_nop 0
    buffer_load_dwordx4 v15, s[44:47], s56 offen offset:0 sc1 lds
    buffer_load_dwordx4 v15, s[44:47], s56 offen offset:1024 sc1 lds
    s_add_u32 s66, s66, 4096
    s_and_b32 s66, s66, 131071
    s_add_u32 s61, s61, 4096
    s_and_b32 s61, s61, 32767
    s_add_u32 s55, s57, s31
    s_and_b32 s55, s55, 3
    s_andn2_b32 s49, s57, 3
    s_or_b32 s55, s55, s49
    s_lshl_b32 s56, s55, 7
    s_add_u32 m0, s52, s59
    s_nop 0
    buffer_load_dwordx4 v21, s[36:39], s56 offen offset:0 lds
    buffer_load_dwordx4 v22, s[36:39], s56 offen offset:1024 lds
    buffer_load_dwordx4 v23, s[36:39], s56 offen offset:2048 lds
    buffer_load_dwordx4 v24, s[36:39], s56 offen offset:3072 lds
    s_add_u32 s57, s57, 1
    s_add_u32 s59, s59, 8192
    s_cmp_eq_u32 s59, 24576
    s_cselect_b32 s59, 0, s59
    s_lshl_b32 s56, s55, 17
    s_add_u32 s56, s56, s69
    s_add_u32 m0, s53, s60
    s_nop 0
    buffer_load_dwordx4 v25, s[40:43], s56 offen offset:0 lds
    buffer_load_dwordx4 v26, s[40:43], s56 offen offset:1024 lds
    buffer_load_dwordx4 v27, s[40:43], s56 offen offset:2048 lds
    buffer_load_dwordx4 v28, s[40:43], s56 offen offset:3072 lds
    s_add_u32 s58, s58, 1
    s_add_u32 s60, s60, 8192
    s_cmp_eq_u32 s60, 24576
    s_cselect_b32 s60, 0, s60
    s_waitcnt vmcnt(10)
    s_barrier
    s_add_u32 s56, s66, s65
    s_add_u32 m0, s54, s61
    s_nop 0
    buffer_load_dwordx4 v15, s[44:47], s56 offen offset:0 sc1 lds
    buffer_load_dwordx4 v15, s[44:47], s56 offen offset:1024 sc1 lds
    s_add_u32 s66, s66, 4096
    s_and_b32 s66, s66, 131071
    s_add_u32 s61, s61, 4096
    s_and_b32 s61, s61, 32767
    s_add_u32 s56, s66, s65
    s_add_u32 m0, s54, s61
    s_nop 0
    buffer_load_dwordx4 v15, s[44:47], s56 offen offset:0 sc1 lds
    buffer_load_dwordx4 v15, s[44:47], s56 offen offset:1024 sc1 lds
    s_add_u32 s66, s66, 4096
    s_and_b32 s66, s66, 131071
    s_add_u32 s61, s61, 4096
    s_and_b32 s61, s61, 32767
    s_add_u32 s55, s57, s31
    s_and_b32 s55, s55, 3
    s_andn2_b32 s49, s57, 3
    s_or_b32 s55, s55, s49
    s_lshl_b32 s56, s55, 7
    s_add_u32 m0, s52, s59
    s_nop 0
    buffer_load_dwordx4 v21, s[36:39], s56 offen offset:0 lds
    buffer_load_dwordx4 v22, s[36:39], s56 offen offset:1024 lds
    buffer_load_dwordx4 v23, s[36:39], s56 offen offset:2048 lds
    buffer_load_dwordx4 v24, s[36:39], s56 offen offset:3072 lds
    s_add_u32 s57, s57, 1
    s_add_u32 s59, s59, 8192
    s_cmp_eq_u32 s59, 24576
    s_cselect_b32 s59, 0, s59
    s_lshl_b32 s56, s55, 17
    s_add_u32 s56, s56, s69
    s_add_u32 m0, s53, s60
    s_nop 0
    buffer_load_dwordx4 v25, s[40:43], s56 offen offset:0 lds
    buffer_load_dwordx4 v26, s[40:43], s56 offen offset:1024 lds
    buffer_load_dwordx4 v27, s[40:43], s56 offen offset:2048 lds
    buffer_load_dwordx4 v28, s[40:43], s56 offen offset:3072 lds
    s_add_u32 s58, s58, 1
    s_add_u32 s60, s60, 8192
    s_cmp_eq_u32 s60, 24576
    s_cselect_b32 s60, 0, s60
    s_mov_b32 s71, 3
ld_loop3:
    s_waitcnt vmcnt(12)
    s_barrier
    s_add_u32 s56, s66, s65
    s_add_u32 m0, s54, s61
    s_nop 0
    buffer_load_dwordx4 v15, s[44:47], s56 offen offset:0 sc1 lds
    buffer_load_dwordx4 v15, s[44:47], s56 offen offset:1024 sc1 lds
    s_add_u32 s66, s66, 4096
    s_and_b32 s66, s66, 131071
    s_add_u32 s61, s61, 4096
    s_and_b32 s61, s61, 32767
    s_add_u32 s56, s66, s65
    s_add_u32 m0, s54, s61
    s_nop 0
    buffer_load_dwordx4 v15, s[44:47], s56 offen offset:0 sc1 lds
    buffer_load_dwordx4 v15, s[44:47], s56 offen offset:1024 sc1 lds
    s_add_u32 s66, s66, 4096
    s_and_b32 s66, s66, 131071
    s_add_u32 s61, s61, 4096
    s_and_b32 s61, s61, 32767
    s_add_u32 s55, s57, s31
    s_and_b32 s55, s55, 3
    s_andn2_b32 s49, s57, 3
    s_or_b32 s55, s55, s49
    s_lshl_b32 s56, s55, 7
    s_add_u32 m0, s52, s59
    s_nop 0
    buffer_load_dwordx4 v21, s[36:39], s56 offen offset:0 lds
    buffer_load_dwordx4 v22, s[36:39], s56 offen offset:1024 lds
    buffer_load_dwordx4 v23, s[36:39], s56 offen offset:2048 lds
    buffer_load_dwordx4 v24, s[36:39], s56 offen offset:3072 lds
    s_add_u32 s57, s57, 1
    s_add_u32 s59, s59, 8192
    s_cmp_eq_u32 s59, 24576
    s_cselect_b32 s59, 0, s59
    s_lshl_b32 s56, s55, 17
    s_add_u32 s56, s56, s69
    s_add_u32 m0, s53, s60
    s_nop 0
    buffer_load_dwordx4 v25, s[40:43], s56 offen offset:0 lds
    buffer_load_dwordx4 v26, s[40:43], s56 offen offset:1024 lds
    buffer_load_dwordx4 v27, s[40:43], s56 offen offset:2048 lds
    buffer_load_dwordx4 v28, s[40:43], s56 offen offset:3072 lds
    s_add_u32 s58, s58, 1
    s_add_u32 s60, s60, 8192
    s_cmp_eq_u32 s60, 24576
    s_cselect_b32 s60, 0, s60
    s_sub_u32 s71, s71, 1
    s_cbranch_scc0 ld_loop3
    s_waitcnt vmcnt(12)
    s_barrier
    buffer_load_dword v17, v16, s[44:47], 0 offen sc1
    s_add_u32 s56, s66, s65
    s_add_u32 m0, s54, s61
    s_nop 0
    buffer_load_dwordx4 v15, s[44:47], s56 offen offset:0 sc1 lds
    buffer_load_dwordx4 v15, s[44:47], s56 offen offset:1024 sc1 lds
    s_add_u32 s66, s66, 4096
    s_and_b32 s66, s66, 131071
    s_add_u32 s61, s61, 4096
    s_and_b32 s61, s61, 32767
    s_add_u32 s56, s66, s65
    s_add_u32 m0, s54, s61
    s_nop 0
    buffer_load_dwordx4 v15, s[44:47], s56 offen offset:0 sc1 lds
    buffer_load_dwordx4 v15, s[44:47], s56 offen offset:1024 sc1 lds
    s_add_u32 s66, s66, 4096
    s_and_b32 s66, s66, 131071
    s_add_u32 s61, s61, 4096
    s_and_b32 s61, s61, 32767
    s_add_u32 s55, s57, s31
    s_and_b32 s55, s55, 3
    s_andn2_b32 s49, s57, 3
    s_or_b32 s55, s55, s49
    s_lshl_b32 s56, s55, 7
    s_add_u32 m0, s52, s59
    s_nop 0
    buffer_load_dwordx4 v21, s[36:39], s56 offen offset:0 lds
    buffer_load_dwordx4 v22, s[36:39], s56 offen offset:1024 lds
    buffer_load_dwordx4 v23, s[36:39], s56 offen offset:2048 lds
    buffer_load_dwordx4 v24, s[36:39], s56 offen offset:3072 lds
    s_add_u32 s57, s57, 1
    s_add_u32 s59, s59, 8192
    s_cmp_eq_u32 s59, 24576
    s_cselect_b32 s59, 0, s59
    s_lshl_b32 s56, s55, 17
    s_add_u32 s56, s56, s69
    s_add_u32 m0, s53, s60
    s_nop 0
    buffer_load_dwordx4 v25, s[40:43], s56 offen offset:0 lds
    buffer_load_dwordx4 v26, s[40:43], s56 offen offset:1024 lds
    buffer_load_dwordx4 v27, s[40:43], s56 offen offset:2048 lds
    buffer_load_dwordx4 v28, s[40:43], s56 offen offset:3072 lds
    s_add_u32 s58, s58, 1
    s_add_u32 s60, s60, 8192
    s_cmp_eq_u32 s60, 24576
    s_cselect_b32 s60, 0, s60
    s_waitcnt vmcnt(13)
    s_barrier
    s_add_u32 s56, s66, s65
    s_add_u32 m0, s54, s61
    s_nop 0
    buffer_load_dwordx4 v15, s[44:47], s56 offen offset:0 sc1 lds
    buffer_load_dwordx4 v15, s[44:47], s56 offen offset:1024 sc1 lds
    s_add_u32 s66, s66, 4096
    s_and_b32 s66, s66, 131071
    s_add_u32 s61, s61, 4096
    s_and_b32 s61, s61, 32767
    s_add_u32 s56, s66, s65
    s_add_u32 m0, s54, s61
    s_nop 0
    buffer_load_dwordx4 v15, s[44:47], s56 offen offset:0 sc1 lds
    buffer_load_dwordx4 v15, s[44:47], s56 offen offset:1024 sc1 lds
    s_add_u32 s66, s66, 4096
    s_and_b32 s66, s66, 131071
    s_add_u32 s61, s61, 4096
    s_and_b32 s61, s61, 32767
    s_add_u32 s55, s57, s31
    s_and_b32 s55, s55, 3
    s_andn2_b32 s49, s57, 3
    s_or_b32 s55, s55, s49
    s_lshl_b32 s56, s55, 7
    s_add_u32 m0, s52, s59
    s_nop 0
    buffer_load_dwordx4 v21, s[36:39], s56 offen offset:0 lds
    buffer_load_dwordx4 v22, s[36:39], s56 offen offset:1024 lds
    buffer_load_dwordx4 v23, s[36:39], s56 offen offset:2048 lds
    buffer_load_dwordx4 v24, s[36:39], s56 offen offset:3072 lds
    s_add_u32 s57, s57, 1
    s_add_u32 s59, s59, 8192
    s_cmp_eq_u32 s59, 24576
    s_cselect_b32 s59, 0, s59
    s_lshl_b32 s56, s55, 17
    s_add_u32 s56, s56, s69
    s_add_u32 m0, s53, s60
    s_nop 0
    buffer_load_dwordx4 v25, s[40:43], s56 offen offset:0 lds
    buffer_load_dwordx4 v26, s[40:43], s56 offen offset:1024 lds
    buffer_load_dwordx4 v27, s[40:43], s56 offen offset:2048 lds
    buffer_load_dwordx4 v28, s[40:43], s56 offen offset:3072 lds
    s_add_u32 s58, s58, 1
    s_add_u32 s60, s60, 8192
    s_cmp_eq_u32 s60, 24576
    s_cselect_b32 s60, 0, s60
    s_waitcnt vmcnt(12)
    s_barrier
    s_mov_b32 s72, 65536
ld2_poll:
    v_cmp_ne_u32 vcc, v18, v17
    s_nop 0
    s_cmp_eq_u32 vcc_lo, -1
    s_cbranch_scc1 ld2_polled
    s_sleep 1
    buffer_load_dword v17, v16, s[44:47], 0 offen sc1
    s_sub_u32 s72, s72, 1
    s_cmp_lg_u32 s72, 0
    s_waitcnt vmcnt(0)
    s_cbranch_scc1 ld2_poll
ld2_polled:
    s_add_u32 s56, s66, s65
    s_add_u32 m0, s54, s61
    s_nop 0
    buffer_load_dwordx4 v15, s[44:47], s56 offen offset:0 sc1 lds
    buffer_load_dwordx4 v15, s[44:47], s56 offen offset:1024 sc1 lds
    s_add_u32 s66, s66, 4096
    s_and_b32 s66, s66, 131071
    s_add_u32 s61, s61, 4096
    s_and_b32 s61, s61, 32767
    s_add_u32 s56, s66, s65
    s_add_u32 m0, s54, s61
    s_nop 0
    buffer_load_dwordx4 v15, s[44:47], s56 offen offset:0 sc1 lds
    buffer_load_dwordx4 v15, s[44:47], s56 offen offset:1024 sc1 lds
    s_add_u32 s66, s66, 4096
    s_and_b32 s66, s66, 131071
    s_add_u32 s61, s61, 4096
    s_and_b32 s61, s61, 32767
    s_add_u32 s55, s57, s31
    s_and_b32 s55, s55, 3
    s_andn2_b32 s49, s57, 3
    s_or_b32 s55, s55, s49
    s_lshl_b32 s56, s55, 7
    s_add_u32 m0, s52, s59
    s_nop 0
    buffer_load_dwordx4 v21, s[36:39], s56 offen offset:0 lds
    buffer_load_dwordx4 v22, s[36:39], s56 offen offset:1024 lds
    buffer_load_dwordx4 v23, s[36:39], s56 offen offset:2048 lds
    buffer_load_dwordx4 v24, s[36:39], s56 offen offset:3072 lds
    s_add_u32 s57, s57, 1
    s_add_u32 s59, s59, 8192
    s_cmp_eq_u32 s59, 24576
    s_cselect_b32 s59, 0, s59
    s_lshl_b32 s56, s55, 17
    s_add_u32 s56, s56, s69
    s_add_u32 m0, s53, s60
    s_nop 0
    buffer_load_dwordx4 v25, s[40:43], s56 offen offset:0 lds
    buffer_load_dwordx4 v26, s[40:43], s56 offen offset:1024 lds
    buffer_load_dwordx4 v27, s[40:43], s56 offen offset:2048 lds
    buffer_load_dwordx4 v28, s[40:43], s56 offen offset:3072 lds
    s_add_u32 s58, s58, 1
    s_add_u32 s60, s60, 8192
    s_cmp_eq_u32 s60, 24576
    s_cselect_b32 s60, 0, s60
    s_waitcnt vmcnt(12)
    s_barrier
    s_add_u32 s56, s66, s65
    s_add_u32 m0, s54, s61
    s_nop 0
    buffer_load_dwordx4 v15, s[44:47], s56 offen offset:0 sc1 lds
    buffer_load_dwordx4 v15, s[44:47], s56 offen offset:1024 sc1 lds
    s_add_u32 s66, s66, 4096
    s_and_b32 s66, s66, 131071
    s_add_u32 s61, s61, 4096
    s_and_b32 s61, s61, 32767
    s_add_u32 s56, s66, s65
    s_add_u32 m0, s54, s61
    s_nop 0
    buffer_load_dwordx4 v15, s[44:47], s56 offen offset:0 sc1 lds
    buffer_load_dwordx4 v15, s[44:47], s56 offen offset:1024 sc1 lds
    s_add_u32 s66, s66, 4096
    s_and_b32 s66, s66, 131071
    s_add_u32 s61, s61, 4096
    s_and_b32 s61, s61, 32767
    s_add_u32 s55, s57, s31
    s_and_b32 s55, s55, 3
    s_andn2_b32 s49, s57, 3
    s_or_b32 s55, s55, s49
    s_lshl_b32 s56, s55, 7
    s_add_u32 m0, s52, s59
    s_nop 0
    buffer_load_dwordx4 v21, s[36:39], s56 offen offset:0 lds
    buffer_load_dwordx4 v22, s[36:39], s56 offen offset:1024 lds
    buffer_load_dwordx4 v23, s[36:39], s56 offen offset:2048 lds
    buffer_load_dwordx4 v24, s[36:39], s56 offen offset:3072 lds
    s_add_u32 s57, s57, 1
    s_add_u32 s59, s59, 8192
    s_cmp_eq_u32 s59, 24576
    s_cselect_b32 s59, 0, s59
    s_lshl_b32 s56, s55, 17
    s_add_u32 s56, s56, s69
    s_add_u32 m0, s53, s60
    s_nop 0
    buffer_load_dwordx4 v25, s[40:43], s56 offen offset:0 lds
    buffer_load_dwordx4 v26, s[40:43], s56 offen offset:1024 lds
    buffer_load_dwordx4 v27, s[40:43], s56 offen offset:2048 lds
    buffer_load_dwordx4 v28, s[40:43], s56 offen offset:3072 lds
    s_add_u32 s58, s58, 1
    s_add_u32 s60, s60, 8192
    s_cmp_eq_u32 s60, 24576
    s_cselect_b32 s60, 0, s60
    s_waitcnt vmcnt(12)
    s_barrier
    s_add_u32 s56, s66, s65
    s_add_u32 m0, s54, s61
    s_nop 0
    buffer_load_dwordx4 v15, s[44:47], s56 offen offset:0 sc1 lds
    buffer_load_dwordx4 v15, s[44:47], s56 offen offset:1024 sc1 lds
    s_add_u32 s66, s66, 4096
    s_and_b32 s66, s66, 131071
    s_add_u32 s61, s61, 4096
    s_and_b32 s61, s61, 32767
    s_add_u32 s56, s66, s65
    s_add_u32 m0, s54, s61
    s_nop 0
    buffer_load_dwordx4 v15, s[44:47], s56 offen offset:0 sc1 lds
    buffer_load_dwordx4 v15, s[44:47], s56 offen offset:1024 sc1 lds
    s_add_u32 s66, s66, 4096
    s_and_b32 s66, s66, 131071
    s_add_u32 s61, s61, 4096
    s_and_b32 s61, s61, 32767
    s_add_u32 s55, s57, s31
    s_and_b32 s55, s55, 3
    s_andn2_b32 s49, s57, 3
    s_or_b32 s55, s55, s49
    s_lshl_b32 s56, s55, 7
    s_add_u32 m0, s52, s59
    s_nop 0
    buffer_load_dwordx4 v21, s[36:39], s56 offen offset:0 lds
    buffer_load_dwordx4 v22, s[36:39], s56 offen offset:1024 lds
    buffer_load_dwordx4 v23, s[36:39], s56 offen offset:2048 lds
    buffer_load_dwordx4 v24, s[36:39], s56 offen offset:3072 lds
    s_add_u32 s57, s57, 1
    s_add_u32 s59, s59, 8192
    s_cmp_eq_u32 s59, 24576
    s_cselect_b32 s59, 0, s59
    s_lshl_b32 s56, s55, 17
    s_add_u32 s56, s56, s69
    s_add_u32 m0, s53, s60
    s_nop 0
    buffer_load_dwordx4 v25, s[40:43], s56 offen offset:0 lds
    buffer_load_dwordx4 v26, s[40:43], s56 offen offset:1024 lds
    buffer_load_dwordx4 v27, s[40:43], s56 offen offset:2048 lds
    buffer_load_dwordx4 v28, s[40:43], s56 offen offset:3072 lds
    s_add_u32 s58, s58, 1
    s_add_u32 s60, s60, 8192
    s_cmp_eq_u32 s60, 24576
    s_cselect_b32 s60, 0, s60
    s_waitcnt vmcnt(12)
    s_barrier
    s_xor_b32 s65, s65, 131072
    s_add_u32 s56, s66, s65
    s_add_u32 m0, s54, s61
    s_nop 0
    buffer_load_dwordx4 v15, s[44:47], s56 offen offset:0 sc1 lds
    buffer_load_dwordx4 v15, s[44:47], s56 offen offset:1024 sc1 lds
    s_add_u32 s66, s66, 4096
    s_and_b32 s66, s66, 131071
    s_add_u32 s61, s61, 4096
    s_and_b32 s61, s61, 32767
    s_add_u32 s56, s66, s65
    s_add_u32 m0, s54, s61
    s_nop 0
    buffer_load_dwordx4 v15, s[44:47], s56 offen offset:0 sc1 lds
    buffer_load_dwordx4 v15, s[44:47], s56 offen offset:1024 sc1 lds
    s_add_u32 s66, s66, 4096
    s_and_b32 s66, s66, 131071
    s_add_u32 s61, s61, 4096
    s_and_b32 s61, s61, 32767
    s_add_u32 s55, s57, s31
    s_and_b32 s55, s55, 3
    s_andn2_b32 s49, s57, 3
    s_or_b32 s55, s55, s49
    s_lshl_b32 s56, s55, 7
    s_add_u32 m0, s52, s59
    s_nop 0
    buffer_load_dwordx4 v21, s[36:39], s56 offen offset:0 lds
    buffer_load_dwordx4 v22, s[36:39], s56 offen offset:1024 lds
    buffer_load_dwordx4 v23, s[36:39], s56 offen offset:2048 lds
    buffer_load_dwordx4 v24, s[36:39], s56 offen offset:3072 lds
    s_add_u32 s57, s57, 1
    s_add_u32 s59, s59, 8192
    s_cmp_eq_u32 s59, 24576
    s_cselect_b32 s59, 0, s59
    s_lshl_b32 s56, s55, 17
    s_add_u32 s56, s56, s69
    s_add_u32 m0, s53, s60
    s_nop 0
    buffer_load_dwordx4 v25, s[40:43], s56 offen offset:0 lds
    buffer_load_dwordx4 v26, s[40:43], s56 offen offset:1024 lds
    buffer_load_dwordx4 v27, s[40:43], s56 offen offset:2048 lds
    buffer_load_dwordx4 v28, s[40:43], s56 offen offset:3072 lds
    s_add_u32 s58, s58, 1
    s_add_u32 s60, s60, 8192
    s_cmp_eq_u32 s60, 24576
    s_cselect_b32 s60, 0, s60
    s_mov_b32 s71, 5
ld_loop4:
    s_waitcnt vmcnt(12)
    s_barrier
    s_add_u32 s56, s66, s65
    s_add_u32 m0, s54, s61
    s_nop 0
    buffer_load_dwordx4 v15, s[44:47], s56 offen offset:0 sc1 lds
    buffer_load_dwordx4 v15, s[44:47], s56 offen offset:1024 sc1 lds
    s_add_u32 s66, s66, 4096
    s_and_b32 s66, s66, 131071
    s_add_u32 s61, s61, 4096
    s_and_b32 s61, s61, 32767
    s_add_u32 s56, s66, s65
    s_add_u32 m0, s54, s61
    s_nop 0
    buffer_load_dwordx4 v15, s[44:47], s56 offen offset:0 sc1 lds
    buffer_load_dwordx4 v15, s[44:47], s56 offen offset:1024 sc1 lds
    s_add_u32 s66, s66, 4096
    s_and_b32 s66, s66, 131071
    s_add_u32 s61, s61, 4096
    s_and_b32 s61, s61, 32767
    s_add_u32 s55, s57, s31
    s_and_b32 s55, s55, 3
    s_andn2_b32 s49, s57, 3
    s_or_b32 s55, s55, s49
    s_lshl_b32 s56, s55, 7
    s_add_u32 m0, s52, s59
    s_nop 0
    buffer_load_dwordx4 v21, s[36:39], s56 offen offset:0 lds
    buffer_load_dwordx4 v22, s[36:39], s56 offen offset:1024 lds
    buffer_load_dwordx4 v23, s[36:39], s56 offen offset:2048 lds
    buffer_load_dwordx4 v24, s[36:39], s56 offen offset:3072 lds
    s_add_u32 s57, s57, 1
    s_add_u32 s59, s59, 8192
    s_cmp_eq_u32 s59, 24576
    s_cselect_b32 s59, 0, s59
    s_lshl_b32 s56, s55, 17
    s_add_u32 s56, s56, s69
    s_add_u32 m0, s53, s60
    s_nop 0
    buffer_load_dwordx4 v25, s[40:43], s56 offen offset:0 lds
    buffer_load_dwordx4 v26, s[40:43], s56 offen offset:1024 lds
    buffer_load_dwordx4 v27, s[40:43], s56 offen offset:2048 lds
    buffer_load_dwordx4 v28, s[40:43], s56 offen offset:3072 lds
    s_add_u32 s58, s58, 1
    s_add_u32 s60, s60, 8192
    s_cmp_eq_u32 s60, 24576
    s_cselect_b32 s60, 0, s60
    s_sub_u32 s71, s71, 1
    s_cbranch_scc0 ld_loop4
    s_waitcnt vmcnt(12)
    s_barrier
    s_add_u32 s56, s66, s65
    s_add_u32 m0, s54, s61
    s_nop 0
    buffer_load_dwordx4 v15, s[44:47], s56 offen offset:0 sc1 lds
    buffer_load_dwordx4 v15, s[44:47], s56 offen offset:1024 sc1 lds
    s_add_u32 s66, s66, 4096
    s_and_b32 s66, s66, 131071
    s_add_u32 s61, s61, 4096
    s_and_b32 s61, s61, 32767
    s_add_u32 s56, s66, s65
    s_add_u32 m0, s54, s61
    s_nop 0
    buffer_load_dwordx4 v15, s[44:47], s56 offen offset:0 sc1 lds
    buffer_load_dwordx4 v15, s[44:47], s56 offen offset:1024 sc1 lds
    s_add_u32 s66, s66, 4096
    s_and_b32 s66, s66, 131071
    s_add_u32 s61, s61, 4096
    s_and_b32 s61, s61, 32767
    s_add_u32 s55, s57, s31
    s_and_b32 s55, s55, 3
    s_andn2_b32 s49, s57, 3
    s_or_b32 s55, s55, s49
    s_lshl_b32 s56, s55, 7
    s_add_u32 m0, s52, s59
    s_nop 0
    buffer_load_dwordx4 v21, s[36:39], s56 offen offset:0 lds
    buffer_load_dwordx4 v22, s[36:39], s56 offen offset:1024 lds
    buffer_load_dwordx4 v23, s[36:39], s56 offen offset:2048 lds
    buffer_load_dwordx4 v24, s[36:39], s56 offen offset:3072 lds
    s_add_u32 s57, s57, 1
    s_add_u32 s59, s59, 8192
    s_cmp_eq_u32 s59, 24576
    s_cselect_b32 s59, 0, s59
    s_lshl_b32 s56, s55, 17
    s_add_u32 s56, s56, s69
    s_add_u32 m0, s53, s60
    s_nop 0
    buffer_load_dwordx4 v25, s[40:43], s56 offen offset:0 lds
    buffer_load_dwordx4 v26, s[40:43], s56 offen offset:1024 lds
    buffer_load_dwordx4 v27, s[40:43], s56 offen offset:2048 lds
    buffer_load_dwordx4 v28, s[40:43], s56 offen offset:3072 lds
    s_add_u32 s58, s58, 1
    s_add_u32 s60, s60, 8192
    s_cmp_eq_u32 s60, 24576
    s_cselect_b32 s60, 0, s60
    s_mov_b32 s78, 2097152
    s_mov_b32 s79, 0x00020000
    v_lshrrev_b32 v33, 3, v0
    v_lshlrev_b32 v33, 4, v33
    v_and_or_b32 v33, v0, 7, v33
    v_lshlrev_b32 v33, 7, v33
    s_lshl2_add_u32 s49, s5, s48
    s_lshl_b32 s56, s49, 4
    s_add_u32 s56, s56, s30
    s_cmp_eq_u32 s30, 1
    s_cselect_b64 s[76:77], s[16:17], s[14:15]
    s_lshl_b32 s56, s56, 10
    buffer_load_dword v34, v33, s[76:79], s56 offen
    s_waitcnt vmcnt(13)
    s_barrier
    s_add_u32 s56, s66, s65
    s_add_u32 m0, s54, s61
    s_nop 0
    buffer_load_dwordx4 v15, s[44:47], s56 offen offset:0 sc1 lds
    buffer_load_dwordx4 v15, s[44:47], s56 offen offset:1024 sc1 lds
    s_add_u32 s66, s66, 4096
    s_and_b32 s66, s66, 131071
    s_add_u32 s61, s61, 4096
    s_and_b32 s61, s61, 32767
    s_add_u32 s56, s66, s65
    s_add_u32 m0, s54, s61
    s_nop 0
    buffer_load_dwordx4 v15, s[44:47], s56 offen offset:0 sc1 lds
    buffer_load_dwordx4 v15, s[44:47], s56 offen offset:1024 sc1 lds
    s_add_u32 s66, s66, 4096
    s_and_b32 s66, s66, 131071
    s_add_u32 s61, s61, 4096
    s_and_b32 s61, s61, 32767
    s_add_u32 s55, s57, s31
    s_and_b32 s55, s55, 3
    s_andn2_b32 s49, s57, 3
    s_or_b32 s55, s55, s49
    s_lshl_b32 s56, s55, 7
    s_add_u32 m0, s52, s59
    s_nop 0
    buffer_load_dwordx4 v21, s[36:39], s56 offen offset:0 lds
    buffer_load_dwordx4 v22, s[36:39], s56 offen offset:1024 lds
    buffer_load_dwordx4 v23, s[36:39], s56 offen offset:2048 lds
    buffer_load_dwordx4 v24, s[36:39], s56 offen offset:3072 lds
    s_add_u32 s57, s57, 1
    s_add_u32 s59, s59, 8192
    s_cmp_eq_u32 s59, 24576
    s_cselect_b32 s59, 0, s59
    s_lshl_b32 s56, s55, 17
    s_add_u32 s56, s56, s69
    s_add_u32 m0, s53, s60
    s_nop 0
    buffer_load_dwordx4 v25, s[40:43], s56 offen offset:0 lds
    buffer_load_dwordx4 v26, s[40:43], s56 offen offset:1024 lds
    buffer_load_dwordx4 v27, s[40:43], s56 offen offset:2048 lds
    buffer_load_dwordx4 v28, s[40:43], s56 offen offset:3072 lds
    s_add_u32 s58, s58, 1
    s_add_u32 s60, s60, 8192
    s_cmp_eq_u32 s60, 24576
    s_cselect_b32 s60, 0, s60
    s_waitcnt vmcnt(13)
    s_barrier
    s_add_u32 s56, s66, s65
    s_add_u32 m0, s54, s61
    s_nop 0
    buffer_load_dwordx4 v15, s[44:47], s56 offen offset:0 sc1 lds
    buffer_load_dwordx4 v15, s[44:47], s56 offen offset:1024 sc1 lds
    s_add_u32 s66, s66, 4096
    s_and_b32 s66, s66, 131071
    s_add_u32 s61, s61, 4096
    s_and_b32 s61, s61, 32767
    s_add_u32 s56, s66, s65
    s_add_u32 m0, s54, s61
    s_nop 0
    buffer_load_dwordx4 v15, s[44:47], s56 offen offset:0 sc1 lds
    buffer_load_dwordx4 v15, s[44:47], s56 offen offset:1024 sc1 lds
    s_add_u32 s66, s66, 4096
    s_and_b32 s66, s66, 131071
    s_add_u32 s61, s61, 4096
    s_and_b32 s61, s61, 32767
    s_cmp_eq_u32 s30, 1
    s_cselect_b64 s[40:41], s[16:17], s[14:15]
    s_mov_b32 s42, 2097152
    s_mov_b32 s58, 0
    s_cselect_b32 s57, 24, 0
    s_cselect_b32 s58, 8, 0
    s_add_u32 s55, s58, s31
    s_and_b32 s55, s55, 3
    s_andn2_b32 s49, s58, 3
    s_or_b32 s55, s55, s49
    s_lshl_b32 s56, s55, 7
    s_add_u32 m0, s53, s60
    s_nop 0
    buffer_load_dwordx4 v29, s[40:43], s56 offen offset:0 lds
    buffer_load_dwordx4 v30, s[40:43], s56 offen offset:1024 lds
    buffer_load_dwordx4 v31, s[40:43], s56 offen offset:2048 lds
    buffer_load_dwordx4 v32, s[40:43], s56 offen offset:3072 lds
    s_add_u32 s58, s58, 1
    s_add_u32 s60, s60, 8192
    s_cmp_eq_u32 s60, 24576
    s_cselect_b32 s60, 49152, s60
    s_cmp_eq_u32 s60, 57344
    s_cselect_b32 s60, 0, s60
    s_waitcnt vmcnt(8)
    s_barrier
    s_add_u32 s56, s66, s65
    s_add_u32 m0, s54, s61
    s_nop 0
    buffer_load_dwordx4 v15, s[44:47], s56 offen offset:0 sc1 lds
    buffer_load_dwordx4 v15, s[44:47], s56 offen offset:1024 sc1 lds
    s_add_u32 s66, s66, 4096
    s_and_b32 s66, s66, 131071
    s_add_u32 s61, s61, 4096
    s_and_b32 s61, s61, 32767
    s_add_u32 s56, s66, s65
    s_add_u32 m0, s54, s61
    s_nop 0
    buffer_load_dwordx4 v15, s[44:47], s56 offen offset:0 sc1 lds
    buffer_load_dwordx4 v15, s[44:47], s56 offen offset:1024 sc1 lds
    s_add_u32 s66, s66, 4096
    s_and_b32 s66, s66, 131071
    s_add_u32 s61, s61, 4096
    s_and_b32 s61, s61, 32767
    s_add_u32 s55, s58, s31
    s_and_b32 s55, s55, 3
    s_andn2_b32 s49, s58, 3
    s_or_b32 s55, s55, s49
    s_lshl_b32 s56, s55, 7
    s_add_u32 m0, s53, s60
    s_nop 0
    buffer_load_dwordx4 v29, s[40:43], s56 offen offset:0 lds
    buffer_load_dwordx4 v30, s[40:43], s56 offen offset:1024 lds
    buffer_load_dwordx4 v31, s[40:43], s56 offen offset:2048 lds
    buffer_load_dwordx4 v32, s[40:43], s56 offen offset:3072 lds
    s_add_u32 s58, s58, 1
    s_add_u32 s60, s60, 8192
    s_cmp_eq_u32 s60, 24576
    s_cselect_b32 s60, 49152, s60
    s_cmp_eq_u32 s60, 57344
    s_cselect_b32 s60, 0, s60
    s_waitcnt vmcnt(14)
    s_barrier
    s_add_u32 s56, s66, s65
    s_add_u32 m0, s54, s61
    s_nop 0
    buffer_load_dwordx4 v15, s[44:47], s56 offen offset:0 sc1 lds
    buffer_load_dwordx4 v15, s[44:47], s56 offen offset:1024 sc1 lds
    s_add_u32 s66, s66, 4096
    s_and_b32 s66, s66, 131071
    s_add_u32 s61, s61, 4096
    s_and_b32 s61, s61, 32767
    s_add_u32 s56, s66, s65
    s_add_u32 m0, s54, s61
    s_nop 0
    buffer_load_dwordx4 v15, s[44:47], s56 offen offset:0 sc1 lds
    buffer_load_dwordx4 v15, s[44:47], s56 offen offset:1024 sc1 lds
    s_add_u32 s66, s66, 4096
    s_and_b32 s66, s66, 131071
    s_add_u32 s61, s61, 4096
    s_and_b32 s61, s61, 32767
    s_add_u32 s55, s58, s31
    s_and_b32 s55, s55, 3
    s_andn2_b32 s49, s58, 3
    s_or_b32 s55, s55, s49
    s_lshl_b32 s56, s55, 7
    s_add_u32 m0, s53, s60
    s_nop 0
    buffer_load_dwordx4 v29, s[40:43], s56 offen offset:0 lds
    buffer_load_dwordx4 v30, s[40:43], s56 offen offset:1024 lds
    buffer_load_dwordx4 v31, s[40:43], s56 offen offset:2048 lds
    buffer_load_dwordx4 v32, s[40:43], s56 offen offset:3072 lds
    s_add_u32 s58, s58, 1
    s_add_u32 s60, s60, 8192
    s_cmp_eq_u32 s60, 24576
    s_cselect_b32 s60, 49152, s60
    s_cmp_eq_u32 s60, 57344
    s_cselect_b32 s60, 0, s60
    s_waitcnt vmcnt(14)
    s_barrier
    s_add_u32 s56, s66, s65
    s_add_u32 m0, s54, s61
    s_nop 0
    buffer_load_dwordx4 v15, s[44:47], s56 offen offset:0 sc1 lds
    buffer_load_dwordx4 v15, s[44:47], s56 offen offset:1024 sc1 lds
    s_add_u32 s66, s66, 4096
    s_and_b32 s66, s66, 131071
    s_add_u32 s61, s61, 4096
    s_and_b32 s61, s61, 32767
    s_add_u32 s56, s66, s65
    s_add_u32 m0, s54, s61
    s_nop 0
    buffer_load_dwordx4 v15, s[44:47], s56 offen offset:0 sc1 lds
    buffer_load_dwordx4 v15, s[44:47], s56 offen offset:1024 sc1 lds
    s_add_u32 s66, s66, 4096
    s_and_b32 s66, s66, 131071
    s_add_u32 s61, s61, 4096
    s_and_b32 s61, s61, 32767
    s_waitcnt vmcnt(10)
    s_barrier
    s_add_u32 s56, s66, s65
    s_add_u32 m0, s54, s61
    s_nop 0
    buffer_load_dwordx4 v15, s[44:47], s56 offen offset:0 sc1 lds
    buffer_load_dwordx4 v15, s[44:47], s56 offen offset:1024 sc1 lds
    s_add_u32 s66, s66, 4096
    s_and_b32 s66, s66, 131071
    s_add_u32 s61, s61, 4096
    s_and_b32 s61, s61, 32767
    s_add_u32 s56, s66, s65
    s_add_u32 m0, s54, s61
    s_nop 0
    buffer_load_dwordx4 v15, s[44:47], s56 offen offset:0 sc1 lds
    buffer_load_dwordx4 v15, s[44:47], s56 offen offset:1024 sc1 lds
    s_add_u32 s66, s66, 4096
    s_and_b32 s66, s66, 131071
    s_add_u32 s61, s61, 4096
    s_and_b32 s61, s61, 32767
    s_lshl2_add_u32 s49, s5, s48
    s_lshl_b32 s56, s49, 4
    s_add_u32 s56, s56, 1
    s_lshr_b32 s49, s49, 1
    s_lshl4_add_u32 s49, s49, s50
    s_cmp_eq_u32 s30, 1
    s_cselect_b32 s56, s49, s56
    s_cselect_b64 s[76:77], s[22:23], s[14:15]
    s_lshl_b32 s56, s56, 10
    buffer_load_dword v34, v33, s[76:79], s56 offen
    s_waitcnt vmcnt(7)
    s_barrier
    s_add_u32 s56, s66, s65
    s_add_u32 m0, s54, s61
    s_nop 0
    buffer_load_dwordx4 v15, s[44:47], s56 offen offset:0 sc1 lds
    buffer_load_dwordx4 v15, s[44:47], s56 offen offset:1024 sc1 lds
    s_add_u32 s66, s66, 4096
    s_and_b32 s66, s66, 131071
    s_add_u32 s61, s61, 4096
    s_and_b32 s61, s61, 32767
    s_add_u32 s56, s66, s65
    s_add_u32 m0, s54, s61
    s_nop 0
    buffer_load_dwordx4 v15, s[44:47], s56 offen offset:0 sc1 lds
    buffer_load_dwordx4 v15, s[44:47], s56 offen offset:1024 sc1 lds
    s_add_u32 s66, s66, 4096
    s_and_b32 s66, s66, 131071
    s_add_u32 s61, s61, 4096
    s_and_b32 s61, s61, 32767
    s_waitcnt vmcnt(7)
    s_barrier
    s_add_u32 s56, s66, s65
    s_add_u32 m0, s54, s61
    s_nop 0
    buffer_load_dwordx4 v15, s[44:47], s56 offen offset:0 sc1 lds
    buffer_load_dwordx4 v15, s[44:47], s56 offen offset:1024 sc1 lds
    s_add_u32 s66, s66, 4096
    s_and_b32 s66, s66, 131071
    s_add_u32 s61, s61, 4096
    s_and_b32 s61, s61, 32767
    s_add_u32 s56, s66, s65
    s_add_u32 m0, s54, s61
    s_nop 0
    buffer_load_dwordx4 v15, s[44:47], s56 offen offset:0 sc1 lds
    buffer_load_dwordx4 v15, s[44:47], s56 offen offset:1024 sc1 lds
    s_add_u32 s66, s66, 4096
    s_and_b32 s66, s66, 131071
    s_add_u32 s61, s61, 4096
    s_and_b32 s61, s61, 32767
    s_lshl2_add_u32 s49, s5, s48
    s_lshl_b32 s56, s49, 4
    s_lshr_b32 s49, s49, 1
    s_lshl4_add_u32 s49, s49, s50
    s_add_u32 s49, s49, 1024
    s_cmp_eq_u32 s30, 1
    s_cselect_b32 s56, s49, s56
    s_cselect_b64 s[76:77], s[22:23], s[16:17]
    s_lshl_b32 s56, s56, 10
    buffer_load_dword v34, v33, s[76:79], s56 offen
    s_waitcnt vmcnt(7)
    s_barrier
    buffer_load_dword v17, v16, s[44:47], 0 offen sc1
    s_waitcnt vmcnt(4)
    s_barrier
    s_waitcnt vmcnt(0)
    s_mov_b32 s72, 65536
ld3_poll:
    v_cmp_ne_u32 vcc, v18, v17
    s_nop 0
    s_cmp_eq_u32 vcc_hi, -1
    s_cbranch_scc1 ld3_polled
    s_sleep 1
    buffer_load_dword v17, v16, s[44:47], 0 offen sc1
    s_sub_u32 s72, s72, 1
    s_cmp_lg_u32 s72, 0
    s_waitcnt vmcnt(0)
    s_cbranch_scc1 ld3_poll
ld3_polled:
    s_add_u32 s55, s57, s31
    s_and_b32 s55, s55, 3
    s_andn2_b32 s49, s57, 3
    s_or_b32 s55, s55, s49
    s_lshl_b32 s56, s55, 12
    s_add_u32 s56, s56, s70
    s_add_u32 m0, s52, s59
    s_nop 0
    buffer_load_dwordx4 v15, s[44:47], s56 offen offset:0 sc1 lds
    buffer_load_dwordx4 v15, s[44:47], s56 offen offset:1024 sc1 lds
    buffer_load_dwordx4 v15, s[44:47], s56 offen offset:2048 sc1 lds
    buffer_load_dwordx4 v15, s[44:47], s56 offen offset:3072 sc1 lds
    s_add_u32 s57, s57, 1
    s_add_u32 s59, s59, 8192
    s_cmp_eq_u32 s59, 24576
    s_cselect_b32 s59, 106496, s59
    s_cmp_eq_u32 s59, 114688
    s_cselect_b32 s59, 0, s59
    s_add_u32 s55, s57, s31
    s_and_b32 s55, s55, 3
    s_andn2_b32 s49, s57, 3
    s_or_b32 s55, s55, s49
    s_lshl_b32 s56, s55, 12
    s_add_u32 s56, s56, s70
    s_add_u32 m0, s52, s59
    s_nop 0
    buffer_load_dwordx4 v15, s[44:47], s56 offen offset:0 sc1 lds
    buffer_load_dwordx4 v15, s[44:47], s56 offen offset:1024 sc1 lds
    buffer_load_dwordx4 v15, s[44:47], s56 offen offset:2048 sc1 lds
    buffer_load_dwordx4 v15, s[44:47], s56 offen offset:3072 sc1 lds
    s_add_u32 s57, s57, 1
    s_add_u32 s59, s59, 8192
    s_cmp_eq_u32 s59, 24576
    s_cselect_b32 s59, 106496, s59
    s_cmp_eq_u32 s59, 114688
    s_cselect_b32 s59, 0, s59
    s_barrier
    s_add_u32 s55, s57, s31
    s_and_b32 s55, s55, 3
    s_andn2_b32 s49, s57, 3
    s_or_b32 s55, s55, s49
    s_lshl_b32 s56, s55, 12
    s_add_u32 s56, s56, s70
    s_add_u32 m0, s52, s59
    s_nop 0
    buffer_load_dwordx4 v15, s[44:47], s56 offen offset:0 sc1 lds
    buffer_load_dwordx4 v15, s[44:47], s56 offen offset:1024 sc1 lds
    buffer_load_dwordx4 v15, s[44:47], s56 offen offset:2048 sc1 lds
    buffer_load_dwordx4 v15, s[44:47], s56 offen offset:3072 sc1 lds
    s_add_u32 s57, s57, 1
    s_add_u32 s59, s59, 8192
    s_cmp_eq_u32 s59, 24576
    s_cselect_b32 s59, 106496, s59
    s_cmp_eq_u32 s59, 114688
    s_cselect_b32 s59, 0, s59
    s_waitcnt vmcnt(8)
    s_barrier
    s_add_u32 s55, s57, s31
    s_and_b32 s55, s55, 3
    s_andn2_b32 s49, s57, 3
    s_or_b32 s55, s55, s49
    s_lshl_b32 s56, s55, 12
    s_add_u32 s56, s56, s70
    s_add_u32 m0, s52, s59
    s_nop 0
    buffer_load_dwordx4 v15, s[44:47], s56 offen offset:0 sc1 lds
    buffer_load_dwordx4 v15, s[44:47], s56 offen offset:1024 sc1 lds
    buffer_load_dwordx4 v15, s[44:47], s56 offen offset:2048 sc1 lds
    buffer_load_dwordx4 v15, s[44:47], s56 offen offset:3072 sc1 lds
    s_add_u32 s57, s57, 1
    s_add_u32 s59, s59, 8192
    s_cmp_eq_u32 s59, 24576
    s_cselect_b32 s59, 106496, s59
    s_cmp_eq_u32 s59, 114688
    s_cselect_b32 s59, 0, s59
    s_add_u32 s55, s58, s31
    s_and_b32 s55, s55, 3
    s_andn2_b32 s49, s58, 3
    s_or_b32 s55, s55, s49
    s_lshl_b32 s56, s55, 7
    s_add_u32 m0, s53, s60
    s_nop 0
    buffer_load_dwordx4 v29, s[40:43], s56 offen offset:0 lds
    buffer_load_dwordx4 v30, s[40:43], s56 offen offset:1024 lds
    buffer_load_dwordx4 v31, s[40:43], s56 offen offset:2048 lds
    buffer_load_dwordx4 v32, s[40:43], s56 offen offset:3072 lds
    s_add_u32 s58, s58, 1
    s_add_u32 s60, s60, 8192
    s_cmp_eq_u32 s60, 24576
    s_cselect_b32 s60, 49152, s60
    s_cmp_eq_u32 s60, 57344
    s_cselect_b32 s60, 0, s60
    s_cmp_eq_u32 s30, 1
    s_cbranch_scc1 ld_b
    s_waitcnt vmcnt(12)
    s_barrier
    buffer_load_dword v17, v19, s[44:47], 0 offen sc1
    s_add_u32 s55, s57, s31
    s_and_b32 s55, s55, 3
    s_andn2_b32 s49, s57, 3
    s_or_b32 s55, s55, s49
    s_lshl_b32 s56, s55, 12
    s_add_u32 s56, s56, s70
    s_add_u32 m0, s52, s59
    s_nop 0
    buffer_load_dwordx4 v15, s[44:47], s56 offen offset:0 sc1 lds
    buffer_load_dwordx4 v15, s[44:47], s56 offen offset:1024 sc1 lds
    buffer_load_dwordx4 v15, s[44:47], s56 offen offset:2048 sc1 lds
    buffer_load_dwordx4 v15, s[44:47], s56 offen offset:3072 sc1 lds
    s_add_u32 s57, s57, 1
    s_add_u32 s59, s59, 8192
    s_cmp_eq_u32 s59, 24576
    s_cselect_b32 s59, 106496, s59
    s_cmp_eq_u32 s59, 114688
    s_cselect_b32 s59, 0, s59
    s_add_u32 s55, s58, s31
    s_and_b32 s55, s55, 3
    s_andn2_b32 s49, s58, 3
    s_or_b32 s55, s55, s49
    s_lshl_b32 s56, s55, 7
    s_add_u32 m0, s53, s60
    s_nop 0
    buffer_load_dwordx4 v29, s[40:43], s56 offen offset:0 lds
    buffer_load_dwordx4 v30, s[40:43], s56 offen offset:1024 lds
    buffer_load_dwordx4 v31, s[40:43], s56 offen offset:2048 lds
    buffer_load_dwordx4 v32, s[40:43], s56 offen offset:3072 lds
    s_add_u32 s58, s58, 1
    s_add_u32 s60, s60, 8192
    s_cmp_eq_u32 s60, 24576
    s_cselect_b32 s60, 49152, s60
    s_cmp_eq_u32 s60, 57344
    s_cselect_b32 s60, 0, s60
    s_waitcnt vmcnt(17)
    s_barrier
    s_add_u32 s55, s57, s31
    s_and_b32 s55, s55, 3
    s_andn2_b32 s49, s57, 3
    s_or_b32 s55, s55, s49
    s_lshl_b32 s56, s55, 12
    s_add_u32 s56, s56, s70
    s_add_u32 m0, s52, s59
    s_nop 0
    buffer_load_dwordx4 v15, s[44:47], s56 offen offset:0 sc1 lds
    buffer_load_dwordx4 v15, s[44:47], s56 offen offset:1024 sc1 lds
    buffer_load_dwordx4 v15, s[44:47], s56 offen offset:2048 sc1 lds
    buffer_load_dwordx4 v15, s[44:47], s56 offen offset:3072 sc1 lds
    s_add_u32 s57, s57, 1
    s_add_u32 s59, s59, 8192
    s_cmp_eq_u32 s59, 24576
    s_cselect_b32 s59, 106496, s59
    s_cmp_eq_u32 s59, 114688
    s_cselect_b32 s59, 0, s59
    s_add_u32 s55, s58, s31
    s_and_b32 s55, s55, 3
    s_andn2_b32 s49, s58, 3
    s_or_b32 s55, s55, s49
    s_lshl_b32 s56, s55, 7
    s_add_u32 m0, s53, s60
    s_nop 0
    buffer_load_dwordx4 v29, s[40:43], s56 offen offset:0 lds
    buffer_load_dwordx4 v30, s[40:43], s56 offen offset:1024 lds
    buffer_load_dwordx4 v31, s[40:43], s56 offen offset:2048 lds
    buffer_load_dwordx4 v32, s[40:43], s56 offen offset:3072 lds
    s_add_u32 s58, s58, 1
    s_add_u32 s60, s60, 8192
    s_cmp_eq_u32 s60, 24576
    s_cselect_b32 s60, 49152, s60
    s_cmp_eq_u32 s60, 57344
    s_cselect_b32 s60, 0, s60
    s_waitcnt vmcnt(17)
    s_barrier
    s_add_u32 s55, s57, s31
    s_and_b32 s55, s55, 3
    s_andn2_b32 s49, s57, 3
    s_or_b32 s55, s55, s49
    s_lshl_b32 s56, s55, 12
    s_add_u32 s56, s56, s70
    s_add_u32 m0, s52, s59
    s_nop 0
    buffer_load_dwordx4 v15, s[44:47], s56 offen offset:0 sc1 lds
    buffer_load_dwordx4 v15, s[44:47], s56 offen offset:1024 sc1 lds
    buffer_load_dwordx4 v15, s[44:47], s56 offen offset:2048 sc1 lds
    buffer_load_dwordx4 v15, s[44:47], s56 offen offset:3072 sc1 lds
    s_add_u32 s57, s57, 1
    s_add_u32 s59, s59, 8192
    s_cmp_eq_u32 s59, 24576
    s_cselect_b32 s59, 106496, s59
    s_cmp_eq_u32 s59, 114688
    s_cselect_b32 s59, 0, s59
    s_add_u32 s55, s58, s31
    s_and_b32 s55, s55, 3
    s_andn2_b32 s49, s58, 3
    s_or_b32 s55, s55, s49
    s_lshl_b32 s56, s55, 7
    s_add_u32 m0, s53, s60
    s_nop 0
    buffer_load_dwordx4 v29, s[40:43], s56 offen offset:0 lds
    buffer_load_dwordx4 v30, s[40:43], s56 offen offset:1024 lds
    buffer_load_dwordx4 v31, s[40:43], s56 offen offset:2048 lds
    buffer_load_dwordx4 v32, s[40:43], s56 offen offset:3072 lds
    s_add_u32 s58, s58, 1
    s_add_u32 s60, s60, 8192
    s_cmp_eq_u32 s60, 24576
    s_cselect_b32 s60, 49152, s60
    s_cmp_eq_u32 s60, 57344
    s_cselect_b32 s60, 0, s60
    s_mov_b32 s71, 3
lda_loop1:
    s_waitcnt vmcnt(16)
    s_barrier
    s_add_u32 s55, s57, s31
    s_and_b32 s55, s55, 3
    s_andn2_b32 s49, s57, 3
    s_or_b32 s55, s55, s49
    s_lshl_b32 s56, s55, 12
    s_add_u32 s56, s56, s70
    s_add_u32 m0, s52, s59
    s_nop 0
    buffer_load_dwordx4 v15, s[44:47], s56 offen offset:0 sc1 lds
    buffer_load_dwordx4 v15, s[44:47], s56 offen offset:1024 sc1 lds
    buffer_load_dwordx4 v15, s[44:47], s56 offen offset:2048 sc1 lds
    buffer_load_dwordx4 v15, s[44:47], s56 offen offset:3072 sc1 lds
    s_add_u32 s57, s57, 1
    s_add_u32 s59, s59, 8192
    s_cmp_eq_u32 s59, 24576
    s_cselect_b32 s59, 106496, s59
    s_cmp_eq_u32 s59, 114688
    s_cselect_b32 s59, 0, s59
    s_add_u32 s55, s58, s31
    s_and_b32 s55, s55, 3
    s_andn2_b32 s49, s58, 3
    s_or_b32 s55, s55, s49
    s_lshl_b32 s56, s55, 7
    s_add_u32 m0, s53, s60
    s_nop 0
    buffer_load_dwordx4 v29, s[40:43], s56 offen offset:0 lds
    buffer_load_dwordx4 v30, s[40:43], s56 offen offset:1024 lds
    buffer_load_dwordx4 v31, s[40:43], s56 offen offset:2048 lds
    buffer_load_dwordx4 v32, s[40:43], s56 offen offset:3072 lds
    s_add_u32 s58, s58, 1
    s_add_u32 s60, s60, 8192
    s_cmp_eq_u32 s60, 24576
    s_cselect_b32 s60, 49152, s60
    s_cmp_eq_u32 s60, 57344
    s_cselect_b32 s60, 0, s60
    s_sub_u32 s71, s71, 1
    s_cbranch_scc0 lda_loop1
    s_mov_b32 s71, 4
lda_loop2:
    s_waitcnt vmcnt(16)
    s_barrier
    s_add_u32 s55, s57, s31
    s_and_b32 s55, s55, 3
    s_andn2_b32 s49, s57, 3
    s_or_b32 s55, s55, s49
    s_lshl_b32 s56, s55, 12
    s_add_u32 s56, s56, s70
    s_add_u32 m0, s52, s59
    s_nop 0
    buffer_load_dwordx4 v15, s[44:47], s56 offen offset:0 sc1 lds
    buffer_load_dwordx4 v15, s[44:47], s56 offen offset:1024 sc1 lds
    buffer_load_dwordx4 v15, s[44:47], s56 offen offset:2048 sc1 lds
    buffer_load_dwordx4 v15, s[44:47], s56 offen offset:3072 sc1 lds
    s_add_u32 s57, s57, 1
    s_add_u32 s59, s59, 8192
    s_cmp_eq_u32 s59, 24576
    s_cselect_b32 s59, 106496, s59
    s_cmp_eq_u32 s59, 114688
    s_cselect_b32 s59, 0, s59
    s_add_u32 s55, s58, s31
    s_and_b32 s55, s55, 3
    s_andn2_b32 s49, s58, 3
    s_or_b32 s55, s55, s49
    s_lshl_b32 s56, s55, 7
    s_add_u32 m0, s53, s60
    s_nop 0
    buffer_load_dwordx4 v29, s[40:43], s56 offen offset:0 lds
    buffer_load_dwordx4 v30, s[40:43], s56 offen offset:1024 lds
    buffer_load_dwordx4 v31, s[40:43], s56 offen offset:2048 lds
    buffer_load_dwordx4 v32, s[40:43], s56 offen offset:3072 lds
    s_add_u32 s58, s58, 1
    s_add_u32 s60, s60, 8192
    s_cmp_eq_u32 s60, 24576
    s_cselect_b32 s60, 49152, s60
    s_cmp_eq_u32 s60, 57344
    s_cselect_b32 s60, 0, s60
    s_sub_u32 s71, s71, 1
    s_cbranch_scc0 lda_loop2
    s_waitcnt vmcnt(16)
    s_barrier
    s_mov_b64 s[40:41], s[16:17]
    s_mov_b32 s42, 2097152
    s_mov_b32 s58, 0
    s_add_u32 s55, s58, s31
    s_and_b32 s55, s55, 3
    s_andn2_b32 s49, s58, 3
    s_or_b32 s55, s55, s49
    s_lshl_b32 s56, s55, 7
    s_add_u32 m0, s53, s60
    s_nop 0
    buffer_load_dwordx4 v29, s[40:43], s56 offen offset:0 lds
    buffer_load_dwordx4 v30, s[40:43], s56 offen offset:1024 lds
    buffer_load_dwordx4 v31, s[40:43], s56 offen offset:2048 lds
    buffer_load_dwordx4 v32, s[40:43], s56 offen offset:3072 lds
    s_add_u32 s58, s58, 1
    s_add_u32 s60, s60, 8192
    s_cmp_eq_u32 s60, 24576
    s_cselect_b32 s60, 49152, s60
    s_cmp_eq_u32 s60, 57344
    s_cselect_b32 s60, 0, s60
    s_mov_b32 s72, 65536
ld4_poll:
    v_cmp_ne_u32 vcc, v20, v17
    s_nop 0
    s_cmp_eq_u32 vcc_lo, -1
    s_cbranch_scc1 ld4_polled
    s_sleep 1
    buffer_load_dword v17, v19, s[44:47], 0 offen sc1
    s_sub_u32 s72, s72, 1
    s_cmp_lg_u32 s72, 0
    s_waitcnt vmcnt(0)
    s_cbranch_scc1 ld4_poll
ld4_polled:
    s_add_u32 s55, s57, s31
    s_and_b32 s55, s55, 3
    s_andn2_b32 s49, s57, 3
    s_or_b32 s55, s55, s49
    s_lshl_b32 s56, s55, 12
    s_add_u32 s56, s56, s70
    s_add_u32 m0, s52, s59
    s_nop 0
    buffer_load_dwordx4 v15, s[44:47], s56 offen offset:0 sc1 lds
    buffer_load_dwordx4 v15, s[44:47], s56 offen offset:1024 sc1 lds
    buffer_load_dwordx4 v15, s[44:47], s56 offen offset:2048 sc1 lds
    buffer_load_dwordx4 v15, s[44:47], s56 offen offset:3072 sc1 lds
    s_add_u32 s57, s57, 1
    s_add_u32 s59, s59, 8192
    s_cmp_eq_u32 s59, 24576
    s_cselect_b32 s59, 106496, s59
    s_cmp_eq_u32 s59, 114688
    s_cselect_b32 s59, 0, s59
    s_mov_b32 s71, 3
lda_loop3:
    s_waitcnt vmcnt(16)
    s_barrier
    s_add_u32 s55, s57, s31
    s_and_b32 s55, s55, 3
    s_andn2_b32 s49, s57, 3
    s_or_b32 s55, s55, s49
    s_lshl_b32 s56, s55, 12
    s_add_u32 s56, s56, s70
    s_add_u32 m0, s52, s59
    s_nop 0
    buffer_load_dwordx4 v15, s[44:47], s56 offen offset:0 sc1 lds
    buffer_load_dwordx4 v15, s[44:47], s56 offen offset:1024 sc1 lds
    buffer_load_dwordx4 v15, s[44:47], s56 offen offset:2048 sc1 lds
    buffer_load_dwordx4 v15, s[44:47], s56 offen offset:3072 sc1 lds
    s_add_u32 s57, s57, 1
    s_add_u32 s59, s59, 8192
    s_cmp_eq_u32 s59, 24576
    s_cselect_b32 s59, 106496, s59
    s_cmp_eq_u32 s59, 114688
    s_cselect_b32 s59, 0, s59
    s_add_u32 s55, s58, s31
    s_and_b32 s55, s55, 3
    s_andn2_b32 s49, s58, 3
    s_or_b32 s55, s55, s49
    s_lshl_b32 s56, s55, 7
    s_add_u32 m0, s53, s60
    s_nop 0
    buffer_load_dwordx4 v29, s[40:43], s56 offen offset:0 lds
    buffer_load_dwordx4 v30, s[40:43], s56 offen offset:1024 lds
    buffer_load_dwordx4 v31, s[40:43], s56 offen offset:2048 lds
    buffer_load_dwordx4 v32, s[40:43], s56 offen offset:3072 lds
    s_add_u32 s58, s58, 1
    s_add_u32 s60, s60, 8192
    s_cmp_eq_u32 s60, 24576
    s_cselect_b32 s60, 49152, s60
    s_cmp_eq_u32 s60, 57344
    s_cselect_b32 s60, 0, s60
    s_sub_u32 s71, s71, 1
    s_cbranch_scc0 lda_loop3
    s_waitcnt vmcnt(16)
    s_barrier
    s_add_u32 s55, s57, s31
    s_and_b32 s55, s55, 3
    s_andn2_b32 s49, s57, 3
    s_or_b32 s55, s55, s49
    s_lshl_b32 s56, s55, 12
    s_add_u32 s56, s56, s70
    s_add_u32 m0, s52, s59
    s_nop 0
    buffer_load_dwordx4 v15, s[44:47], s56 offen offset:0 sc1 lds
    buffer_load_dwordx4 v15, s[44:47], s56 offen offset:1024 sc1 lds
    buffer_load_dwordx4 v15, s[44:47], s56 offen offset:2048 sc1 lds
    buffer_load_dwordx4 v15, s[44:47], s56 offen offset:3072 sc1 lds
    s_add_u32 s57, s57, 1
    s_add_u32 s59, s59, 8192
    s_cmp_eq_u32 s59, 24576
    s_cselect_b32 s59, 106496, s59
    s_cmp_eq_u32 s59, 114688
    s_cselect_b32 s59, 0, s59
    s_add_u32 s55, s58, s31
    s_and_b32 s55, s55, 3
    s_andn2_b32 s49, s58, 3
    s_or_b32 s55, s55, s49
    s_lshl_b32 s56, s55, 7
    s_add_u32 m0, s53, s60
    s_nop 0
    buffer_load_dwordx4 v29, s[40:43], s56 offen offset:0 lds
    buffer_load_dwordx4 v30, s[40:43], s56 offen offset:1024 lds
    buffer_load_dwordx4 v31, s[40:43], s56 offen offset:2048 lds
    buffer_load_dwordx4 v32, s[40:43], s56 offen offset:3072 lds
    s_add_u32 s58, s58, 1
    s_add_u32 s60, s60, 8192
    s_cmp_eq_u32 s60, 24576
    s_cselect_b32 s60, 49152, s60
    s_cmp_eq_u32 s60, 57344
    s_cselect_b32 s60, 0, s60
    buffer_load_dword v17, v19, s[44:47], 0 offen sc1
    s_waitcnt vmcnt(17)
    s_barrier
    s_add_u32 s55, s57, s31
    s_and_b32 s55, s55, 3
    s_andn2_b32 s49, s57, 3
    s_or_b32 s55, s55, s49
    s_lshl_b32 s56, s55, 12
    s_add_u32 s56, s56, s70
    s_add_u32 m0, s52, s59
    s_nop 0
    buffer_load_dwordx4 v15, s[44:47], s56 offen offset:0 sc1 lds
    buffer_load_dwordx4 v15, s[44:47], s56 offen offset:1024 sc1 lds
    buffer_load_dwordx4 v15, s[44:47], s56 offen offset:2048 sc1 lds
    buffer_load_dwordx4 v15, s[44:47], s56 offen offset:3072 sc1 lds
    s_add_u32 s57, s57, 1
    s_add_u32 s59, s59, 8192
    s_cmp_eq_u32 s59, 24576
    s_cselect_b32 s59, 106496, s59
    s_cmp_eq_u32 s59, 114688
    s_cselect_b32 s59, 0, s59
    s_add_u32 s55, s58, s31
    s_and_b32 s55, s55, 3
    s_andn2_b32 s49, s58, 3
    s_or_b32 s55, s55, s49
    s_lshl_b32 s56, s55, 7
    s_add_u32 m0, s53, s60
    s_nop 0
    buffer_load_dwordx4 v29, s[40:43], s56 offen offset:0 lds
    buffer_load_dwordx4 v30, s[40:43], s56 offen offset:1024 lds
    buffer_load_dwordx4 v31, s[40:43], s56 offen offset:2048 lds
    buffer_load_dwordx4 v32, s[40:43], s56 offen offset:3072 lds
    s_add_u32 s58, s58, 1
    s_add_u32 s60, s60, 8192
    s_cmp_eq_u32 s60, 24576
    s_cselect_b32 s60, 49152, s60
    s_cmp_eq_u32 s60, 57344
    s_cselect_b32 s60, 0, s60
    s_waitcnt vmcnt(17)
    s_barrier
    s_add_u32 s55, s57, s31
    s_and_b32 s55, s55, 3
    s_andn2_b32 s49, s57, 3
    s_or_b32 s55, s55, s49
    s_lshl_b32 s56, s55, 12
    s_add_u32 s56, s56, s70
    s_add_u32 m0, s52, s59
    s_nop 0
    buffer_load_dwordx4 v15, s[44:47], s56 offen offset:0 sc1 lds
    buffer_load_dwordx4 v15, s[44:47], s56 offen offset:1024 sc1 lds
    buffer_load_dwordx4 v15, s[44:47], s56 offen offset:2048 sc1 lds
    buffer_load_dwordx4 v15, s[44:47], s56 offen offset:3072 sc1 lds
    s_add_u32 s57, s57, 1
    s_add_u32 s59, s59, 8192
    s_cmp_eq_u32 s59, 24576
    s_cselect_b32 s59, 106496, s59
    s_cmp_eq_u32 s59, 114688
    s_cselect_b32 s59, 0, s59
    s_add_u32 s55, s58, s31
    s_and_b32 s55, s55, 3
    s_andn2_b32 s49, s58, 3
    s_or_b32 s55, s55, s49
    s_lshl_b32 s56, s55, 7
    s_add_u32 m0, s53, s60
    s_nop 0
    buffer_load_dwordx4 v29, s[40:43], s56 offen offset:0 lds
    buffer_load_dwordx4 v30, s[40:43], s56 offen offset:1024 lds
    buffer_load_dwordx4 v31, s[40:43], s56 offen offset:2048 lds
    buffer_load_dwordx4 v32, s[40:43], s56 offen offset:3072 lds
    s_add_u32 s58, s58, 1
    s_add_u32 s60, s60, 8192
    s_cmp_eq_u32 s60, 24576
    s_cselect_b32 s60, 49152, s60
    s_cmp_eq_u32 s60, 57344
    s_cselect_b32 s60, 0, s60
    s_waitcnt vmcnt(16)
    s_mov_b32 s72, 65536
ld6_poll:
    v_cmp_ne_u32 vcc, v20, v17
    s_nop 0
    s_cmp_eq_u32 vcc_hi, -1
    s_cbranch_scc1 ld6_polled
    s_sleep 1
    buffer_load_dword v17, v19, s[44:47], 0 offen sc1
    s_sub_u32 s72, s72, 1
    s_cmp_lg_u32 s72, 0
    s_waitcnt vmcnt(0)
    s_cbranch_scc1 ld6_poll
ld6_polled:
    s_lshl_b32 s56, s73, 13
    s_add_u32 s56, s56, 25165824
    s_lshl_b32 s49, s48, 13
    s_cselect_b32 s49, s49, 4294950912
    s_add_u32 m0, s49, 131072
    s_nop 0
    buffer_load_dwordx4 v15, s[44:47], s56 offen offset:0 sc1 lds
    buffer_load_dwordx4 v15, s[44:47], s56 offen offset:1024 sc1 lds
    buffer_load_dwordx4 v15, s[44:47], s56 offen offset:2048 sc1 lds
    buffer_load_dwordx4 v15, s[44:47], s56 offen offset:3072 sc1 lds
    s_add_u32 s56, s56, 4096
    s_add_u32 m0, s49, 135168
    s_nop 0
    buffer_load_dwordx4 v15, s[44:47], s56 offen offset:0 sc1 lds
    buffer_load_dwordx4 v15, s[44:47], s56 offen offset:1024 sc1 lds
    buffer_load_dwordx4 v15, s[44:47], s56 offen offset:2048 sc1 lds
    buffer_load_dwordx4 v15, s[44:47], s56 offen offset:3072 sc1 lds
    s_barrier
    s_waitcnt vmcnt(16)
    s_barrier
    s_waitcnt vmcnt(8)
    s_barrier
    s_waitcnt vmcnt(0)
    s_barrier
    s_endpgm
ld_b:
    s_waitcnt vmcnt(12)
    s_barrier
    s_add_u32 s55, s57, s31
    s_and_b32 s55, s55, 3
    s_andn2_b32 s49, s57, 3
    s_or_b32 s55, s55, s49
    s_lshl_b32 s56, s55, 12
    s_add_u32 s56, s56, s70
    s_add_u32 m0, s52, s59
    s_nop 0
    buffer_load_dwordx4 v15, s[44:47], s56 offen offset:0 sc1 lds
    buffer_load_dwordx4 v15, s[44:47], s56 offen offset:1024 sc1 lds
    buffer_load_dwordx4 v15, s[44:47], s56 offen offset:2048 sc1 lds
    buffer_load_dwordx4 v15, s[44:47], s56 offen offset:3072 sc1 lds
    s_add_u32 s57, s57, 1
    s_add_u32 s59, s59, 8192
    s_cmp_eq_u32 s59, 24576
    s_cselect_b32 s59, 106496, s59
    s_cmp_eq_u32 s59, 114688
    s_cselect_b32 s59, 0, s59
    s_add_u32 s55, s58, s31
    s_and_b32 s55, s55, 3
    s_andn2_b32 s49, s58, 3
    s_or_b32 s55, s55, s49
    s_lshl_b32 s56, s55, 7
    s_add_u32 m0, s53, s60
    s_nop 0
    buffer_load_dwordx4 v29, s[40:43], s56 offen offset:0 lds
    buffer_load_dwordx4 v30, s[40:43], s56 offen offset:1024 lds
    buffer_load_dwordx4 v31, s[40:43], s56 offen offset:2048 lds
    buffer_load_dwordx4 v32, s[40:43], s56 offen offset:3072 lds
    s_add_u32 s58, s58, 1
    s_add_u32 s60, s60, 8192
    s_cmp_eq_u32 s60, 24576
    s_cselect_b32 s60, 49152, s60
    s_cmp_eq_u32 s60, 57344
    s_cselect_b32 s60, 0, s60
    s_mov_b32 s71, 2
ldb_loop1:
    s_waitcnt vmcnt(16)
    s_barrier
    s_add_u32 s55, s57, s31
    s_and_b32 s55, s55, 3
    s_andn2_b32 s49, s57, 3
    s_or_b32 s55, s55, s49
    s_lshl_b32 s56, s55, 12
    s_add_u32 s56, s56, s70
    s_add_u32 m0, s52, s59
    s_nop 0
    buffer_load_dwordx4 v15, s[44:47], s56 offen offset:0 sc1 lds
    buffer_load_dwordx4 v15, s[44:47], s56 offen offset:1024 sc1 lds
    buffer_load_dwordx4 v15, s[44:47], s56 offen offset:2048 sc1 lds
    buffer_load_dwordx4 v15, s[44:47], s56 offen offset:3072 sc1 lds
    s_add_u32 s57, s57, 1
    s_add_u32 s59, s59, 8192
    s_cmp_eq_u32 s59, 24576
    s_cselect_b32 s59, 106496, s59
    s_cmp_eq_u32 s59, 114688
    s_cselect_b32 s59, 0, s59
    s_add_u32 s55, s58, s31
    s_and_b32 s55, s55, 3
    s_andn2_b32 s49, s58, 3
    s_or_b32 s55, s55, s49
    s_lshl_b32 s56, s55, 7
    s_add_u32 m0, s53, s60
    s_nop 0
    buffer_load_dwordx4 v29, s[40:43], s56 offen offset:0 lds
    buffer_load_dwordx4 v30, s[40:43], s56 offen offset:1024 lds
    buffer_load_dwordx4 v31, s[40:43], s56 offen offset:2048 lds
    buffer_load_dwordx4 v32, s[40:43], s56 offen offset:3072 lds
    s_add_u32 s58, s58, 1
    s_add_u32 s60, s60, 8192
    s_cmp_eq_u32 s60, 24576
    s_cselect_b32 s60, 49152, s60
    s_cmp_eq_u32 s60, 57344
    s_cselect_b32 s60, 0, s60
    s_sub_u32 s71, s71, 1
    s_cbranch_scc0 ldb_loop1
    s_waitcnt vmcnt(16)
    s_barrier
    s_mov_b64 s[40:41], s[22:23]
    s_mov_b32 s42, 2097152
    s_mov_b32 s58, 0
    s_lshr_b32 s70, s70, 1
    s_add_u32 s70, s70, 4194304
    s_mov_b32 s68, 0x01010101
    s_lshl_b32 s66, s28, 1
    s_and_b32 s66, s66, 24
    s_lshl_b32 s66, -1, s66
    v_lshlrev_b32 v16, 2, v0
    v_add_u32 v16, 114688, v16
    s_and_b32 s67, s66, s68
    s_cselect_b32 s67, s67, s68
    s_ff1_i32_b32 s49, s67
    s_bitset0_b32 s68, s49
    s_lshl_b32 s67, 255, s49
    s_lshr_b32 s57, s49, 1
    s_mov_b32 s58, s57
    s_add_u32 s55, s58, s31
    s_and_b32 s55, s55, 3
    s_andn2_b32 s49, s58, 3
    s_or_b32 s55, s55, s49
    s_lshl_b32 s56, s55, 17
    s_add_u32 s56, s56, s69
    s_add_u32 m0, s53, s60
    s_nop 0
    buffer_load_dwordx4 v25, s[40:43], s56 offen offset:0 lds
    buffer_load_dwordx4 v26, s[40:43], s56 offen offset:1024 lds
    buffer_load_dwordx4 v27, s[40:43], s56 offen offset:2048 lds
    buffer_load_dwordx4 v28, s[40:43], s56 offen offset:3072 lds
    s_add_u32 s58, s58, 1
    s_add_u32 s60, s60, 8192
    s_cmp_eq_u32 s60, 24576
    s_cselect_b32 s60, 49152, s60
    s_cmp_eq_u32 s60, 57344
    s_cselect_b32 s60, 0, s60
    s_waitcnt vmcnt(12)
    s_barrier
    s_add_u32 s55, s58, s31
    s_and_b32 s55, s55, 3
    s_andn2_b32 s49, s58, 3
    s_or_b32 s55, s55, s49
    s_lshl_b32 s56, s55, 17
    s_add_u32 s56, s56, s69
    s_add_u32 m0, s53, s60
    s_nop 0
    buffer_load_dwordx4 v25, s[40:43], s56 offen offset:0 lds
    buffer_load_dwordx4 v26, s[40:43], s56 offen offset:1024 lds
    buffer_load_dwordx4 v27, s[40:43], s56 offen offset:2048 lds
    buffer_load_dwordx4 v28, s[40:43], s56 offen offset:3072 lds
    s_add_u32 s58, s58, 1
    s_add_u32 s60, s60, 8192
    s_cmp_eq_u32 s60, 24576
    s_cselect_b32 s60, 49152, s60
    s_cmp_eq_u32 s60, 57344
    s_cselect_b32 s60, 0, s60
    s_waitcnt vmcnt(8)
    s_barrier
    buffer_load_dword v17, v19, s[44:47], 0 offen sc1
    s_add_u32 s55, s58, s31
    s_and_b32 s55, s55, 3
    s_andn2_b32 s49, s58, 3
    s_or_b32 s55, s55, s49
    s_lshl_b32 s56, s55, 17
    s_add_u32 s56, s56, s69
    s_add_u32 m0, s53, s60
    s_nop 0
    buffer_load_dwordx4 v25, s[40:43], s56 offen offset:0 lds
    buffer_load_dwordx4 v26, s[40:43], s56 offen offset:1024 lds
    buffer_load_dwordx4 v27, s[40:43], s56 offen offset:2048 lds
    buffer_load_dwordx4 v28, s[40:43], s56 offen offset:3072 lds
    s_add_u32 s58, s58, 1
    s_add_u32 s60, s60, 8192
    s_cmp_eq_u32 s60, 24576
    s_cselect_b32 s60, 49152, s60
    s_cmp_eq_u32 s60, 57344
    s_cselect_b32 s60, 0, s60
    s_barrier
    s_waitcnt vmcnt(4)
    s_mov_b32 s72, 65536
ldo1_poll:
    v_cmp_ne_u32 vcc, v20, v17
    s_nop 0
    s_and_b32 s49, vcc_lo, vcc_hi
    s_andn2_b32 s49, s67, s49
    s_cmp_eq_u32 s49, 0
    s_cbranch_scc1 ldo1_polled
    s_sleep 1
    buffer_load_dword v17, v19, s[44:47], 0 offen sc1
    s_sub_u32 s72, s72, 1
    s_cmp_lg_u32 s72, 0
    s_waitcnt vmcnt(0)
    s_cbranch_scc1 ldo1_poll
ldo1_polled:
    s_add_u32 s55, s57, s31
    s_and_b32 s55, s55, 3
    s_andn2_b32 s49, s57, 3
    s_or_b32 s55, s55, s49
    s_lshl_b32 s56, s55, 12
    s_add_u32 s56, s56, s70
    s_add_u32 m0, s52, s59
    s_nop 0
    buffer_load_dwordx4 v15, s[44:47], s56 offen offset:0 sc1 lds
    buffer_load_dwordx4 v15, s[44:47], s56 offen offset:1024 sc1 lds
    buffer_load_dwordx4 v15, s[44:47], s56 offen offset:2048 sc1 lds
    buffer_load_dwordx4 v15, s[44:47], s56 offen offset:3072 sc1 lds
    s_add_u32 s57, s57, 1
    s_add_u32 s59, s59, 8192
    s_cmp_eq_u32 s59, 24576
    s_cselect_b32 s59, 106496, s59
    s_cmp_eq_u32 s59, 114688
    s_cselect_b32 s59, 0, s59
    s_add_u32 s55, s57, s31
    s_and_b32 s55, s55, 3
    s_andn2_b32 s49, s57, 3
    s_or_b32 s55, s55, s49
    s_lshl_b32 s56, s55, 12
    s_add_u32 s56, s56, s70
    s_add_u32 m0, s52, s59
    s_nop 0
    buffer_load_dwordx4 v15, s[44:47], s56 offen offset:0 sc1 lds
    buffer_load_dwordx4 v15, s[44:47], s56 offen offset:1024 sc1 lds
    buffer_load_dwordx4 v15, s[44:47], s56 offen offset:2048 sc1 lds
    buffer_load_dwordx4 v15, s[44:47], s56 offen offset:3072 sc1 lds
    s_add_u32 s57, s57, 1
    s_add_u32 s59, s59, 8192
    s_cmp_eq_u32 s59, 24576
    s_cselect_b32 s59, 106496, s59
    s_cmp_eq_u32 s59, 114688
    s_cselect_b32 s59, 0, s59
    s_add_u32 s55, s57, s31
    s_and_b32 s55, s55, 3
    s_andn2_b32 s49, s57, 3
    s_or_b32 s55, s55, s49
    s_lshl_b32 s56, s55, 12
    s_add_u32 s56, s56, s70
    s_add_u32 m0, s52, s59
    s_nop 0
    buffer_load_dwordx4 v15, s[44:47], s56 offen offset:0 sc1 lds
    buffer_load_dwordx4 v15, s[44:47], s56 offen offset:1024 sc1 lds
    buffer_load_dwordx4 v15, s[44:47], s56 offen offset:2048 sc1 lds
    buffer_load_dwordx4 v15, s[44:47], s56 offen offset:3072 sc1 lds
    s_add_u32 s57, s57, 1
    s_add_u32 s59, s59, 8192
    s_cmp_eq_u32 s59, 24576
    s_cselect_b32 s59, 106496, s59
    s_cmp_eq_u32 s59, 114688
    s_cselect_b32 s59, 0, s59
    s_add_u32 s55, s58, s31
    s_and_b32 s55, s55, 3
    s_andn2_b32 s49, s58, 3
    s_or_b32 s55, s55, s49
    s_lshl_b32 s56, s55, 17
    s_add_u32 s56, s56, s69
    s_add_u32 m0, s53, s60
    s_nop 0
    buffer_load_dwordx4 v25, s[40:43], s56 offen offset:0 lds
    buffer_load_dwordx4 v26, s[40:43], s56 offen offset:1024 lds
    buffer_load_dwordx4 v27, s[40:43], s56 offen offset:2048 lds
    buffer_load_dwordx4 v28, s[40:43], s56 offen offset:3072 lds
    s_add_u32 s58, s58, 1
    s_add_u32 s60, s60, 8192
    s_cmp_eq_u32 s60, 24576
    s_cselect_b32 s60, 49152, s60
    s_cmp_eq_u32 s60, 57344
    s_cselect_b32 s60, 0, s60
    s_waitcnt vmcnt(12)
    s_barrier
    s_add_u32 s55, s57, s31
    s_and_b32 s55, s55, 3
    s_andn2_b32 s49, s57, 3
    s_or_b32 s55, s55, s49
    s_lshl_b32 s56, s55, 12
    s_add_u32 s56, s56, s70
    s_add_u32 m0, s52, s59
    s_nop 0
    buffer_load_dwordx4 v15, s[44:47], s56 offen offset:0 sc1 lds
    buffer_load_dwordx4 v15, s[44:47], s56 offen offset:1024 sc1 lds
    buffer_load_dwordx4 v15, s[44:47], s56 offen offset:2048 sc1 lds
    buffer_load_dwordx4 v15, s[44:47], s56 offen offset:3072 sc1 lds
    s_add_u32 s57, s57, 1
    s_add_u32 s59, s59, 8192
    s_cmp_eq_u32 s59, 24576
    s_cselect_b32 s59, 106496, s59
    s_cmp_eq_u32 s59, 114688
    s_cselect_b32 s59, 0, s59
    s_and_b32 s67, s66, s68
    s_cselect_b32 s67, s67, s68
    s_ff1_i32_b32 s49, s67
    s_bitset0_b32 s68, s49
    s_lshl_b32 s67, 255, s49
    s_lshr_b32 s57, s49, 1
    s_mov_b32 s58, s57
    s_mov_b32 s72, 65536
ldo2_poll:
    v_cmp_ne_u32 vcc, v20, v17
    s_nop 0
    s_and_b32 s49, vcc_lo, vcc_hi
    s_andn2_b32 s49, s67, s49
    s_cmp_eq_u32 s49, 0
    s_cbranch_scc1 ldo2_polled
    s_sleep 1
    buffer_load_dword v17, v19, s[44:47], 0 offen sc1
    s_sub_u32 s72, s72, 1
    s_cmp_lg_u32 s72, 0
    s_waitcnt vmcnt(0)
    s_cbranch_scc1 ldo2_poll
ldo2_polled:
    s_waitcnt vmcnt(12)
    s_barrier
    s_add_u32 s55, s57, s31
    s_and_b32 s55, s55, 3
    s_andn2_b32 s49, s57, 3
    s_or_b32 s55, s55, s49
    s_lshl_b32 s56, s55, 12
    s_add_u32 s56, s56, s70
    s_add_u32 m0, s52, s59
    s_nop 0
    buffer_load_dwordx4 v15, s[44:47], s56 offen offset:0 sc1 lds
    buffer_load_dwordx4 v15, s[44:47], s56 offen offset:1024 sc1 lds
    buffer_load_dwordx4 v15, s[44:47], s56 offen offset:2048 sc1 lds
    buffer_load_dwordx4 v15, s[44:47], s56 offen offset:3072 sc1 lds
    s_add_u32 s57, s57, 1
    s_add_u32 s59, s59, 8192
    s_cmp_eq_u32 s59, 24576
    s_cselect_b32 s59, 106496, s59
    s_cmp_eq_u32 s59, 114688
    s_cselect_b32 s59, 0, s59
    s_add_u32 s55, s58, s31
    s_and_b32 s55, s55, 3
    s_andn2_b32 s49, s58, 3
    s_or_b32 s55, s55, s49
    s_lshl_b32 s56, s55, 17
    s_add_u32 s56, s56, s69
    s_add_u32 m0, s53, s60
    s_nop 0
    buffer_load_dwordx4 v25, s[40:43], s56 offen offset:0 lds
    buffer_load_dwordx4 v26, s[40:43], s56 offen offset:1024 lds
    buffer_load_dwordx4 v27, s[40:43], s56 offen offset:2048 lds
    buffer_load_dwordx4 v28, s[40:43], s56 offen offset:3072 lds
    s_add_u32 s58, s58, 1
    s_add_u32 s60, s60, 8192
    s_cmp_eq_u32 s60, 24576
    s_cselect_b32 s60, 49152, s60
    s_cmp_eq_u32 s60, 57344
    s_cselect_b32 s60, 0, s60
    s_waitcnt vmcnt(16)
    s_barrier
    buffer_load_dword v17, v19, s[44:47], 0 offen sc1
    s_add_u32 s55, s57, s31
    s_and_b32 s55, s55, 3
    s_andn2_b32 s49, s57, 3
    s_or_b32 s55, s55, s49
    s_lshl_b32 s56, s55, 12
    s_add_u32 s56, s56, s70
    s_add_u32 m0, s52, s59
    s_nop 0
    buffer_load_dwordx4 v15, s[44:47], s56 offen offset:0 sc1 lds
    buffer_load_dwordx4 v15, s[44:47], s56 offen offset:1024 sc1 lds
    buffer_load_dwordx4 v15, s[44:47], s56 offen offset:2048 sc1 lds
    buffer_load_dwordx4 v15, s[44:47], s56 offen offset:3072 sc1 lds
    s_add_u32 s57, s57, 1
    s_add_u32 s59, s59, 8192
    s_cmp_eq_u32 s59, 24576
    s_cselect_b32 s59, 106496, s59
    s_cmp_eq_u32 s59, 114688
    s_cselect_b32 s59, 0, s59
    s_add_u32 s55, s58, s31
    s_and_b32 s55, s55, 3
    s_andn2_b32 s49, s58, 3
    s_or_b32 s55, s55, s49
    s_lshl_b32 s56, s55, 17
    s_add_u32 s56, s56, s69
    s_add_u32 m0, s53, s60
    s_nop 0
    buffer_load_dwordx4 v25, s[40:43], s56 offen offset:0 lds
    buffer_load_dwordx4 v26, s[40:43], s56 offen offset:1024 lds
    buffer_load_dwordx4 v27, s[40:43], s56 offen offset:2048 lds
    buffer_load_dwordx4 v28, s[40:43], s56 offen offset:3072 lds
    s_add_u32 s58, s58, 1
    s_add_u32 s60, s60, 8192
    s_cmp_eq_u32 s60, 24576
    s_cselect_b32 s60, 49152, s60
    s_cmp_eq_u32 s60, 57344
    s_cselect_b32 s60, 0, s60
    s_waitcnt vmcnt(17)
    s_barrier
    s_add_u32 s55, s57, s31
    s_and_b32 s55, s55, 3
    s_andn2_b32 s49, s57, 3
    s_or_b32 s55, s55, s49
    s_lshl_b32 s56, s55, 12
    s_add_u32 s56, s56, s70
    s_add_u32 m0, s52, s59
    s_nop 0
    buffer_load_dwordx4 v15, s[44:47], s56 offen offset:0 sc1 lds
    buffer_load_dwordx4 v15, s[44:47], s56 offen offset:1024 sc1 lds
    buffer_load_dwordx4 v15, s[44:47], s56 offen offset:2048 sc1 lds
    buffer_load_dwordx4 v15, s[44:47], s56 offen offset:3072 sc1 lds
    s_add_u32 s57, s57, 1
    s_add_u32 s59, s59, 8192
    s_cmp_eq_u32 s59, 24576
    s_cselect_b32 s59, 106496, s59
    s_cmp_eq_u32 s59, 114688
    s_cselect_b32 s59, 0, s59
    s_add_u32 s55, s58, s31
    s_and_b32 s55, s55, 3
    s_andn2_b32 s49, s58, 3
    s_or_b32 s55, s55, s49
    s_lshl_b32 s56, s55, 17
    s_add_u32 s56, s56, s69
    s_add_u32 m0, s53, s60
    s_nop 0
    buffer_load_dwordx4 v25, s[40:43], s56 offen offset:0 lds
    buffer_load_dwordx4 v26, s[40:43], s56 offen offset:1024 lds
    buffer_load_dwordx4 v27, s[40:43], s56 offen offset:2048 lds
    buffer_load_dwordx4 v28, s[40:43], s56 offen offset:3072 lds
    s_add_u32 s58, s58, 1
    s_add_u32 s60, s60, 8192
    s_cmp_eq_u32 s60, 24576
    s_cselect_b32 s60, 49152, s60
    s_cmp_eq_u32 s60, 57344
    s_cselect_b32 s60, 0, s60
    s_waitcnt vmcnt(17)
    s_barrier
    s_add_u32 s55, s57, s31
    s_and_b32 s55, s55, 3
    s_andn2_b32 s49, s57, 3
    s_or_b32 s55, s55, s49
    s_lshl_b32 s56, s55, 12
    s_add_u32 s56, s56, s70
    s_add_u32 m0, s52, s59
    s_nop 0
    buffer_load_dwordx4 v15, s[44:47], s56 offen offset:0 sc1 lds
    buffer_load_dwordx4 v15, s[44:47], s56 offen offset:1024 sc1 lds
    buffer_load_dwordx4 v15, s[44:47], s56 offen offset:2048 sc1 lds
    buffer_load_dwordx4 v15, s[44:47], s56 offen offset:3072 sc1 lds
    s_add_u32 s57, s57, 1
    s_add_u32 s59, s59, 8192
    s_cmp_eq_u32 s59, 24576
    s_cselect_b32 s59, 106496, s59
    s_cmp_eq_u32 s59, 114688
    s_cselect_b32 s59, 0, s59
    s_add_u32 s55, s58, s31
    s_and_b32 s55, s55, 3
    s_andn2_b32 s49, s58, 3
    s_or_b32 s55, s55, s49
    s_lshl_b32 s56, s55, 17
    s_add_u32 s56, s56, s69
    s_add_u32 m0, s53, s60
    s_nop 0
    buffer_load_dwordx4 v25, s[40:43], s56 offen offset:0 lds
    buffer_load_dwordx4 v26, s[40:43], s56 offen offset:1024 lds
    buffer_load_dwordx4 v27, s[40:43], s56 offen offset:2048 lds
    buffer_load_dwordx4 v28, s[40:43], s56 offen offset:3072 lds
    s_add_u32 s58, s58, 1
    s_add_u32 s60, s60, 8192
    s_cmp_eq_u32 s60, 24576
    s_cselect_b32 s60, 49152, s60
    s_cmp_eq_u32 s60, 57344
    s_cselect_b32 s60, 0, s60
    s_and_b32 s67, s66, s68
    s_cselect_b32 s67, s67, s68
    s_ff1_i32_b32 s49, s67
    s_bitset0_b32 s68, s49
    s_lshl_b32 s67, 255, s49
    s_lshr_b32 s57, s49, 1
    s_mov_b32 s58, s57
    s_waitcnt vmcnt(24)
    s_mov_b32 s72, 65536
ldo3_poll:
    v_cmp_ne_u32 vcc, v20, v17
    s_nop 0
    s_and_b32 s49, vcc_lo, vcc_hi
    s_andn2_b32 s49, s67, s49
    s_cmp_eq_u32 s49, 0
    s_cbranch_scc1 ldo3_polled
    s_sleep 1
    buffer_load_dword v17, v19, s[44:47], 0 offen sc1
    s_sub_u32 s72, s72, 1
    s_cmp_lg_u32 s72, 0
    s_waitcnt vmcnt(0)
    s_cbranch_scc1 ldo3_poll
ldo3_polled:
    s_waitcnt vmcnt(16)
    s_barrier
    s_add_u32 s55, s57, s31
    s_and_b32 s55, s55, 3
    s_andn2_b32 s49, s57, 3
    s_or_b32 s55, s55, s49
    s_lshl_b32 s56, s55, 12
    s_add_u32 s56, s56, s70
    s_add_u32 m0, s52, s59
    s_nop 0
    buffer_load_dwordx4 v15, s[44:47], s56 offen offset:0 sc1 lds
    buffer_load_dwordx4 v15, s[44:47], s56 offen offset:1024 sc1 lds
    buffer_load_dwordx4 v15, s[44:47], s56 offen offset:2048 sc1 lds
    buffer_load_dwordx4 v15, s[44:47], s56 offen offset:3072 sc1 lds
    s_add_u32 s57, s57, 1
    s_add_u32 s59, s59, 8192
    s_cmp_eq_u32 s59, 24576
    s_cselect_b32 s59, 106496, s59
    s_cmp_eq_u32 s59, 114688
    s_cselect_b32 s59, 0, s59
    s_add_u32 s55, s58, s31
    s_and_b32 s55, s55, 3
    s_andn2_b32 s49, s58, 3
    s_or_b32 s55, s55, s49
    s_lshl_b32 s56, s55, 17
    s_add_u32 s56, s56, s69
    s_add_u32 m0, s53, s60
    s_nop 0
    buffer_load_dwordx4 v25, s[40:43], s56 offen offset:0 lds
    buffer_load_dwordx4 v26, s[40:43], s56 offen offset:1024 lds
    buffer_load_dwordx4 v27, s[40:43], s56 offen offset:2048 lds
    buffer_load_dwordx4 v28, s[40:43], s56 offen offset:3072 lds
    s_add_u32 s58, s58, 1
    s_add_u32 s60, s60, 8192
    s_cmp_eq_u32 s60, 24576
    s_cselect_b32 s60, 49152, s60
    s_cmp_eq_u32 s60, 57344
    s_cselect_b32 s60, 0, s60
    s_waitcnt vmcnt(16)
    s_barrier
    buffer_load_dword v17, v19, s[44:47], 0 offen sc1
    s_add_u32 s55, s57, s31
    s_and_b32 s55, s55, 3
    s_andn2_b32 s49, s57, 3
    s_or_b32 s55, s55, s49
    s_lshl_b32 s56, s55, 12
    s_add_u32 s56, s56, s70
    s_add_u32 m0, s52, s59
    s_nop 0
    buffer_load_dwordx4 v15, s[44:47], s56 offen offset:0 sc1 lds
    buffer_load_dwordx4 v15, s[44:47], s56 offen offset:1024 sc1 lds
    buffer_load_dwordx4 v15, s[44:47], s56 offen offset:2048 sc1 lds
    buffer_load_dwordx4 v15, s[44:47], s56 offen offset:3072 sc1 lds
    s_add_u32 s57, s57, 1
    s_add_u32 s59, s59, 8192
    s_cmp_eq_u32 s59, 24576
    s_cselect_b32 s59, 106496, s59
    s_cmp_eq_u32 s59, 114688
    s_cselect_b32 s59, 0, s59
    s_add_u32 s55, s58, s31
    s_and_b32 s55, s55, 3
    s_andn2_b32 s49, s58, 3
    s_or_b32 s55, s55, s49
    s_lshl_b32 s56, s55, 17
    s_add_u32 s56, s56, s69
    s_add_u32 m0, s53, s60
    s_nop 0
    buffer_load_dwordx4 v25, s[40:43], s56 offen offset:0 lds
    buffer_load_dwordx4 v26, s[40:43], s56 offen offset:1024 lds
    buffer_load_dwordx4 v27, s[40:43], s56 offen offset:2048 lds
    buffer_load_dwordx4 v28, s[40:43], s56 offen offset:3072 lds
    s_add_u32 s58, s58, 1
    s_add_u32 s60, s60, 8192
    s_cmp_eq_u32 s60, 24576
    s_cselect_b32 s60, 49152, s60
    s_cmp_eq_u32 s60, 57344
    s_cselect_b32 s60, 0, s60
    s_waitcnt vmcnt(17)
    s_barrier
    s_add_u32 s55, s57, s31
    s_and_b32 s55, s55, 3
    s_andn2_b32 s49, s57, 3
    s_or_b32 s55, s55, s49
    s_lshl_b32 s56, s55, 12
    s_add_u32 s56, s56, s70
    s_add_u32 m0, s52, s59
    s_nop 0
    buffer_load_dwordx4 v15, s[44:47], s56 offen offset:0 sc1 lds
    buffer_load_dwordx4 v15, s[44:47], s56 offen offset:1024 sc1 lds
    buffer_load_dwordx4 v15, s[44:47], s56 offen offset:2048 sc1 lds
    buffer_load_dwordx4 v15, s[44:47], s56 offen offset:3072 sc1 lds
    s_add_u32 s57, s57, 1
    s_add_u32 s59, s59, 8192
    s_cmp_eq_u32 s59, 24576
    s_cselect_b32 s59, 106496, s59
    s_cmp_eq_u32 s59, 114688
    s_cselect_b32 s59, 0, s59
    s_add_u32 s55, s58, s31
    s_and_b32 s55, s55, 3
    s_andn2_b32 s49, s58, 3
    s_or_b32 s55, s55, s49
    s_lshl_b32 s56, s55, 17
    s_add_u32 s56, s56, s69
    s_add_u32 m0, s53, s60
    s_nop 0
    buffer_load_dwordx4 v25, s[40:43], s56 offen offset:0 lds
    buffer_load_dwordx4 v26, s[40:43], s56 offen offset:1024 lds
    buffer_load_dwordx4 v27, s[40:43], s56 offen offset:2048 lds
    buffer_load_dwordx4 v28, s[40:43], s56 offen offset:3072 lds
    s_add_u32 s58, s58, 1
    s_add_u32 s60, s60, 8192
    s_cmp_eq_u32 s60, 24576
    s_cselect_b32 s60, 49152, s60
    s_cmp_eq_u32 s60, 57344
    s_cselect_b32 s60, 0, s60
    s_waitcnt vmcnt(17)
    s_barrier
    s_add_u32 s55, s57, s31
    s_and_b32 s55, s55, 3
    s_andn2_b32 s49, s57, 3
    s_or_b32 s55, s55, s49
    s_lshl_b32 s56, s55, 12
    s_add_u32 s56, s56, s70
    s_add_u32 m0, s52, s59
    s_nop 0
    buffer_load_dwordx4 v15, s[44:47], s56 offen offset:0 sc1 lds
    buffer_load_dwordx4 v15, s[44:47], s56 offen offset:1024 sc1 lds
    buffer_load_dwordx4 v15, s[44:47], s56 offen offset:2048 sc1 lds
    buffer_load_dwordx4 v15, s[44:47], s56 offen offset:3072 sc1 lds
    s_add_u32 s57, s57, 1
    s_add_u32 s59, s59, 8192
    s_cmp_eq_u32 s59, 24576
    s_cselect_b32 s59, 106496, s59
    s_cmp_eq_u32 s59, 114688
    s_cselect_b32 s59, 0, s59
    s_add_u32 s55, s58, s31
    s_and_b32 s55, s55, 3
    s_andn2_b32 s49, s58, 3
    s_or_b32 s55, s55, s49
    s_lshl_b32 s56, s55, 17
    s_add_u32 s56, s56, s69
    s_add_u32 m0, s53, s60
    s_nop 0
    buffer_load_dwordx4 v25, s[40:43], s56 offen offset:0 lds
    buffer_load_dwordx4 v26, s[40:43], s56 offen offset:1024 lds
    buffer_load_dwordx4 v27, s[40:43], s56 offen offset:2048 lds
    buffer_load_dwordx4 v28, s[40:43], s56 offen offset:3072 lds
    s_add_u32 s58, s58, 1
    s_add_u32 s60, s60, 8192
    s_cmp_eq_u32 s60, 24576
    s_cselect_b32 s60, 49152, s60
    s_cmp_eq_u32 s60, 57344
    s_cselect_b32 s60, 0, s60
    s_and_b32 s67, s66, s68
    s_cselect_b32 s67, s67, s68
    s_ff1_i32_b32 s49, s67
    s_bitset0_b32 s68, s49
    s_lshl_b32 s67, 255, s49
    s_lshr_b32 s57, s49, 1
    s_mov_b32 s58, s57
    s_waitcnt vmcnt(24)
    s_mov_b32 s72, 65536
ldo4_poll:
    v_cmp_ne_u32 vcc, v20, v17
    s_nop 0
    s_and_b32 s49, vcc_lo, vcc_hi
    s_andn2_b32 s49, s67, s49
    s_cmp_eq_u32 s49, 0
    s_cbranch_scc1 ldo4_polled
    s_sleep 1
    buffer_load_dword v17, v19, s[44:47], 0 offen sc1
    s_sub_u32 s72, s72, 1
    s_cmp_lg_u32 s72, 0
    s_waitcnt vmcnt(0)
    s_cbranch_scc1 ldo4_poll
ldo4_polled:
    s_mov_b32 s71, 3
ldb_loop2:
    s_waitcnt vmcnt(16)
    s_barrier
    s_add_u32 s55, s57, s31
    s_and_b32 s55, s55, 3
    s_andn2_b32 s49, s57, 3
    s_or_b32 s55, s55, s49
    s_lshl_b32 s56, s55, 12
    s_add_u32 s56, s56, s70
    s_add_u32 m0, s52, s59
    s_nop 0
    buffer_load_dwordx4 v15, s[44:47], s56 offen offset:0 sc1 lds
    buffer_load_dwordx4 v15, s[44:47], s56 offen offset:1024 sc1 lds
    buffer_load_dwordx4 v15, s[44:47], s56 offen offset:2048 sc1 lds
    buffer_load_dwordx4 v15, s[44:47], s56 offen offset:3072 sc1 lds
    s_add_u32 s57, s57, 1
    s_add_u32 s59, s59, 8192
    s_cmp_eq_u32 s59, 24576
    s_cselect_b32 s59, 106496, s59
    s_cmp_eq_u32 s59, 114688
    s_cselect_b32 s59, 0, s59
    s_add_u32 s55, s58, s31
    s_and_b32 s55, s55, 3
    s_andn2_b32 s49, s58, 3
    s_or_b32 s55, s55, s49
    s_lshl_b32 s56, s55, 17
    s_add_u32 s56, s56, s69
    s_add_u32 m0, s53, s60
    s_nop 0
    buffer_load_dwordx4 v25, s[40:43], s56 offen offset:0 lds
    buffer_load_dwordx4 v26, s[40:43], s56 offen offset:1024 lds
    buffer_load_dwordx4 v27, s[40:43], s56 offen offset:2048 lds
    buffer_load_dwordx4 v28, s[40:43], s56 offen offset:3072 lds
    s_add_u32 s58, s58, 1
    s_add_u32 s60, s60, 8192
    s_cmp_eq_u32 s60, 24576
    s_cselect_b32 s60, 49152, s60
    s_cmp_eq_u32 s60, 57344
    s_cselect_b32 s60, 0, s60
    s_sub_u32 s71, s71, 1
    s_cbranch_scc0 ldb_loop2
    s_waitcnt vmcnt(16)
    s_barrier
    s_waitcnt vmcnt(8)
    s_barrier
    s_waitcnt vmcnt(0)
    s_barrier
ld_end:
    s_endpgm
f_kernel_comp:
    s_cmp_ge_u32 s3, 4
    s_cbranch_scc1 f_kernel_g3
    s_setprio 2
    s_and_b32 s42, s3, 1
    s_mul_i32 s45, s42, 24576
    v_and_b32 v152, 15, v0
    v_bfe_u32 v153, v0, 1, 3
    v_lshlrev_b32 v152, 7, v152
    v_add_u32 v152, s45, v152
    v_lshrrev_b32 v154, 4, v0
    v_xor_b32 v153, v153, v154
    v_lshl_add_u32 v1, v153, 4, v152
    v_xor_b32 v2, 64, v1
    s_lshr_b32 s40, s3, 1
    s_mov_b32 s45, 49152
    v_bfe_u32 v152, v0, 1, 1
    v_bfe_u32 v153, v0, 4, 1
    v_lshl_or_b32 v152, v153, 1, v152
    v_bfe_u32 v153, v0, 3, 1
    v_lshl_or_b32 v152, v153, 2, v152
    s_lshl_b32 s43, s40, 2
    v_xor_b32 v152, s43, v152
    v_lshlrev_b32 v152, 4, v152
    v_bfe_u32 v153, v0, 2, 2
    v_lshl_add_u32 v152, v153, 7, v152
    v_and_b32 v153, 1, v0
    v_lshl_add_u32 v152, v153, 3, v152
    v_lshrrev_b32 v153, 4, v0
    v_lshl_add_u32 v152, v153, 10, v152
    v_add_u32 v3, s45, v152
    v_xor_b32 v4, 32, v3
    v_add_u32 v5, 49152, v3
    v_add_u32 v6, 49152, v4
    s_lshl_b32 s41, s40, 15
    s_add_u32 s41, s41, 98304
    s_lshl_b32 s53, s42, 13
    s_sub_u32 s54, s53, 4096
    s_and_b32 s54, s54, 32767
    s_add_u32 s53, s53, s41
    s_add_u32 s54, s54, s41
    s_lshl1_add_u32 s40, s6, s40
    s_lshl1_add_u32 s42, s7, s42
    s_lshl_b32 s45, s40, 5
    s_add_u32 s45, s45, s42
    s_lshl_b32 s50, s45, 2
    s_add_u32 s50, s50, 29360128
    s_lshl_b32 s52, s42, 5
    s_add_u32 s52, s52, s40
    s_lshl_b32 s52, s52, 2
    s_add_u32 s52, s52, 29368320
    v_mov_b32 v152, s50
    v_writelane_b32 v152, s52, 33
    s_mov_b32 s38, 29380608
    s_mov_b32 s39, 0x00020000
    s_waitcnt lgkmcnt(0)
    s_mov_b64 s[36:37], s[26:27]
    buffer_load_dword v7, v152, s[36:39], 0 offen sc1
    s_lshl_b32 s48, s45, 13
    s_add_u32 s49, s48, 4096
    s_lshl_b32 s44, s40, 18
    s_mov_b32 s51, 0x3e8293ee
    v_mov_b32 v8, 0
    v_mov_b32 v9, 0
    v_mov_b32 v10, 0
    v_mov_b32 v11, 0
    v_mov_b32 v12, 0
    v_mov_b32 v13, 0
    v_mov_b32 v14, 0
    v_mov_b32 v15, 0
    v_mov_b32 v16, 0
    v_mov_b32 v17, 0
    v_mov_b32 v18, 0
    v_mov_b32 v19, 0
    v_mov_b32 v20, 0
    v_mov_b32 v21, 0
    v_mov_b32 v22, 0
    v_mov_b32 v23, 0
    v_mov_b32 v24, 0
    v_mov_b32 v25, 0
    v_mov_b32 v26, 0
    v_mov_b32 v27, 0
    v_mov_b32 v28, 0
    v_mov_b32 v29, 0
    v_mov_b32 v30, 0
    v_mov_b32 v31, 0
    v_mov_b32 v32, 0
    v_mov_b32 v33, 0
    v_mov_b32 v34, 0
    v_mov_b32 v35, 0
    v_mov_b32 v36, 0
    v_mov_b32 v37, 0
    v_mov_b32 v38, 0
    v_mov_b32 v39, 0
    v_mov_b32 v40, 0
    v_mov_b32 v41, 0
    v_mov_b32 v42, 0
    v_mov_b32 v43, 0
    v_mov_b32 v44, 0
    v_mov_b32 v45, 0
    v_mov_b32 v46, 0
    v_mov_b32 v47, 0
    v_mov_b32 v48, 0
    v_mov_b32 v49, 0
    v_mov_b32 v50, 0
    v_mov_b32 v51, 0
    v_mov_b32 v52, 0
    v_mov_b32 v53, 0
    v_mov_b32 v54, 0
    v_mov_b32 v55, 0
    v_mov_b32 v56, 0
    v_mov_b32 v57, 0
    v_mov_b32 v58, 0
    v_mov_b32 v59, 0
    v_mov_b32 v60, 0
    v_mov_b32 v61, 0
    v_mov_b32 v62, 0
    v_mov_b32 v63, 0
    v_mov_b32 v64, 0
    v_mov_b32 v65, 0
    v_mov_b32 v66, 0
    v_mov_b32 v67, 0
    v_mov_b32 v68, 0
    v_mov_b32 v69, 0
    v_mov_b32 v70, 0
    v_mov_b32 v71, 0
    v_mov_b32 v72, 0
    v_mov_b32 v73, 0
    v_mov_b32 v74, 0
    v_mov_b32 v75, 0
    v_mov_b32 v76, 0
    v_mov_b32 v77, 0
    v_mov_b32 v78, 0
    v_mov_b32 v79, 0
    v_mov_b32 v80, 0
    v_mov_b32 v81, 0
    v_mov_b32 v82, 0
    v_mov_b32 v83, 0
    v_mov_b32 v84, 0
    v_mov_b32 v85, 0
    v_mov_b32 v86, 0
    v_mov_b32 v87, 0
    v_mov_b32 v88, 0
    v_mov_b32 v89, 0
    v_mov_b32 v90, 0
    v_mov_b32 v91, 0
    v_mov_b32 v92, 0
    v_mov_b32 v93, 0
    v_mov_b32 v94, 0
    v_mov_b32 v95, 0
    v_mov_b32 v96, 0
    v_mov_b32 v97, 0
    v_mov_b32 v98, 0
    v_mov_b32 v99, 0
    v_mov_b32 v100, 0
    v_mov_b32 v101, 0
    v_mov_b32 v102, 0
    v_mov_b32 v103, 0
    s_mov_b32 s47, 4
    s_barrier
    ds_read_b128 v[152:155], v1 offset:8192
    ds_read_b64_tr_b16 v[104:105], v3 offset:8192
    ds_read_b64_tr_b16 v[106:107], v3 offset:8704
    ds_read_b64_tr_b16 v[108:109], v4 offset:8192
    ds_read_b64_tr_b16 v[110:111], v4 offset:8704
    ds_read_b64_tr_b16 v[112:113], v3 offset:32768
    ds_read_b64_tr_b16 v[114:115], v3 offset:33280
    ds_read_b64_tr_b16 v[116:117], v4 offset:32768
    ds_read_b64_tr_b16 v[118:119], v4 offset:33280
    ds_read_b64_tr_b16 v[120:121], v5 offset:8192
    ds_read_b64_tr_b16 v[122:123], v5 offset:8704
    ds_read_b64_tr_b16 v[124:125], v6 offset:8192
    ds_read_b64_tr_b16 v[126:127], v6 offset:8704
    ds_read_b128 v[156:159], v1 offset:10240
    ds_read_b128 v[160:163], v1 offset:12288
    s_waitcnt lgkmcnt(0)
p1_loop:
    ds_read_b128 v[164:167], v1 offset:14336
    s_waitcnt lgkmcnt(13)
    v_mfma_f32_16x16x32_bf16 v[8:11], v[104:107], v[152:155], v[8:11]
    s_waitcnt lgkmcnt(11)
    v_mfma_f32_16x16x32_bf16 v[12:15], v[108:111], v[152:155], v[12:15]
    ds_read_b64_tr_b16 v[128:129], v3 offset:12288
    s_waitcnt lgkmcnt(9)
    v_mfma_f32_16x16x32_bf16 v[40:43], v[112:115], v[152:155], v[40:43]
    ds_read_b64_tr_b16 v[130:131], v3 offset:12800
    s_waitcnt lgkmcnt(8)
    v_mfma_f32_16x16x32_bf16 v[44:47], v[116:119], v[152:155], v[44:47]
    ds_read_b64_tr_b16 v[132:133], v4 offset:12288
    s_waitcnt lgkmcnt(7)
    v_mfma_f32_16x16x32_bf16 v[72:75], v[152:155], v[120:123], v[72:75]
    s_waitcnt lgkmcnt(4)
    v_mfma_f32_16x16x32_bf16 v[80:83], v[152:155], v[124:127], v[80:83]
    ds_read_b128 v[152:155], v2 offset:8192
    ds_read_b64_tr_b16 v[134:135], v4 offset:12800
    v_mfma_f32_16x16x32_bf16 v[84:87], v[156:159], v[124:127], v[84:87]
    ds_read_b64_tr_b16 v[136:137], v3 offset:36864
    v_mfma_f32_16x16x32_bf16 v[76:79], v[156:159], v[120:123], v[76:79]
    ds_read_b64_tr_b16 v[138:139], v3 offset:37376
    v_mfma_f32_16x16x32_bf16 v[52:55], v[116:119], v[156:159], v[52:55]
    v_mfma_f32_16x16x32_bf16 v[48:51], v[112:115], v[156:159], v[48:51]
    ds_read_b64_tr_b16 v[140:141], v4 offset:36864
    v_mfma_f32_16x16x32_bf16 v[20:23], v[108:111], v[156:159], v[20:23]
    ds_read_b64_tr_b16 v[142:143], v4 offset:37376
    v_mfma_f32_16x16x32_bf16 v[16:19], v[104:107], v[156:159], v[16:19]
    ds_read_b128 v[156:159], v2 offset:10240
    ds_read_b64_tr_b16 v[144:145], v5 offset:12288
    v_mfma_f32_16x16x32_bf16 v[24:27], v[104:107], v[160:163], v[24:27]
    v_mfma_f32_16x16x32_bf16 v[28:31], v[108:111], v[160:163], v[28:31]
    ds_read_b64_tr_b16 v[146:147], v5 offset:12800
    v_mfma_f32_16x16x32_bf16 v[56:59], v[112:115], v[160:163], v[56:59]
    ds_read_b64_tr_b16 v[148:149], v6 offset:12288
    v_mfma_f32_16x16x32_bf16 v[60:63], v[116:119], v[160:163], v[60:63]
    ds_read_b64_tr_b16 v[150:151], v6 offset:12800
    v_mfma_f32_16x16x32_bf16 v[88:91], v[160:163], v[120:123], v[88:91]
    v_mfma_f32_16x16x32_bf16 v[96:99], v[160:163], v[124:127], v[96:99]
    ds_read_b128 v[160:163], v2 offset:12288
    s_waitcnt lgkmcnt(15)
    v_mfma_f32_16x16x32_bf16 v[100:103], v[164:167], v[124:127], v[100:103]
    v_mfma_f32_16x16x32_bf16 v[92:95], v[164:167], v[120:123], v[92:95]
    v_mfma_f32_16x16x32_bf16 v[68:71], v[116:119], v[164:167], v[68:71]
    v_mfma_f32_16x16x32_bf16 v[64:67], v[112:115], v[164:167], v[64:67]
    v_mfma_f32_16x16x32_bf16 v[36:39], v[108:111], v[164:167], v[36:39]
    v_mfma_f32_16x16x32_bf16 v[32:35], v[104:107], v[164:167], v[32:35]
    ds_read_b128 v[164:167], v2 offset:14336
    s_waitcnt lgkmcnt(12)
    v_mfma_f32_16x16x32_bf16 v[8:11], v[128:131], v[152:155], v[8:11]
    s_waitcnt lgkmcnt(11)
    v_mfma_f32_16x16x32_bf16 v[12:15], v[132:135], v[152:155], v[12:15]
    s_waitcnt lgkmcnt(9)
    v_mfma_f32_16x16x32_bf16 v[40:43], v[136:139], v[152:155], v[40:43]
    s_waitcnt lgkmcnt(7)
    v_mfma_f32_16x16x32_bf16 v[44:47], v[140:143], v[152:155], v[44:47]
    s_waitcnt lgkmcnt(4)
    v_mfma_f32_16x16x32_bf16 v[72:75], v[152:155], v[144:147], v[72:75]
    s_waitcnt lgkmcnt(2)
    v_mfma_f32_16x16x32_bf16 v[80:83], v[152:155], v[148:151], v[80:83]
    s_waitcnt lgkmcnt(0)
    s_barrier
    ds_read_b128 v[152:155], v1 offset:16384
    v_mfma_f32_16x16x32_bf16 v[84:87], v[156:159], v[148:151], v[84:87]
    ds_read_b64_tr_b16 v[104:105], v3 offset:16384
    v_mfma_f32_16x16x32_bf16 v[76:79], v[156:159], v[144:147], v[76:79]
    ds_read_b64_tr_b16 v[106:107], v3 offset:16896
    v_mfma_f32_16x16x32_bf16 v[52:55], v[140:143], v[156:159], v[52:55]
    ds_read_b64_tr_b16 v[108:109], v4 offset:16384
    v_mfma_f32_16x16x32_bf16 v[48:51], v[136:139], v[156:159], v[48:51]
    ds_read_b64_tr_b16 v[110:111], v4 offset:16896
    v_mfma_f32_16x16x32_bf16 v[20:23], v[132:135], v[156:159], v[20:23]
    ds_read_b64_tr_b16 v[112:113], v3 offset:40960
    v_mfma_f32_16x16x32_bf16 v[16:19], v[128:131], v[156:159], v[16:19]
    ds_read_b128 v[156:159], v1 offset:18432
    ds_read_b64_tr_b16 v[114:115], v3 offset:41472
    v_mfma_f32_16x16x32_bf16 v[24:27], v[128:131], v[160:163], v[24:27]
    ds_read_b64_tr_b16 v[116:117], v4 offset:40960
    v_mfma_f32_16x16x32_bf16 v[28:31], v[132:135], v[160:163], v[28:31]
    ds_read_b64_tr_b16 v[118:119], v4 offset:41472
    v_mfma_f32_16x16x32_bf16 v[56:59], v[136:139], v[160:163], v[56:59]
    ds_read_b64_tr_b16 v[120:121], v5 offset:16384
    v_mfma_f32_16x16x32_bf16 v[60:63], v[140:143], v[160:163], v[60:63]
    ds_read_b64_tr_b16 v[122:123], v5 offset:16896
    v_mfma_f32_16x16x32_bf16 v[88:91], v[160:163], v[144:147], v[88:91]
    ds_read_b64_tr_b16 v[124:125], v6 offset:16384
    v_mfma_f32_16x16x32_bf16 v[96:99], v[160:163], v[148:151], v[96:99]
    ds_read_b128 v[160:163], v1 offset:20480
    ds_read_b64_tr_b16 v[126:127], v6 offset:16896
    v_mfma_f32_16x16x32_bf16 v[100:103], v[164:167], v[148:151], v[100:103]
    v_mfma_f32_16x16x32_bf16 v[92:95], v[164:167], v[144:147], v[92:95]
    v_mfma_f32_16x16x32_bf16 v[68:71], v[140:143], v[164:167], v[68:71]
    v_mfma_f32_16x16x32_bf16 v[64:67], v[136:139], v[164:167], v[64:67]
    v_mfma_f32_16x16x32_bf16 v[36:39], v[132:135], v[164:167], v[36:39]
    v_mfma_f32_16x16x32_bf16 v[32:35], v[128:131], v[164:167], v[32:35]
    ds_read_b128 v[164:167], v1 offset:22528
    s_waitcnt lgkmcnt(13)
    v_mfma_f32_16x16x32_bf16 v[8:11], v[104:107], v[152:155], v[8:11]
    s_waitcnt lgkmcnt(11)
    v_mfma_f32_16x16x32_bf16 v[12:15], v[108:111], v[152:155], v[12:15]
    ds_read_b64_tr_b16 v[128:129], v3 offset:20480
    s_waitcnt lgkmcnt(9)
    v_mfma_f32_16x16x32_bf16 v[40:43], v[112:115], v[152:155], v[40:43]
    ds_read_b64_tr_b16 v[130:131], v3 offset:20992
    s_waitcnt lgkmcnt(8)
    v_mfma_f32_16x16x32_bf16 v[44:47], v[116:119], v[152:155], v[44:47]
    ds_read_b64_tr_b16 v[132:133], v4 offset:20480
    s_waitcnt lgkmcnt(7)
    v_mfma_f32_16x16x32_bf16 v[72:75], v[152:155], v[120:123], v[72:75]
    s_waitcnt lgkmcnt(4)
    v_mfma_f32_16x16x32_bf16 v[80:83], v[152:155], v[124:127], v[80:83]
    ds_read_b128 v[152:155], v2 offset:16384
    ds_read_b64_tr_b16 v[134:135], v4 offset:20992
    v_mfma_f32_16x16x32_bf16 v[84:87], v[156:159], v[124:127], v[84:87]
    ds_read_b64_tr_b16 v[136:137], v3 offset:45056
    v_mfma_f32_16x16x32_bf16 v[76:79], v[156:159], v[120:123], v[76:79]
    ds_read_b64_tr_b16 v[138:139], v3 offset:45568
    v_mfma_f32_16x16x32_bf16 v[52:55], v[116:119], v[156:159], v[52:55]
    v_mfma_f32_16x16x32_bf16 v[48:51], v[112:115], v[156:159], v[48:51]
    ds_read_b64_tr_b16 v[140:141], v4 offset:45056
    v_mfma_f32_16x16x32_bf16 v[20:23], v[108:111], v[156:159], v[20:23]
    ds_read_b64_tr_b16 v[142:143], v4 offset:45568
    v_mfma_f32_16x16x32_bf16 v[16:19], v[104:107], v[156:159], v[16:19]
    ds_read_b128 v[156:159], v2 offset:18432
    ds_read_b64_tr_b16 v[144:145], v5 offset:20480
    v_mfma_f32_16x16x32_bf16 v[24:27], v[104:107], v[160:163], v[24:27]
    v_mfma_f32_16x16x32_bf16 v[28:31], v[108:111], v[160:163], v[28:31]
    ds_read_b64_tr_b16 v[146:147], v5 offset:20992
    v_mfma_f32_16x16x32_bf16 v[56:59], v[112:115], v[160:163], v[56:59]
    ds_read_b64_tr_b16 v[148:149], v6 offset:20480
    v_mfma_f32_16x16x32_bf16 v[60:63], v[116:119], v[160:163], v[60:63]
    ds_read_b64_tr_b16 v[150:151], v6 offset:20992
    v_mfma_f32_16x16x32_bf16 v[88:91], v[160:163], v[120:123], v[88:91]
    v_mfma_f32_16x16x32_bf16 v[96:99], v[160:163], v[124:127], v[96:99]
    ds_read_b128 v[160:163], v2 offset:20480
    s_waitcnt lgkmcnt(15)
    v_mfma_f32_16x16x32_bf16 v[100:103], v[164:167], v[124:127], v[100:103]
    v_mfma_f32_16x16x32_bf16 v[92:95], v[164:167], v[120:123], v[92:95]
    v_mfma_f32_16x16x32_bf16 v[68:71], v[116:119], v[164:167], v[68:71]
    v_mfma_f32_16x16x32_bf16 v[64:67], v[112:115], v[164:167], v[64:67]
    v_mfma_f32_16x16x32_bf16 v[36:39], v[108:111], v[164:167], v[36:39]
    v_mfma_f32_16x16x32_bf16 v[32:35], v[104:107], v[164:167], v[32:35]
    ds_read_b128 v[164:167], v2 offset:22528
    s_waitcnt lgkmcnt(12)
    v_mfma_f32_16x16x32_bf16 v[8:11], v[128:131], v[152:155], v[8:11]
    s_waitcnt lgkmcnt(11)
    v_mfma_f32_16x16x32_bf16 v[12:15], v[132:135], v[152:155], v[12:15]
    s_waitcnt lgkmcnt(9)
    v_mfma_f32_16x16x32_bf16 v[40:43], v[136:139], v[152:155], v[40:43]
    s_waitcnt lgkmcnt(7)
    v_mfma_f32_16x16x32_bf16 v[44:47], v[140:143], v[152:155], v[44:47]
    s_waitcnt lgkmcnt(4)
    v_mfma_f32_16x16x32_bf16 v[72:75], v[152:155], v[144:147], v[72:75]
    s_waitcnt lgkmcnt(2)
    v_mfma_f32_16x16x32_bf16 v[80:83], v[152:155], v[148:151], v[80:83]
    s_waitcnt lgkmcnt(0)
    s_barrier
    ds_read_b128 v[152:155], v1 offset:0
    v_mfma_f32_16x16x32_bf16 v[84:87], v[156:159], v[148:151], v[84:87]
    ds_read_b64_tr_b16 v[104:105], v3 offset:0
    v_mfma_f32_16x16x32_bf16 v[76:79], v[156:159], v[144:147], v[76:79]
    ds_read_b64_tr_b16 v[106:107], v3 offset:512
    v_mfma_f32_16x16x32_bf16 v[52:55], v[140:143], v[156:159], v[52:55]
    ds_read_b64_tr_b16 v[108:109], v4 offset:0
    v_mfma_f32_16x16x32_bf16 v[48:51], v[136:139], v[156:159], v[48:51]
    ds_read_b64_tr_b16 v[110:111], v4 offset:512
    v_mfma_f32_16x16x32_bf16 v[20:23], v[132:135], v[156:159], v[20:23]
    ds_read_b64_tr_b16 v[112:113], v3 offset:24576
    v_mfma_f32_16x16x32_bf16 v[16:19], v[128:131], v[156:159], v[16:19]
    ds_read_b128 v[156:159], v1 offset:2048
    ds_read_b64_tr_b16 v[114:115], v3 offset:25088
    v_mfma_f32_16x16x32_bf16 v[24:27], v[128:131], v[160:163], v[24:27]
    ds_read_b64_tr_b16 v[116:117], v4 offset:24576
    v_mfma_f32_16x16x32_bf16 v[28:31], v[132:135], v[160:163], v[28:31]
    ds_read_b64_tr_b16 v[118:119], v4 offset:25088
    v_mfma_f32_16x16x32_bf16 v[56:59], v[136:139], v[160:163], v[56:59]
    ds_read_b64_tr_b16 v[120:121], v5 offset:0
    v_mfma_f32_16x16x32_bf16 v[60:63], v[140:143], v[160:163], v[60:63]
    ds_read_b64_tr_b16 v[122:123], v5 offset:512
    v_mfma_f32_16x16x32_bf16 v[88:91], v[160:163], v[144:147], v[88:91]
    ds_read_b64_tr_b16 v[124:125], v6 offset:0
    v_mfma_f32_16x16x32_bf16 v[96:99], v[160:163], v[148:151], v[96:99]
    ds_read_b128 v[160:163], v1 offset:4096
    ds_read_b64_tr_b16 v[126:127], v6 offset:512
    v_mfma_f32_16x16x32_bf16 v[100:103], v[164:167], v[148:151], v[100:103]
    v_mfma_f32_16x16x32_bf16 v[92:95], v[164:167], v[144:147], v[92:95]
    v_mfma_f32_16x16x32_bf16 v[68:71], v[140:143], v[164:167], v[68:71]
    v_mfma_f32_16x16x32_bf16 v[64:67], v[136:139], v[164:167], v[64:67]
    v_mfma_f32_16x16x32_bf16 v[36:39], v[132:135], v[164:167], v[36:39]
    v_mfma_f32_16x16x32_bf16 v[32:35], v[128:131], v[164:167], v[32:35]
    ds_read_b128 v[164:167], v1 offset:6144
    v_add_u32 v1, 122880, v1
    s_waitcnt lgkmcnt(13)
    v_mfma_f32_16x16x32_bf16 v[8:11], v[104:107], v[152:155], v[8:11]
    s_waitcnt lgkmcnt(11)
    v_mfma_f32_16x16x32_bf16 v[12:15], v[108:111], v[152:155], v[12:15]
    ds_read_b64_tr_b16 v[128:129], v3 offset:4096
    s_waitcnt lgkmcnt(9)
    v_mfma_f32_16x16x32_bf16 v[40:43], v[112:115], v[152:155], v[40:43]
    ds_read_b64_tr_b16 v[130:131], v3 offset:4608
    s_waitcnt lgkmcnt(8)
    v_mfma_f32_16x16x32_bf16 v[44:47], v[116:119], v[152:155], v[44:47]
    ds_read_b64_tr_b16 v[132:133], v4 offset:4096
    s_waitcnt lgkmcnt(7)
    v_mfma_f32_16x16x32_bf16 v[72:75], v[152:155], v[120:123], v[72:75]
    s_waitcnt lgkmcnt(4)
    v_mfma_f32_16x16x32_bf16 v[80:83], v[152:155], v[124:127], v[80:83]
    ds_read_b128 v[152:155], v2 offset:0
    ds_read_b64_tr_b16 v[134:135], v4 offset:4608
    v_mfma_f32_16x16x32_bf16 v[84:87], v[156:159], v[124:127], v[84:87]
    ds_read_b64_tr_b16 v[136:137], v3 offset:28672
    v_mfma_f32_16x16x32_bf16 v[76:79], v[156:159], v[120:123], v[76:79]
    ds_read_b64_tr_b16 v[138:139], v3 offset:29184
    v_mfma_f32_16x16x32_bf16 v[52:55], v[116:119], v[156:159], v[52:55]
    v_mfma_f32_16x16x32_bf16 v[48:51], v[112:115], v[156:159], v[48:51]
    ds_read_b64_tr_b16 v[140:141], v4 offset:28672
    v_mfma_f32_16x16x32_bf16 v[20:23], v[108:111], v[156:159], v[20:23]
    ds_read_b64_tr_b16 v[142:143], v4 offset:29184
    v_mfma_f32_16x16x32_bf16 v[16:19], v[104:107], v[156:159], v[16:19]
    ds_read_b128 v[156:159], v2 offset:2048
    ds_read_b64_tr_b16 v[144:145], v5 offset:4096
    v_mfma_f32_16x16x32_bf16 v[24:27], v[104:107], v[160:163], v[24:27]
    v_mfma_f32_16x16x32_bf16 v[28:31], v[108:111], v[160:163], v[28:31]
    ds_read_b64_tr_b16 v[146:147], v5 offset:4608
    v_mfma_f32_16x16x32_bf16 v[56:59], v[112:115], v[160:163], v[56:59]
    ds_read_b64_tr_b16 v[148:149], v6 offset:4096
    v_mfma_f32_16x16x32_bf16 v[60:63], v[116:119], v[160:163], v[60:63]
    ds_read_b64_tr_b16 v[150:151], v6 offset:4608
    v_mfma_f32_16x16x32_bf16 v[88:91], v[160:163], v[120:123], v[88:91]
    v_mfma_f32_16x16x32_bf16 v[96:99], v[160:163], v[124:127], v[96:99]
    ds_read_b128 v[160:163], v2 offset:4096
    s_waitcnt lgkmcnt(15)
    v_mfma_f32_16x16x32_bf16 v[100:103], v[164:167], v[124:127], v[100:103]
    v_mfma_f32_16x16x32_bf16 v[92:95], v[164:167], v[120:123], v[92:95]
    v_mfma_f32_16x16x32_bf16 v[68:71], v[116:119], v[164:167], v[68:71]
    v_mfma_f32_16x16x32_bf16 v[64:67], v[112:115], v[164:167], v[64:67]
    v_mfma_f32_16x16x32_bf16 v[36:39], v[108:111], v[164:167], v[36:39]
    v_mfma_f32_16x16x32_bf16 v[32:35], v[104:107], v[164:167], v[32:35]
    ds_read_b128 v[164:167], v2 offset:6144
    v_add_u32 v2, 122880, v2
    s_waitcnt lgkmcnt(12)
    v_mfma_f32_16x16x32_bf16 v[8:11], v[128:131], v[152:155], v[8:11]
    s_waitcnt lgkmcnt(11)
    v_mfma_f32_16x16x32_bf16 v[12:15], v[132:135], v[152:155], v[12:15]
    s_waitcnt lgkmcnt(9)
    v_mfma_f32_16x16x32_bf16 v[40:43], v[136:139], v[152:155], v[40:43]
    s_waitcnt lgkmcnt(7)
    v_mfma_f32_16x16x32_bf16 v[44:47], v[140:143], v[152:155], v[44:47]
    s_waitcnt lgkmcnt(4)
    v_mfma_f32_16x16x32_bf16 v[72:75], v[152:155], v[144:147], v[72:75]
    s_waitcnt lgkmcnt(2)
    v_mfma_f32_16x16x32_bf16 v[80:83], v[152:155], v[148:151], v[80:83]
    s_waitcnt lgkmcnt(0)
    s_waitcnt vmcnt(0)
    s_barrier
    ds_read_b128 v[152:155], v1 offset:0
    v_mfma_f32_16x16x32_bf16 v[84:87], v[156:159], v[148:151], v[84:87]
    ds_read_b64_tr_b16 v[104:105], v5 offset:32768
    v_mfma_f32_16x16x32_bf16 v[76:79], v[156:159], v[144:147], v[76:79]
    ds_read_b64_tr_b16 v[106:107], v5 offset:33280
    v_mfma_f32_16x16x32_bf16 v[52:55], v[140:143], v[156:159], v[52:55]
    ds_read_b64_tr_b16 v[108:109], v6 offset:32768
    v_mfma_f32_16x16x32_bf16 v[48:51], v[136:139], v[156:159], v[48:51]
    ds_read_b64_tr_b16 v[110:111], v6 offset:33280
    v_mfma_f32_16x16x32_bf16 v[20:23], v[132:135], v[156:159], v[20:23]
    ds_read_b64_tr_b16 v[112:113], v5 offset:57344
    v_mfma_f32_16x16x32_bf16 v[16:19], v[128:131], v[156:159], v[16:19]
    ds_read_b128 v[156:159], v1 offset:2048
    ds_read_b64_tr_b16 v[114:115], v5 offset:57856
    v_mfma_f32_16x16x32_bf16 v[24:27], v[128:131], v[160:163], v[24:27]
    ds_read_b64_tr_b16 v[116:117], v6 offset:57344
    v_mfma_f32_16x16x32_bf16 v[28:31], v[132:135], v[160:163], v[28:31]
    ds_read_b64_tr_b16 v[118:119], v6 offset:57856
    v_mfma_f32_16x16x32_bf16 v[56:59], v[136:139], v[160:163], v[56:59]
    ds_read_b64_tr_b16 v[120:121], v5 offset:40960
    v_mfma_f32_16x16x32_bf16 v[60:63], v[140:143], v[160:163], v[60:63]
    ds_read_b64_tr_b16 v[122:123], v5 offset:41472
    v_mfma_f32_16x16x32_bf16 v[88:91], v[160:163], v[144:147], v[88:91]
    ds_read_b64_tr_b16 v[124:125], v6 offset:40960
    v_mfma_f32_16x16x32_bf16 v[96:99], v[160:163], v[148:151], v[96:99]
    ds_read_b128 v[160:163], v1 offset:4096
    ds_read_b64_tr_b16 v[126:127], v6 offset:41472
    v_mfma_f32_16x16x32_bf16 v[100:103], v[164:167], v[148:151], v[100:103]
    v_mfma_f32_16x16x32_bf16 v[92:95], v[164:167], v[144:147], v[92:95]
    v_mfma_f32_16x16x32_bf16 v[68:71], v[140:143], v[164:167], v[68:71]
    v_mfma_f32_16x16x32_bf16 v[64:67], v[136:139], v[164:167], v[64:67]
    v_mfma_f32_16x16x32_bf16 v[36:39], v[132:135], v[164:167], v[36:39]
    v_mfma_f32_16x16x32_bf16 v[32:35], v[128:131], v[164:167], v[32:35]
    s_sub_u32 s47, s47, 1
    s_cmp_eq_u32 s47, 0
    ds_read_b128 v[164:167], v1 offset:6144
    v_subrev_u32 v1, 122880, v1
    s_waitcnt lgkmcnt(13)
    v_mfma_f32_16x16x32_bf16 v[8:11], v[104:107], v[152:155], v[8:11]
    s_waitcnt lgkmcnt(11)
    v_mfma_f32_16x16x32_bf16 v[12:15], v[108:111], v[152:155], v[12:15]
    ds_read_b64_tr_b16 v[128:129], v5 offset:36864
    s_waitcnt lgkmcnt(9)
    v_mfma_f32_16x16x32_bf16 v[40:43], v[112:115], v[152:155], v[40:43]
    ds_read_b64_tr_b16 v[130:131], v5 offset:37376
    s_waitcnt lgkmcnt(8)
    v_mfma_f32_16x16x32_bf16 v[44:47], v[116:119], v[152:155], v[44:47]
    ds_read_b64_tr_b16 v[132:133], v6 offset:36864
    s_waitcnt lgkmcnt(7)
    v_mfma_f32_16x16x32_bf16 v[72:75], v[152:155], v[120:123], v[72:75]
    s_waitcnt lgkmcnt(4)
    v_mfma_f32_16x16x32_bf16 v[80:83], v[152:155], v[124:127], v[80:83]
    ds_read_b128 v[152:155], v2 offset:0
    ds_read_b64_tr_b16 v[134:135], v6 offset:37376
    v_mfma_f32_16x16x32_bf16 v[84:87], v[156:159], v[124:127], v[84:87]
    ds_read_b64_tr_b16 v[136:137], v5 offset:61440
    v_mfma_f32_16x16x32_bf16 v[76:79], v[156:159], v[120:123], v[76:79]
    ds_read_b64_tr_b16 v[138:139], v5 offset:61952
    v_mfma_f32_16x16x32_bf16 v[52:55], v[116:119], v[156:159], v[52:55]
    v_mfma_f32_16x16x32_bf16 v[48:51], v[112:115], v[156:159], v[48:51]
    ds_read_b64_tr_b16 v[140:141], v6 offset:61440
    v_mfma_f32_16x16x32_bf16 v[20:23], v[108:111], v[156:159], v[20:23]
    ds_read_b64_tr_b16 v[142:143], v6 offset:61952
    v_mfma_f32_16x16x32_bf16 v[16:19], v[104:107], v[156:159], v[16:19]
    ds_read_b128 v[156:159], v2 offset:2048
    ds_read_b64_tr_b16 v[144:145], v5 offset:45056
    v_mfma_f32_16x16x32_bf16 v[24:27], v[104:107], v[160:163], v[24:27]
    v_mfma_f32_16x16x32_bf16 v[28:31], v[108:111], v[160:163], v[28:31]
    ds_read_b64_tr_b16 v[146:147], v5 offset:45568
    v_mfma_f32_16x16x32_bf16 v[56:59], v[112:115], v[160:163], v[56:59]
    ds_read_b64_tr_b16 v[148:149], v6 offset:45056
    v_mfma_f32_16x16x32_bf16 v[60:63], v[116:119], v[160:163], v[60:63]
    ds_read_b64_tr_b16 v[150:151], v6 offset:45568
    v_mfma_f32_16x16x32_bf16 v[88:91], v[160:163], v[120:123], v[88:91]
    v_mfma_f32_16x16x32_bf16 v[96:99], v[160:163], v[124:127], v[96:99]
    ds_read_b128 v[160:163], v2 offset:4096
    s_waitcnt lgkmcnt(15)
    v_mfma_f32_16x16x32_bf16 v[100:103], v[164:167], v[124:127], v[100:103]
    v_mfma_f32_16x16x32_bf16 v[92:95], v[164:167], v[120:123], v[92:95]
    v_mfma_f32_16x16x32_bf16 v[68:71], v[116:119], v[164:167], v[68:71]
    v_mfma_f32_16x16x32_bf16 v[64:67], v[112:115], v[164:167], v[64:67]
    v_mfma_f32_16x16x32_bf16 v[36:39], v[108:111], v[164:167], v[36:39]
    v_mfma_f32_16x16x32_bf16 v[32:35], v[104:107], v[164:167], v[32:35]
    s_cbranch_scc1 p1_last
    ds_read_b128 v[164:167], v2 offset:6144
    v_subrev_u32 v2, 122880, v2
    s_waitcnt lgkmcnt(12)
    v_mfma_f32_16x16x32_bf16 v[8:11], v[128:131], v[152:155], v[8:11]
    s_waitcnt lgkmcnt(11)
    v_mfma_f32_16x16x32_bf16 v[12:15], v[132:135], v[152:155], v[12:15]
    s_waitcnt lgkmcnt(9)
    v_mfma_f32_16x16x32_bf16 v[40:43], v[136:139], v[152:155], v[40:43]
    s_waitcnt lgkmcnt(7)
    v_mfma_f32_16x16x32_bf16 v[44:47], v[140:143], v[152:155], v[44:47]
    s_waitcnt lgkmcnt(4)
    v_mfma_f32_16x16x32_bf16 v[72:75], v[152:155], v[144:147], v[72:75]
    s_waitcnt lgkmcnt(2)
    v_mfma_f32_16x16x32_bf16 v[80:83], v[152:155], v[148:151], v[80:83]
    s_waitcnt lgkmcnt(0)
    s_barrier
    ds_read_b128 v[152:155], v1 offset:8192
    v_mfma_f32_16x16x32_bf16 v[84:87], v[156:159], v[148:151], v[84:87]
    ds_read_b64_tr_b16 v[104:105], v3 offset:8192
    v_mfma_f32_16x16x32_bf16 v[76:79], v[156:159], v[144:147], v[76:79]
    ds_read_b64_tr_b16 v[106:107], v3 offset:8704
    v_mfma_f32_16x16x32_bf16 v[52:55], v[140:143], v[156:159], v[52:55]
    ds_read_b64_tr_b16 v[108:109], v4 offset:8192
    v_mfma_f32_16x16x32_bf16 v[48:51], v[136:139], v[156:159], v[48:51]
    ds_read_b64_tr_b16 v[110:111], v4 offset:8704
    v_mfma_f32_16x16x32_bf16 v[20:23], v[132:135], v[156:159], v[20:23]
    ds_read_b64_tr_b16 v[112:113], v3 offset:32768
    v_mfma_f32_16x16x32_bf16 v[16:19], v[128:131], v[156:159], v[16:19]
    ds_read_b128 v[156:159], v1 offset:10240
    ds_read_b64_tr_b16 v[114:115], v3 offset:33280
    v_mfma_f32_16x16x32_bf16 v[24:27], v[128:131], v[160:163], v[24:27]
    ds_read_b64_tr_b16 v[116:117], v4 offset:32768
    v_mfma_f32_16x16x32_bf16 v[28:31], v[132:135], v[160:163], v[28:31]
    ds_read_b64_tr_b16 v[118:119], v4 offset:33280
    v_mfma_f32_16x16x32_bf16 v[56:59], v[136:139], v[160:163], v[56:59]
    ds_read_b64_tr_b16 v[120:121], v5 offset:8192
    v_mfma_f32_16x16x32_bf16 v[60:63], v[140:143], v[160:163], v[60:63]
    ds_read_b64_tr_b16 v[122:123], v5 offset:8704
    v_mfma_f32_16x16x32_bf16 v[88:91], v[160:163], v[144:147], v[88:91]
    ds_read_b64_tr_b16 v[124:125], v6 offset:8192
    v_mfma_f32_16x16x32_bf16 v[96:99], v[160:163], v[148:151], v[96:99]
    ds_read_b128 v[160:163], v1 offset:12288
    ds_read_b64_tr_b16 v[126:127], v6 offset:8704
    v_mfma_f32_16x16x32_bf16 v[100:103], v[164:167], v[148:151], v[100:103]
    v_mfma_f32_16x16x32_bf16 v[92:95], v[164:167], v[144:147], v[92:95]
    v_mfma_f32_16x16x32_bf16 v[68:71], v[140:143], v[164:167], v[68:71]
    v_mfma_f32_16x16x32_bf16 v[64:67], v[136:139], v[164:167], v[64:67]
    v_mfma_f32_16x16x32_bf16 v[36:39], v[132:135], v[164:167], v[36:39]
    v_mfma_f32_16x16x32_bf16 v[32:35], v[128:131], v[164:167], v[32:35]
    s_branch p1_loop
p1_last:
    ds_read_b128 v[164:167], v2 offset:6144
    v_subrev_u32 v2, 122880, v2
    s_waitcnt lgkmcnt(9)
    v_mfma_f32_16x16x32_bf16 v[40:43], v[136:139], v[152:155], v[40:43]
    v_lshlrev_b32 v124, 4, v0
    v_add_u32 v125, s53, v124
    v_add_u32 v126, s54, v124
    s_waitcnt lgkmcnt(7)
    v_mfma_f32_16x16x32_bf16 v[44:47], v[140:143], v[152:155], v[44:47]
    s_waitcnt lgkmcnt(6)
    v_mfma_f32_16x16x32_bf16 v[52:55], v[140:143], v[156:159], v[52:55]
    v_mfma_f32_16x16x32_bf16 v[48:51], v[136:139], v[156:159], v[48:51]
    s_waitcnt lgkmcnt(4)
    v_mfma_f32_16x16x32_bf16 v[72:75], v[152:155], v[144:147], v[72:75]
    s_waitcnt lgkmcnt(2)
    v_mfma_f32_16x16x32_bf16 v[80:83], v[152:155], v[148:151], v[80:83]
    s_waitcnt lgkmcnt(0)
    s_barrier
    v_mfma_f32_16x16x32_bf16 v[84:87], v[156:159], v[148:151], v[84:87]
    v_cvt_pk_bf16_f32 v40, v40, v41
    v_cvt_pk_bf16_f32 v41, v42, v43
    v_cvt_pk_bf16_f32 v42, v44, v45
    v_mfma_f32_16x16x32_bf16 v[76:79], v[156:159], v[144:147], v[76:79]
    v_cvt_pk_bf16_f32 v43, v46, v47
    v_cvt_pk_bf16_f32 v44, v48, v49
    v_cvt_pk_bf16_f32 v45, v50, v51
    v_mfma_f32_16x16x32_bf16 v[56:59], v[136:139], v[160:163], v[56:59]
    v_cvt_pk_bf16_f32 v46, v52, v53
    v_cvt_pk_bf16_f32 v47, v54, v55
    ds_write_b128 v126, v[40:43] offset:0
    v_mfma_f32_16x16x32_bf16 v[60:63], v[140:143], v[160:163], v[60:63]
    ds_write_b128 v126, v[44:47] offset:1024
    buffer_store_dwordx4 v[40:43], v124, s[36:39], s48 offen offset:0 sc1
    buffer_store_dwordx4 v[44:47], v124, s[36:39], s48 offen offset:1024 sc1
    v_mfma_f32_16x16x32_bf16 v[68:71], v[140:143], v[164:167], v[68:71]
    v_cvt_pk_bf16_f32 v72, v72, v73
    v_cvt_pk_bf16_f32 v73, v74, v75
    v_cvt_pk_bf16_f32 v74, v76, v77
    v_mfma_f32_16x16x32_bf16 v[64:67], v[136:139], v[164:167], v[64:67]
    v_cvt_pk_bf16_f32 v75, v78, v79
    v_cvt_pk_bf16_f32 v76, v80, v81
    v_cvt_pk_bf16_f32 v77, v82, v83
    v_mfma_f32_16x16x32_bf16 v[88:91], v[160:163], v[144:147], v[88:91]
    v_cvt_pk_bf16_f32 v78, v84, v85
    v_cvt_pk_bf16_f32 v79, v86, v87
    ds_write_b128 v125, v[72:75] offset:2048
    v_mfma_f32_16x16x32_bf16 v[96:99], v[160:163], v[148:151], v[96:99]
    ds_write_b128 v125, v[76:79] offset:3072
    buffer_store_dwordx4 v[72:75], v124, s[36:39], s48 offen offset:2048 sc1
    buffer_store_dwordx4 v[76:79], v124, s[36:39], s48 offen offset:3072 sc1
    v_mfma_f32_16x16x32_bf16 v[100:103], v[164:167], v[148:151], v[100:103]
    v_cvt_pk_bf16_f32 v56, v56, v57
    v_cvt_pk_bf16_f32 v57, v58, v59
    v_cvt_pk_bf16_f32 v58, v60, v61
    v_mfma_f32_16x16x32_bf16 v[92:95], v[164:167], v[144:147], v[92:95]
    v_cvt_pk_bf16_f32 v59, v62, v63
    v_cvt_pk_bf16_f32 v60, v64, v65
    v_cvt_pk_bf16_f32 v61, v66, v67
    v_mfma_f32_16x16x32_bf16 v[8:11], v[128:131], v[152:155], v[8:11]
    v_cvt_pk_bf16_f32 v62, v68, v69
    v_cvt_pk_bf16_f32 v63, v70, v71
    ds_write_b128 v125, v[56:59] offset:0
    v_mfma_f32_16x16x32_bf16 v[12:15], v[132:135], v[152:155], v[12:15]
    ds_write_b128 v125, v[60:63] offset:1024
    buffer_store_dwordx4 v[56:59], v124, s[36:39], s49 offen offset:0 sc1
    buffer_store_dwordx4 v[60:63], v124, s[36:39], s49 offen offset:1024 sc1
    v_mfma_f32_16x16x32_bf16 v[20:23], v[132:135], v[156:159], v[20:23]
    v_cvt_pk_bf16_f32 v88, v88, v89
    v_cvt_pk_bf16_f32 v89, v90, v91
    v_cvt_pk_bf16_f32 v90, v92, v93
    v_mfma_f32_16x16x32_bf16 v[16:19], v[128:131], v[156:159], v[16:19]
    v_cvt_pk_bf16_f32 v91, v94, v95
    v_cvt_pk_bf16_f32 v92, v96, v97
    v_cvt_pk_bf16_f32 v93, v98, v99
    v_mfma_f32_16x16x32_bf16 v[24:27], v[128:131], v[160:163], v[24:27]
    v_cvt_pk_bf16_f32 v94, v100, v101
    v_cvt_pk_bf16_f32 v95, v102, v103
    ds_write_b128 v125, v[88:91] offset:6144
    v_mfma_f32_16x16x32_bf16 v[28:31], v[132:135], v[160:163], v[28:31]
    ds_write_b128 v125, v[92:95] offset:7168
    buffer_store_dwordx4 v[88:91], v124, s[36:39], s49 offen offset:2048 sc1
    buffer_store_dwordx4 v[92:95], v124, s[36:39], s49 offen offset:3072 sc1
    v_mfma_f32_16x16x32_bf16 v[36:39], v[132:135], v[164:167], v[36:39]
    v_mul_f32 v8, s51, v8
    v_mul_f32 v9, s51, v9
    v_mul_f32 v10, s51, v10
    v_mfma_f32_16x16x32_bf16 v[32:35], v[128:131], v[164:167], v[32:35]
    v_mul_f32 v11, s51, v11
    v_mul_f32 v12, s51, v12
    v_mul_f32 v13, s51, v13
    v_add_u32 v2, s41, v124
    v_mul_f32 v14, s51, v14
    v_mul_f32 v15, s51, v15
    v_mul_f32 v16, s51, v16
    v_mul_f32 v17, s51, v17
    v_mul_f32 v18, s51, v18
    v_mul_f32 v19, s51, v19
    v_mul_f32 v20, s51, v20
    v_mul_f32 v21, s51, v21
    v_mul_f32 v22, s51, v22
    v_mul_f32 v23, s51, v23
    v_cvt_pk_bf16_f32 v104, v8, v9
    v_cvt_pk_bf16_f32 v105, v10, v11
    v_cvt_pk_bf16_f32 v106, v12, v13
    v_cvt_pk_bf16_f32 v107, v14, v15
    v_cvt_pk_bf16_f32 v108, v16, v17
    v_cvt_pk_bf16_f32 v109, v18, v19
    v_cvt_pk_bf16_f32 v110, v20, v21
    v_cvt_pk_bf16_f32 v111, v22, v23
    v_mul_f32 v24, s51, v24
    v_mul_f32 v25, s51, v25
    v_mul_f32 v26, s51, v26
    v_mul_f32 v27, s51, v27
    v_mul_f32 v28, s51, v28
    v_mul_f32 v29, s51, v29
    v_mul_f32 v30, s51, v30
    v_mul_f32 v31, s51, v31
    v_mul_f32 v32, s51, v32
    v_mul_f32 v33, s51, v33
    v_mul_f32 v34, s51, v34
    v_mul_f32 v35, s51, v35
    v_mul_f32 v36, s51, v36
    v_mul_f32 v37, s51, v37
    v_mul_f32 v38, s51, v38
    v_mul_f32 v39, s51, v39
    v_cvt_pk_bf16_f32 v112, v24, v25
    v_cvt_pk_bf16_f32 v113, v26, v27
    v_cvt_pk_bf16_f32 v114, v28, v29
    v_cvt_pk_bf16_f32 v115, v30, v31
    v_cvt_pk_bf16_f32 v116, v32, v33
    v_cvt_pk_bf16_f32 v117, v34, v35
    v_cvt_pk_bf16_f32 v118, v36, v37
    v_cvt_pk_bf16_f32 v119, v38, v39
    s_waitcnt lgkmcnt(0)
    s_barrier
    ds_read_b128 v[128:131], v2 offset:28672
    ds_read_b128 v[132:135], v2 offset:29696
    s_waitcnt lgkmcnt(0)
    v_mfma_f32_16x16x32_bf16 v[8:11], v[128:131], v[104:107], 0
    v_lshrrev_b32 v3, 4, v0
    v_and_b32 v3, 2, v3
    v_xor_b32 v3, v0, v3
    v_mfma_f32_16x16x32_bf16 v[12:15], v[132:135], v[104:107], 0
    v_and_b32 v3, 14, v3
    v_cmp_eq_u32 vcc, 0, v3
    v_mov_b32 v144, 0x3f803f80
    s_nop 0
    v_cndmask_b32 v144, 0, v144, vcc
    v_mfma_f32_16x16x32_bf16 v[20:23], v[132:135], v[108:111], 0
    v_mov_b32 v145, v144
    v_mov_b32 v146, v144
    v_mov_b32 v147, v144
    v_and_b32 v3, 1, v0
    v_mfma_f32_16x16x32_bf16 v[16:19], v[128:131], v[108:111], 0
    v_mul_u32_u24 v3, 0xaaaa, v3
    v_add_u32 v3, 0x4444, v3
    v_bfe_u32 v1, v0, 4, 1
    v_lshlrev_b32 v1, 6, v1
    v_mfma_f32_16x16x32_bf16 v[24:27], v[128:131], v[112:115], 0
    v_and_or_b32 v1, v0, 47, v1
    v_lshlrev_b32 v0, 4, v1
    v_readlane_b32 s56, v7, 32
    v_readlane_b32 s57, v7, 33
    v_mfma_f32_16x16x32_bf16 v[28:31], v[132:135], v[112:115], 0
    s_add_u32 s56, s56, 1
    s_add_u32 s57, s57, 1
    v_mov_b32 v5, s56
    v_mov_b32 v6, s57
    v_mfma_f32_16x16x32_bf16 v[36:39], v[132:135], v[116:119], 0
    v_mov_b32 v120, 0
    v_mov_b32 v121, 0
    v_mov_b32 v122, 0
    v_mov_b32 v123, 0
    v_mfma_f32_16x16x32_bf16 v[32:35], v[128:131], v[116:119], 0
    v_mov_b32 v124, 0
    v_mov_b32 v125, 0
    v_mov_b32 v126, 0
    v_mov_b32 v127, 0
    v_max3_f32 v72, v8, v9, v10
    v_max3_f32 v72, v72, v11, v12
    v_max3_f32 v72, v72, v13, v14
    v_max_f32 v72, v72, v15
    v_max3_f32 v73, v16, v17, v18
    v_max3_f32 v73, v73, v19, v20
    v_max3_f32 v73, v73, v21, v22
    v_max_f32 v73, v73, v23
    v_max3_f32 v74, v24, v25, v26
    v_max3_f32 v74, v74, v27, v28
    v_max3_f32 v74, v74, v29, v30
    v_max_f32 v74, v74, v31
    v_max3_f32 v75, v32, v33, v34
    v_max3_f32 v75, v75, v35, v36
    v_max3_f32 v75, v75, v37, v38
    v_max_f32 v75, v75, v39
    v_permlane32_swap_b32 v72, v73
    s_nop 0
    v_permlane32_swap_b32 v74, v75
    v_max_f32 v72, v72, v73
    v_max_f32 v74, v74, v75
    s_nop 1
    v_permlane16_swap_b32 v72, v74
    v_max_f32 v72, v72, v74
    v_sub_f32 v72, 0xc2c00000, v72
    v_mov_b32 v74, v72
    s_nop 1
    v_permlane16_swap_b32 v72, v74
    v_mov_b32 v73, v72
    v_mov_b32 v75, v74
    s_nop 0
    v_permlane32_swap_b32 v72, v73
    v_permlane32_swap_b32 v74, v75
    s_barrier
    v_mov_b32 v88, v72
    v_mov_b32 v89, v72
    v_mov_b32 v90, v72
    v_mov_b32 v91, v72
    v_mov_b32 v92, v73
    v_mov_b32 v93, v73
    v_mov_b32 v94, v73
    v_mov_b32 v95, v73
    v_mov_b32 v96, v74
    v_mov_b32 v97, v74
    v_mov_b32 v98, v74
    v_mov_b32 v99, v74
    v_mov_b32 v100, v75
    v_mov_b32 v101, v75
    v_mov_b32 v102, v75
    v_mov_b32 v103, v75
    v_add_f32 v8, v88, v8
    v_add_f32 v9, v88, v9
    v_add_f32 v10, v88, v10
    v_add_f32 v11, v88, v11
    v_add_f32 v12, v88, v12
    v_add_f32 v13, v88, v13
    v_add_f32 v14, v88, v14
    v_add_f32 v15, v88, v15
    v_add_f32 v16, v92, v16
    v_add_f32 v17, v92, v17
    v_add_f32 v18, v92, v18
    v_add_f32 v19, v92, v19
    v_add_f32 v20, v92, v20
    v_add_f32 v21, v92, v21
    v_add_f32 v22, v92, v22
    v_add_f32 v23, v92, v23
    v_add_f32 v24, v96, v24
    v_add_f32 v25, v96, v25
    v_add_f32 v26, v96, v26
    v_add_f32 v27, v96, v27
    v_add_f32 v28, v96, v28
    v_add_f32 v29, v96, v29
    v_add_f32 v30, v96, v30
    v_add_f32 v31, v96, v31
    v_add_f32 v32, v100, v32
    v_add_f32 v33, v100, v33
    v_add_f32 v34, v100, v34
    v_add_f32 v35, v100, v35
    v_add_f32 v36, v100, v36
    v_add_f32 v37, v100, v37
    v_add_f32 v38, v100, v38
    v_add_f32 v39, v100, v39
    ds_read_b128 v[136:139], v2 offset:0
    ds_read_b128 v[140:143], v2 offset:1024
    v_exp_f32 v8, v8
    v_exp_f32 v9, v9
    v_exp_f32 v10, v10
    v_exp_f32 v11, v11
    v_cvt_pk_bf16_f32 v72, v8, v9
    v_cvt_pk_bf16_f32 v73, v10, v11
    ds_read_b128 v[160:163], v2 offset:2048
    ds_read_b128 v[164:167], v2 offset:3072
    v_exp_f32 v12, v12
    v_exp_f32 v13, v13
    v_exp_f32 v14, v14
    v_exp_f32 v15, v15
    v_cvt_pk_bf16_f32 v74, v12, v13
    v_cvt_pk_bf16_f32 v75, v14, v15
    v_exp_f32 v16, v16
    v_exp_f32 v17, v17
    v_exp_f32 v18, v18
    v_exp_f32 v19, v19
    v_cvt_pk_bf16_f32 v76, v16, v17
    v_cvt_pk_bf16_f32 v77, v18, v19
    v_exp_f32 v20, v20
    v_exp_f32 v21, v21
    v_exp_f32 v22, v22
    v_exp_f32 v23, v23
    v_cvt_pk_bf16_f32 v78, v20, v21
    v_cvt_pk_bf16_f32 v79, v22, v23
    s_waitcnt lgkmcnt(0)
    v_mfma_f32_16x16x32_bf16 v[8:11], v[136:139], v[104:107], v[88:91]
    v_exp_f32 v24, v24
    v_mfma_f32_16x16x32_bf16 v[12:15], v[140:143], v[104:107], v[88:91]
    v_exp_f32 v25, v25
    v_exp_f32 v26, v26
    v_exp_f32 v27, v27
    v_cvt_pk_bf16_f32 v80, v24, v25
    v_cvt_pk_bf16_f32 v81, v26, v27
    v_mfma_f32_16x16x32_bf16 v[20:23], v[140:143], v[108:111], v[92:95]
    v_exp_f32 v28, v28
    v_mfma_f32_16x16x32_bf16 v[16:19], v[136:139], v[108:111], v[92:95]
    v_exp_f32 v29, v29
    v_exp_f32 v30, v30
    v_exp_f32 v31, v31
    v_cvt_pk_bf16_f32 v82, v28, v29
    v_cvt_pk_bf16_f32 v83, v30, v31
    v_mfma_f32_16x16x32_bf16 v[40:43], v[160:163], v[72:75], 0
    v_exp_f32 v32, v32
    v_mfma_f32_16x16x32_bf16 v[44:47], v[164:167], v[72:75], 0
    v_exp_f32 v33, v33
    v_exp_f32 v34, v34
    v_exp_f32 v35, v35
    v_cvt_pk_bf16_f32 v84, v32, v33
    v_cvt_pk_bf16_f32 v85, v34, v35
    v_mfma_f32_16x16x32_bf16 v[52:55], v[164:167], v[76:79], 0
    v_exp_f32 v36, v36
    v_mfma_f32_16x16x32_bf16 v[48:51], v[160:163], v[76:79], 0
    v_exp_f32 v37, v37
    v_exp_f32 v38, v38
    v_smfmac_f32_16x16x64_bf16 v[120:123], v[144:147], v[72:79], v3
    v_exp_f32 v39, v39
    v_cvt_pk_bf16_f32 v86, v36, v37
    v_cvt_pk_bf16_f32 v87, v38, v39
    v_mfma_f32_16x16x32_bf16 v[24:27], v[136:139], v[112:115], v[96:99]
    ds_read_b128 v[128:131], v2 offset:4096
    ds_read_b128 v[132:135], v2 offset:5120
    v_exp_f32 v8, v8
    v_mfma_f32_16x16x32_bf16 v[28:31], v[140:143], v[112:115], v[96:99]
    v_exp_f32 v9, v9
    v_exp_f32 v10, v10
    v_exp_f32 v11, v11
    v_cvt_pk_bf16_f32 v72, v8, v9
    v_cvt_pk_bf16_f32 v73, v10, v11
    v_mfma_f32_16x16x32_bf16 v[36:39], v[140:143], v[116:119], v[100:103]
    ds_read_b128 v[152:155], v2 offset:6144
    ds_read_b128 v[156:159], v2 offset:7168
    v_exp_f32 v12, v12
    v_mfma_f32_16x16x32_bf16 v[32:35], v[136:139], v[116:119], v[100:103]
    v_exp_f32 v13, v13
    v_exp_f32 v14, v14
    v_exp_f32 v15, v15
    v_cvt_pk_bf16_f32 v74, v12, v13
    v_cvt_pk_bf16_f32 v75, v14, v15
    v_mfma_f32_16x16x32_bf16 v[56:59], v[160:163], v[80:83], 0
    v_exp_f32 v16, v16
    v_mfma_f32_16x16x32_bf16 v[60:63], v[164:167], v[80:83], 0
    v_exp_f32 v17, v17
    v_exp_f32 v18, v18
    v_exp_f32 v19, v19
    v_cvt_pk_bf16_f32 v76, v16, v17
    v_cvt_pk_bf16_f32 v77, v18, v19
    v_mfma_f32_16x16x32_bf16 v[68:71], v[164:167], v[84:87], 0
    v_exp_f32 v20, v20
    v_mfma_f32_16x16x32_bf16 v[64:67], v[160:163], v[84:87], 0
    v_exp_f32 v21, v21
    v_exp_f32 v22, v22
    v_smfmac_f32_16x16x64_bf16 v[124:127], v[144:147], v[80:87], v3
    v_exp_f32 v23, v23
    v_cvt_pk_bf16_f32 v78, v20, v21
    v_cvt_pk_bf16_f32 v79, v22, v23
    s_waitcnt lgkmcnt(0)
    v_mfma_f32_16x16x32_bf16 v[8:11], v[128:131], v[104:107], v[88:91]
    s_barrier
    v_exp_f32 v24, v24
    v_mfma_f32_16x16x32_bf16 v[12:15], v[132:135], v[104:107], v[88:91]
    v_exp_f32 v25, v25
    v_exp_f32 v26, v26
    v_exp_f32 v27, v27
    v_cvt_pk_bf16_f32 v80, v24, v25
    v_cvt_pk_bf16_f32 v81, v26, v27
    v_mfma_f32_16x16x32_bf16 v[20:23], v[132:135], v[108:111], v[92:95]
    v_exp_f32 v28, v28
    v_mfma_f32_16x16x32_bf16 v[16:19], v[128:131], v[108:111], v[92:95]
    v_exp_f32 v29, v29
    v_exp_f32 v30, v30
    v_exp_f32 v31, v31
    v_cvt_pk_bf16_f32 v82, v28, v29
    v_cvt_pk_bf16_f32 v83, v30, v31
    v_mfma_f32_16x16x32_bf16 v[40:43], v[152:155], v[72:75], v[40:43]
    v_exp_f32 v32, v32
    v_mfma_f32_16x16x32_bf16 v[44:47], v[156:159], v[72:75], v[44:47]
    v_exp_f32 v33, v33
    v_exp_f32 v34, v34
    v_exp_f32 v35, v35
    v_cvt_pk_bf16_f32 v84, v32, v33
    v_cvt_pk_bf16_f32 v85, v34, v35
    v_mfma_f32_16x16x32_bf16 v[52:55], v[156:159], v[76:79], v[52:55]
    v_exp_f32 v36, v36
    v_mfma_f32_16x16x32_bf16 v[48:51], v[152:155], v[76:79], v[48:51]
    v_exp_f32 v37, v37
    v_exp_f32 v38, v38
    v_smfmac_f32_16x16x64_bf16 v[120:123], v[144:147], v[72:79], v3
    v_exp_f32 v39, v39
    v_cvt_pk_bf16_f32 v86, v36, v37
    v_cvt_pk_bf16_f32 v87, v38, v39
    v_mfma_f32_16x16x32_bf16 v[24:27], v[128:131], v[112:115], v[96:99]
    ds_read_b128 v[136:139], v2 offset:8192
    ds_read_b128 v[140:143], v2 offset:9216
    v_exp_f32 v8, v8
    v_mfma_f32_16x16x32_bf16 v[28:31], v[132:135], v[112:115], v[96:99]
    v_exp_f32 v9, v9
    v_exp_f32 v10, v10
    v_exp_f32 v11, v11
    v_cvt_pk_bf16_f32 v72, v8, v9
    v_cvt_pk_bf16_f32 v73, v10, v11
    v_mfma_f32_16x16x32_bf16 v[36:39], v[132:135], v[116:119], v[100:103]
    ds_read_b128 v[160:163], v2 offset:10240
    ds_read_b128 v[164:167], v2 offset:11264
    v_exp_f32 v12, v12
    v_mfma_f32_16x16x32_bf16 v[32:35], v[128:131], v[116:119], v[100:103]
    v_exp_f32 v13, v13
    v_exp_f32 v14, v14
    v_exp_f32 v15, v15
    v_cvt_pk_bf16_f32 v74, v12, v13
    v_cvt_pk_bf16_f32 v75, v14, v15
    v_mfma_f32_16x16x32_bf16 v[56:59], v[152:155], v[80:83], v[56:59]
    v_exp_f32 v16, v16
    v_mfma_f32_16x16x32_bf16 v[60:63], v[156:159], v[80:83], v[60:63]
    v_exp_f32 v17, v17
    v_exp_f32 v18, v18
    v_exp_f32 v19, v19
    v_cvt_pk_bf16_f32 v76, v16, v17
    v_cvt_pk_bf16_f32 v77, v18, v19
    v_mfma_f32_16x16x32_bf16 v[68:71], v[156:159], v[84:87], v[68:71]
    v_exp_f32 v20, v20
    v_mfma_f32_16x16x32_bf16 v[64:67], v[152:155], v[84:87], v[64:67]
    v_exp_f32 v21, v21
    v_exp_f32 v22, v22
    v_smfmac_f32_16x16x64_bf16 v[124:127], v[144:147], v[80:87], v3
    v_exp_f32 v23, v23
    v_cvt_pk_bf16_f32 v78, v20, v21
    v_cvt_pk_bf16_f32 v79, v22, v23
    s_waitcnt lgkmcnt(0)
    v_mfma_f32_16x16x32_bf16 v[8:11], v[136:139], v[104:107], v[88:91]
    s_barrier
    s_waitcnt vmcnt(0)
    buffer_store_dword v5, off, s[36:39], s50 sc1
    s_barrier
    s_barrier
    s_barrier
    s_barrier
    s_barrier
    v_exp_f32 v24, v24
    v_mfma_f32_16x16x32_bf16 v[12:15], v[140:143], v[104:107], v[88:91]
    v_exp_f32 v25, v25
    v_exp_f32 v26, v26
    v_exp_f32 v27, v27
    v_cvt_pk_bf16_f32 v80, v24, v25
    v_cvt_pk_bf16_f32 v81, v26, v27
    v_mfma_f32_16x16x32_bf16 v[20:23], v[140:143], v[108:111], v[92:95]
    v_exp_f32 v28, v28
    v_mfma_f32_16x16x32_bf16 v[16:19], v[136:139], v[108:111], v[92:95]
    v_exp_f32 v29, v29
    v_exp_f32 v30, v30
    v_exp_f32 v31, v31
    v_cvt_pk_bf16_f32 v82, v28, v29
    v_cvt_pk_bf16_f32 v83, v30, v31
    v_mfma_f32_16x16x32_bf16 v[40:43], v[160:163], v[72:75], v[40:43]
    v_exp_f32 v32, v32
    v_mfma_f32_16x16x32_bf16 v[44:47], v[164:167], v[72:75], v[44:47]
    v_exp_f32 v33, v33
    v_exp_f32 v34, v34
    v_exp_f32 v35, v35
    v_cvt_pk_bf16_f32 v84, v32, v33
    v_cvt_pk_bf16_f32 v85, v34, v35
    v_mfma_f32_16x16x32_bf16 v[52:55], v[164:167], v[76:79], v[52:55]
    v_exp_f32 v36, v36
    v_mfma_f32_16x16x32_bf16 v[48:51], v[160:163], v[76:79], v[48:51]
    v_exp_f32 v37, v37
    v_exp_f32 v38, v38
    v_smfmac_f32_16x16x64_bf16 v[120:123], v[144:147], v[72:79], v3
    v_exp_f32 v39, v39
    v_cvt_pk_bf16_f32 v86, v36, v37
    v_cvt_pk_bf16_f32 v87, v38, v39
    v_mfma_f32_16x16x32_bf16 v[24:27], v[136:139], v[112:115], v[96:99]
    ds_read_b128 v[128:131], v2 offset:12288
    ds_read_b128 v[132:135], v2 offset:13312
    v_exp_f32 v8, v8
    v_mfma_f32_16x16x32_bf16 v[28:31], v[140:143], v[112:115], v[96:99]
    v_exp_f32 v9, v9
    v_exp_f32 v10, v10
    v_exp_f32 v11, v11
    v_cvt_pk_bf16_f32 v72, v8, v9
    v_cvt_pk_bf16_f32 v73, v10, v11
    v_mfma_f32_16x16x32_bf16 v[36:39], v[140:143], v[116:119], v[100:103]
    ds_read_b128 v[152:155], v2 offset:14336
    ds_read_b128 v[156:159], v2 offset:15360
    v_exp_f32 v12, v12
    v_mfma_f32_16x16x32_bf16 v[32:35], v[136:139], v[116:119], v[100:103]
    v_exp_f32 v13, v13
    v_exp_f32 v14, v14
    v_exp_f32 v15, v15
    v_cvt_pk_bf16_f32 v74, v12, v13
    v_cvt_pk_bf16_f32 v75, v14, v15
    v_mfma_f32_16x16x32_bf16 v[56:59], v[160:163], v[80:83], v[56:59]
    v_exp_f32 v16, v16
    v_mfma_f32_16x16x32_bf16 v[60:63], v[164:167], v[80:83], v[60:63]
    v_exp_f32 v17, v17
    v_exp_f32 v18, v18
    v_exp_f32 v19, v19
    v_cvt_pk_bf16_f32 v76, v16, v17
    v_cvt_pk_bf16_f32 v77, v18, v19
    v_mfma_f32_16x16x32_bf16 v[68:71], v[164:167], v[84:87], v[68:71]
    v_exp_f32 v20, v20
    v_mfma_f32_16x16x32_bf16 v[64:67], v[160:163], v[84:87], v[64:67]
    v_exp_f32 v21, v21
    v_exp_f32 v22, v22
    v_smfmac_f32_16x16x64_bf16 v[124:127], v[144:147], v[80:87], v3
    v_exp_f32 v23, v23
    v_cvt_pk_bf16_f32 v78, v20, v21
    v_cvt_pk_bf16_f32 v79, v22, v23
    s_waitcnt lgkmcnt(0)
    v_mfma_f32_16x16x32_bf16 v[8:11], v[128:131], v[104:107], v[88:91]
    s_barrier
    v_exp_f32 v24, v24
    v_mfma_f32_16x16x32_bf16 v[12:15], v[132:135], v[104:107], v[88:91]
    v_exp_f32 v25, v25
    v_exp_f32 v26, v26
    v_exp_f32 v27, v27
    v_cvt_pk_bf16_f32 v80, v24, v25
    v_cvt_pk_bf16_f32 v81, v26, v27
    v_mfma_f32_16x16x32_bf16 v[20:23], v[132:135], v[108:111], v[92:95]
    v_exp_f32 v28, v28
    v_mfma_f32_16x16x32_bf16 v[16:19], v[128:131], v[108:111], v[92:95]
    v_exp_f32 v29, v29
    v_exp_f32 v30, v30
    v_exp_f32 v31, v31
    v_cvt_pk_bf16_f32 v82, v28, v29
    v_cvt_pk_bf16_f32 v83, v30, v31
    v_mfma_f32_16x16x32_bf16 v[40:43], v[152:155], v[72:75], v[40:43]
    v_exp_f32 v32, v32
    v_mfma_f32_16x16x32_bf16 v[44:47], v[156:159], v[72:75], v[44:47]
    v_exp_f32 v33, v33
    v_exp_f32 v34, v34
    v_exp_f32 v35, v35
    v_cvt_pk_bf16_f32 v84, v32, v33
    v_cvt_pk_bf16_f32 v85, v34, v35
    v_mfma_f32_16x16x32_bf16 v[52:55], v[156:159], v[76:79], v[52:55]
    v_exp_f32 v36, v36
    v_mfma_f32_16x16x32_bf16 v[48:51], v[152:155], v[76:79], v[48:51]
    v_exp_f32 v37, v37
    v_exp_f32 v38, v38
    v_smfmac_f32_16x16x64_bf16 v[120:123], v[144:147], v[72:79], v3
    v_exp_f32 v39, v39
    v_cvt_pk_bf16_f32 v86, v36, v37
    v_cvt_pk_bf16_f32 v87, v38, v39
    v_mfma_f32_16x16x32_bf16 v[24:27], v[128:131], v[112:115], v[96:99]
    ds_read_b128 v[136:139], v2 offset:16384
    ds_read_b128 v[140:143], v2 offset:17408
    v_exp_f32 v8, v8
    v_mfma_f32_16x16x32_bf16 v[28:31], v[132:135], v[112:115], v[96:99]
    v_exp_f32 v9, v9
    v_exp_f32 v10, v10
    v_exp_f32 v11, v11
    v_cvt_pk_bf16_f32 v72, v8, v9
    v_cvt_pk_bf16_f32 v73, v10, v11
    v_mfma_f32_16x16x32_bf16 v[36:39], v[132:135], v[116:119], v[100:103]
    ds_read_b128 v[160:163], v2 offset:18432
    ds_read_b128 v[164:167], v2 offset:19456
    v_exp_f32 v12, v12
    v_mfma_f32_16x16x32_bf16 v[32:35], v[128:131], v[116:119], v[100:103]
    v_exp_f32 v13, v13
    v_exp_f32 v14, v14
    v_exp_f32 v15, v15
    v_cvt_pk_bf16_f32 v74, v12, v13
    v_cvt_pk_bf16_f32 v75, v14, v15
    v_mfma_f32_16x16x32_bf16 v[56:59], v[152:155], v[80:83], v[56:59]
    v_exp_f32 v16, v16
    v_mfma_f32_16x16x32_bf16 v[60:63], v[156:159], v[80:83], v[60:63]
    v_exp_f32 v17, v17
    v_exp_f32 v18, v18
    v_exp_f32 v19, v19
    v_cvt_pk_bf16_f32 v76, v16, v17
    v_cvt_pk_bf16_f32 v77, v18, v19
    v_mfma_f32_16x16x32_bf16 v[68:71], v[156:159], v[84:87], v[68:71]
    v_exp_f32 v20, v20
    v_mfma_f32_16x16x32_bf16 v[64:67], v[152:155], v[84:87], v[64:67]
    v_exp_f32 v21, v21
    v_exp_f32 v22, v22
    v_smfmac_f32_16x16x64_bf16 v[124:127], v[144:147], v[80:87], v3
    v_exp_f32 v23, v23
    v_cvt_pk_bf16_f32 v78, v20, v21
    v_cvt_pk_bf16_f32 v79, v22, v23
    s_waitcnt lgkmcnt(0)
    v_mfma_f32_16x16x32_bf16 v[8:11], v[136:139], v[104:107], v[88:91]
    v_exp_f32 v24, v24
    v_mfma_f32_16x16x32_bf16 v[12:15], v[140:143], v[104:107], v[88:91]
    v_exp_f32 v25, v25
    v_exp_f32 v26, v26
    v_exp_f32 v27, v27
    v_cvt_pk_bf16_f32 v80, v24, v25
    v_cvt_pk_bf16_f32 v81, v26, v27
    v_mfma_f32_16x16x32_bf16 v[20:23], v[140:143], v[108:111], v[92:95]
    v_exp_f32 v28, v28
    v_mfma_f32_16x16x32_bf16 v[16:19], v[136:139], v[108:111], v[92:95]
    v_exp_f32 v29, v29
    v_exp_f32 v30, v30
    v_exp_f32 v31, v31
    v_cvt_pk_bf16_f32 v82, v28, v29
    v_cvt_pk_bf16_f32 v83, v30, v31
    v_mfma_f32_16x16x32_bf16 v[40:43], v[160:163], v[72:75], v[40:43]
    v_exp_f32 v32, v32
    v_mfma_f32_16x16x32_bf16 v[44:47], v[164:167], v[72:75], v[44:47]
    v_exp_f32 v33, v33
    v_exp_f32 v34, v34
    v_exp_f32 v35, v35
    v_cvt_pk_bf16_f32 v84, v32, v33
    v_cvt_pk_bf16_f32 v85, v34, v35
    v_mfma_f32_16x16x32_bf16 v[52:55], v[164:167], v[76:79], v[52:55]
    v_exp_f32 v36, v36
    v_mfma_f32_16x16x32_bf16 v[48:51], v[160:163], v[76:79], v[48:51]
    v_exp_f32 v37, v37
    v_exp_f32 v38, v38
    v_smfmac_f32_16x16x64_bf16 v[120:123], v[144:147], v[72:79], v3
    v_exp_f32 v39, v39
    v_cvt_pk_bf16_f32 v86, v36, v37
    v_cvt_pk_bf16_f32 v87, v38, v39
    v_mfma_f32_16x16x32_bf16 v[24:27], v[136:139], v[112:115], v[96:99]
    ds_read_b128 v[128:131], v2 offset:20480
    ds_read_b128 v[132:135], v2 offset:21504
    v_exp_f32 v8, v8
    v_mfma_f32_16x16x32_bf16 v[28:31], v[140:143], v[112:115], v[96:99]
    v_exp_f32 v9, v9
    v_exp_f32 v10, v10
    v_exp_f32 v11, v11
    v_cvt_pk_bf16_f32 v72, v8, v9
    v_cvt_pk_bf16_f32 v73, v10, v11
    v_mfma_f32_16x16x32_bf16 v[36:39], v[140:143], v[116:119], v[100:103]
    ds_read_b128 v[152:155], v2 offset:22528
    ds_read_b128 v[156:159], v2 offset:23552
    v_exp_f32 v12, v12
    v_mfma_f32_16x16x32_bf16 v[32:35], v[136:139], v[116:119], v[100:103]
    v_exp_f32 v13, v13
    v_exp_f32 v14, v14
    v_exp_f32 v15, v15
    v_cvt_pk_bf16_f32 v74, v12, v13
    v_cvt_pk_bf16_f32 v75, v14, v15
    v_mfma_f32_16x16x32_bf16 v[56:59], v[160:163], v[80:83], v[56:59]
    v_exp_f32 v16, v16
    v_mfma_f32_16x16x32_bf16 v[60:63], v[164:167], v[80:83], v[60:63]
    v_exp_f32 v17, v17
    v_exp_f32 v18, v18
    v_exp_f32 v19, v19
    v_cvt_pk_bf16_f32 v76, v16, v17
    v_cvt_pk_bf16_f32 v77, v18, v19
    v_mfma_f32_16x16x32_bf16 v[68:71], v[164:167], v[84:87], v[68:71]
    v_exp_f32 v20, v20
    v_mfma_f32_16x16x32_bf16 v[64:67], v[160:163], v[84:87], v[64:67]
    v_exp_f32 v21, v21
    v_exp_f32 v22, v22
    v_smfmac_f32_16x16x64_bf16 v[124:127], v[144:147], v[80:87], v3
    v_exp_f32 v23, v23
    v_cvt_pk_bf16_f32 v78, v20, v21
    v_cvt_pk_bf16_f32 v79, v22, v23
    s_waitcnt lgkmcnt(0)
    v_mfma_f32_16x16x32_bf16 v[8:11], v[128:131], v[104:107], v[88:91]
    s_barrier
    v_exp_f32 v24, v24
    v_mfma_f32_16x16x32_bf16 v[12:15], v[132:135], v[104:107], v[88:91]
    v_exp_f32 v25, v25
    v_exp_f32 v26, v26
    v_exp_f32 v27, v27
    v_cvt_pk_bf16_f32 v80, v24, v25
    v_cvt_pk_bf16_f32 v81, v26, v27
    v_mfma_f32_16x16x32_bf16 v[20:23], v[132:135], v[108:111], v[92:95]
    v_exp_f32 v28, v28
    v_mfma_f32_16x16x32_bf16 v[16:19], v[128:131], v[108:111], v[92:95]
    v_exp_f32 v29, v29
    v_exp_f32 v30, v30
    v_exp_f32 v31, v31
    v_cvt_pk_bf16_f32 v82, v28, v29
    v_cvt_pk_bf16_f32 v83, v30, v31
    v_mfma_f32_16x16x32_bf16 v[40:43], v[152:155], v[72:75], v[40:43]
    v_exp_f32 v32, v32
    v_mfma_f32_16x16x32_bf16 v[44:47], v[156:159], v[72:75], v[44:47]
    v_exp_f32 v33, v33
    v_exp_f32 v34, v34
    v_exp_f32 v35, v35
    v_cvt_pk_bf16_f32 v84, v32, v33
    v_cvt_pk_bf16_f32 v85, v34, v35
    v_mfma_f32_16x16x32_bf16 v[52:55], v[156:159], v[76:79], v[52:55]
    v_exp_f32 v36, v36
    v_mfma_f32_16x16x32_bf16 v[48:51], v[152:155], v[76:79], v[48:51]
    v_exp_f32 v37, v37
    v_exp_f32 v38, v38
    v_smfmac_f32_16x16x64_bf16 v[120:123], v[144:147], v[72:79], v3
    v_exp_f32 v39, v39
    v_cvt_pk_bf16_f32 v86, v36, v37
    v_cvt_pk_bf16_f32 v87, v38, v39
    v_mfma_f32_16x16x32_bf16 v[24:27], v[128:131], v[112:115], v[96:99]
    ds_read_b128 v[136:139], v2 offset:24576
    ds_read_b128 v[140:143], v2 offset:25600
    v_exp_f32 v8, v8
    v_mfma_f32_16x16x32_bf16 v[28:31], v[132:135], v[112:115], v[96:99]
    v_exp_f32 v9, v9
    v_exp_f32 v10, v10
    v_exp_f32 v11, v11
    v_cvt_pk_bf16_f32 v72, v8, v9
    v_cvt_pk_bf16_f32 v73, v10, v11
    v_mfma_f32_16x16x32_bf16 v[36:39], v[132:135], v[116:119], v[100:103]
    ds_read_b128 v[160:163], v2 offset:26624
    ds_read_b128 v[164:167], v2 offset:27648
    v_exp_f32 v12, v12
    v_mfma_f32_16x16x32_bf16 v[32:35], v[128:131], v[116:119], v[100:103]
    v_exp_f32 v13, v13
    v_exp_f32 v14, v14
    v_exp_f32 v15, v15
    v_cvt_pk_bf16_f32 v74, v12, v13
    v_cvt_pk_bf16_f32 v75, v14, v15
    v_mfma_f32_16x16x32_bf16 v[56:59], v[152:155], v[80:83], v[56:59]
    v_exp_f32 v16, v16
    v_mfma_f32_16x16x32_bf16 v[60:63], v[156:159], v[80:83], v[60:63]
    v_exp_f32 v17, v17
    v_exp_f32 v18, v18
    v_exp_f32 v19, v19
    v_cvt_pk_bf16_f32 v76, v16, v17
    v_cvt_pk_bf16_f32 v77, v18, v19
    v_mfma_f32_16x16x32_bf16 v[68:71], v[156:159], v[84:87], v[68:71]
    v_exp_f32 v20, v20
    v_mfma_f32_16x16x32_bf16 v[64:67], v[152:155], v[84:87], v[64:67]
    v_exp_f32 v21, v21
    v_exp_f32 v22, v22
    v_smfmac_f32_16x16x64_bf16 v[124:127], v[144:147], v[80:87], v3
    v_exp_f32 v23, v23
    v_cvt_pk_bf16_f32 v78, v20, v21
    v_cvt_pk_bf16_f32 v79, v22, v23
    s_waitcnt lgkmcnt(0)
    v_mfma_f32_16x16x32_bf16 v[8:11], v[136:139], v[104:107], v[88:91]
    v_exp_f32 v24, v24
    v_mfma_f32_16x16x32_bf16 v[12:15], v[140:143], v[104:107], v[88:91]
    v_exp_f32 v25, v25
    v_exp_f32 v26, v26
    v_exp_f32 v27, v27
    v_cvt_pk_bf16_f32 v80, v24, v25
    v_cvt_pk_bf16_f32 v81, v26, v27
    v_mfma_f32_16x16x32_bf16 v[20:23], v[140:143], v[108:111], v[92:95]
    v_exp_f32 v28, v28
    v_mfma_f32_16x16x32_bf16 v[16:19], v[136:139], v[108:111], v[92:95]
    v_exp_f32 v29, v29
    v_exp_f32 v30, v30
    v_exp_f32 v31, v31
    v_cvt_pk_bf16_f32 v82, v28, v29
    v_cvt_pk_bf16_f32 v83, v30, v31
    v_mfma_f32_16x16x32_bf16 v[40:43], v[160:163], v[72:75], v[40:43]
    v_exp_f32 v32, v32
    v_mfma_f32_16x16x32_bf16 v[44:47], v[164:167], v[72:75], v[44:47]
    v_exp_f32 v33, v33
    v_exp_f32 v34, v34
    v_exp_f32 v35, v35
    v_cvt_pk_bf16_f32 v84, v32, v33
    v_cvt_pk_bf16_f32 v85, v34, v35
    v_mfma_f32_16x16x32_bf16 v[52:55], v[164:167], v[76:79], v[52:55]
    v_exp_f32 v36, v36
    v_mfma_f32_16x16x32_bf16 v[48:51], v[160:163], v[76:79], v[48:51]
    v_exp_f32 v37, v37
    v_exp_f32 v38, v38
    v_smfmac_f32_16x16x64_bf16 v[120:123], v[144:147], v[72:79], v3
    v_exp_f32 v39, v39
    v_cvt_pk_bf16_f32 v86, v36, v37
    v_cvt_pk_bf16_f32 v87, v38, v39
    v_mfma_f32_16x16x32_bf16 v[24:27], v[136:139], v[112:115], v[96:99]
    ds_read_b128 v[128:131], v2 offset:28672
    ds_read_b128 v[132:135], v2 offset:29696
    v_exp_f32 v8, v8
    v_mfma_f32_16x16x32_bf16 v[28:31], v[140:143], v[112:115], v[96:99]
    v_exp_f32 v9, v9
    v_exp_f32 v10, v10
    v_exp_f32 v11, v11
    v_cvt_pk_bf16_f32 v72, v8, v9
    v_cvt_pk_bf16_f32 v73, v10, v11
    v_mfma_f32_16x16x32_bf16 v[36:39], v[140:143], v[116:119], v[100:103]
    ds_read_b128 v[152:155], v2 offset:30720
    ds_read_b128 v[156:159], v2 offset:31744
    v_exp_f32 v12, v12
    v_mfma_f32_16x16x32_bf16 v[32:35], v[136:139], v[116:119], v[100:103]
    v_exp_f32 v13, v13
    v_exp_f32 v14, v14
    v_exp_f32 v15, v15
    v_cvt_pk_bf16_f32 v74, v12, v13
    v_cvt_pk_bf16_f32 v75, v14, v15
    v_mfma_f32_16x16x32_bf16 v[56:59], v[160:163], v[80:83], v[56:59]
    v_exp_f32 v16, v16
    v_mfma_f32_16x16x32_bf16 v[60:63], v[164:167], v[80:83], v[60:63]
    v_exp_f32 v17, v17
    v_exp_f32 v18, v18
    v_exp_f32 v19, v19
    v_cvt_pk_bf16_f32 v76, v16, v17
    v_cvt_pk_bf16_f32 v77, v18, v19
    v_mfma_f32_16x16x32_bf16 v[68:71], v[164:167], v[84:87], v[68:71]
    v_exp_f32 v20, v20
    v_mfma_f32_16x16x32_bf16 v[64:67], v[160:163], v[84:87], v[64:67]
    v_exp_f32 v21, v21
    v_exp_f32 v22, v22
    v_smfmac_f32_16x16x64_bf16 v[124:127], v[144:147], v[80:87], v3
    v_exp_f32 v23, v23
    v_cvt_pk_bf16_f32 v78, v20, v21
    v_cvt_pk_bf16_f32 v79, v22, v23
    s_waitcnt lgkmcnt(0)
    v_mfma_f32_16x16x32_bf16 v[8:11], v[128:131], v[104:107], v[88:91]
    s_barrier
    v_exp_f32 v24, v24
    v_mfma_f32_16x16x32_bf16 v[12:15], v[132:135], v[104:107], v[88:91]
    v_exp_f32 v25, v25
    v_exp_f32 v26, v26
    v_exp_f32 v27, v27
    v_cvt_pk_bf16_f32 v80, v24, v25
    v_cvt_pk_bf16_f32 v81, v26, v27
    v_mfma_f32_16x16x32_bf16 v[20:23], v[132:135], v[108:111], v[92:95]
    v_exp_f32 v28, v28
    v_mfma_f32_16x16x32_bf16 v[16:19], v[128:131], v[108:111], v[92:95]
    v_exp_f32 v29, v29
    v_exp_f32 v30, v30
    v_exp_f32 v31, v31
    v_cvt_pk_bf16_f32 v82, v28, v29
    v_cvt_pk_bf16_f32 v83, v30, v31
    v_mfma_f32_16x16x32_bf16 v[40:43], v[152:155], v[72:75], v[40:43]
    v_exp_f32 v32, v32
    v_mfma_f32_16x16x32_bf16 v[44:47], v[156:159], v[72:75], v[44:47]
    v_exp_f32 v33, v33
    v_exp_f32 v34, v34
    v_exp_f32 v35, v35
    v_cvt_pk_bf16_f32 v84, v32, v33
    v_cvt_pk_bf16_f32 v85, v34, v35
    v_mfma_f32_16x16x32_bf16 v[52:55], v[156:159], v[76:79], v[52:55]
    v_exp_f32 v36, v36
    v_mfma_f32_16x16x32_bf16 v[48:51], v[152:155], v[76:79], v[48:51]
    v_exp_f32 v37, v37
    v_exp_f32 v38, v38
    v_smfmac_f32_16x16x64_bf16 v[120:123], v[144:147], v[72:79], v3
    v_exp_f32 v39, v39
    v_cvt_pk_bf16_f32 v86, v36, v37
    v_cvt_pk_bf16_f32 v87, v38, v39
    s_mov_b32 s47, 7
att_loop1:
    v_mfma_f32_16x16x32_bf16 v[24:27], v[128:131], v[112:115], v[96:99]
    ds_read_b128 v[136:139], v2 offset:0
    ds_read_b128 v[140:143], v2 offset:1024
    v_exp_f32 v8, v8
    v_mfma_f32_16x16x32_bf16 v[28:31], v[132:135], v[112:115], v[96:99]
    v_exp_f32 v9, v9
    v_exp_f32 v10, v10
    v_exp_f32 v11, v11
    v_cvt_pk_bf16_f32 v72, v8, v9
    v_cvt_pk_bf16_f32 v73, v10, v11
    v_mfma_f32_16x16x32_bf16 v[36:39], v[132:135], v[116:119], v[100:103]
    ds_read_b128 v[160:163], v2 offset:2048
    ds_read_b128 v[164:167], v2 offset:3072
    v_exp_f32 v12, v12
    v_mfma_f32_16x16x32_bf16 v[32:35], v[128:131], v[116:119], v[100:103]
    v_exp_f32 v13, v13
    v_exp_f32 v14, v14
    v_exp_f32 v15, v15
    v_cvt_pk_bf16_f32 v74, v12, v13
    v_cvt_pk_bf16_f32 v75, v14, v15
    v_mfma_f32_16x16x32_bf16 v[56:59], v[152:155], v[80:83], v[56:59]
    v_exp_f32 v16, v16
    v_mfma_f32_16x16x32_bf16 v[60:63], v[156:159], v[80:83], v[60:63]
    v_exp_f32 v17, v17
    v_exp_f32 v18, v18
    v_exp_f32 v19, v19
    v_cvt_pk_bf16_f32 v76, v16, v17
    v_cvt_pk_bf16_f32 v77, v18, v19
    v_mfma_f32_16x16x32_bf16 v[68:71], v[156:159], v[84:87], v[68:71]
    v_exp_f32 v20, v20
    v_mfma_f32_16x16x32_bf16 v[64:67], v[152:155], v[84:87], v[64:67]
    v_exp_f32 v21, v21
    v_exp_f32 v22, v22
    v_smfmac_f32_16x16x64_bf16 v[124:127], v[144:147], v[80:87], v3
    v_exp_f32 v23, v23
    v_cvt_pk_bf16_f32 v78, v20, v21
    v_cvt_pk_bf16_f32 v79, v22, v23
    s_waitcnt lgkmcnt(0)
    v_mfma_f32_16x16x32_bf16 v[8:11], v[136:139], v[104:107], v[88:91]
    v_exp_f32 v24, v24
    v_mfma_f32_16x16x32_bf16 v[12:15], v[140:143], v[104:107], v[88:91]
    v_exp_f32 v25, v25
    v_exp_f32 v26, v26
    v_exp_f32 v27, v27
    v_cvt_pk_bf16_f32 v80, v24, v25
    v_cvt_pk_bf16_f32 v81, v26, v27
    v_mfma_f32_16x16x32_bf16 v[20:23], v[140:143], v[108:111], v[92:95]
    v_exp_f32 v28, v28
    v_mfma_f32_16x16x32_bf16 v[16:19], v[136:139], v[108:111], v[92:95]
    v_exp_f32 v29, v29
    v_exp_f32 v30, v30
    v_exp_f32 v31, v31
    v_cvt_pk_bf16_f32 v82, v28, v29
    v_cvt_pk_bf16_f32 v83, v30, v31
    v_mfma_f32_16x16x32_bf16 v[40:43], v[160:163], v[72:75], v[40:43]
    v_exp_f32 v32, v32
    v_mfma_f32_16x16x32_bf16 v[44:47], v[164:167], v[72:75], v[44:47]
    v_exp_f32 v33, v33
    v_exp_f32 v34, v34
    v_exp_f32 v35, v35
    v_cvt_pk_bf16_f32 v84, v32, v33
    v_cvt_pk_bf16_f32 v85, v34, v35
    v_mfma_f32_16x16x32_bf16 v[52:55], v[164:167], v[76:79], v[52:55]
    v_exp_f32 v36, v36
    v_mfma_f32_16x16x32_bf16 v[48:51], v[160:163], v[76:79], v[48:51]
    v_exp_f32 v37, v37
    v_exp_f32 v38, v38
    v_smfmac_f32_16x16x64_bf16 v[120:123], v[144:147], v[72:79], v3
    v_exp_f32 v39, v39
    v_cvt_pk_bf16_f32 v86, v36, v37
    v_cvt_pk_bf16_f32 v87, v38, v39
    v_mfma_f32_16x16x32_bf16 v[24:27], v[136:139], v[112:115], v[96:99]
    ds_read_b128 v[128:131], v2 offset:4096
    ds_read_b128 v[132:135], v2 offset:5120
    v_exp_f32 v8, v8
    v_mfma_f32_16x16x32_bf16 v[28:31], v[140:143], v[112:115], v[96:99]
    v_exp_f32 v9, v9
    v_exp_f32 v10, v10
    v_exp_f32 v11, v11
    v_cvt_pk_bf16_f32 v72, v8, v9
    v_cvt_pk_bf16_f32 v73, v10, v11
    v_mfma_f32_16x16x32_bf16 v[36:39], v[140:143], v[116:119], v[100:103]
    ds_read_b128 v[152:155], v2 offset:6144
    ds_read_b128 v[156:159], v2 offset:7168
    v_exp_f32 v12, v12
    v_mfma_f32_16x16x32_bf16 v[32:35], v[136:139], v[116:119], v[100:103]
    v_exp_f32 v13, v13
    v_exp_f32 v14, v14
    v_exp_f32 v15, v15
    v_cvt_pk_bf16_f32 v74, v12, v13
    v_cvt_pk_bf16_f32 v75, v14, v15
    v_mfma_f32_16x16x32_bf16 v[56:59], v[160:163], v[80:83], v[56:59]
    v_exp_f32 v16, v16
    v_mfma_f32_16x16x32_bf16 v[60:63], v[164:167], v[80:83], v[60:63]
    v_exp_f32 v17, v17
    v_exp_f32 v18, v18
    v_exp_f32 v19, v19
    v_cvt_pk_bf16_f32 v76, v16, v17
    v_cvt_pk_bf16_f32 v77, v18, v19
    v_mfma_f32_16x16x32_bf16 v[68:71], v[164:167], v[84:87], v[68:71]
    v_exp_f32 v20, v20
    v_mfma_f32_16x16x32_bf16 v[64:67], v[160:163], v[84:87], v[64:67]
    v_exp_f32 v21, v21
    v_exp_f32 v22, v22
    v_smfmac_f32_16x16x64_bf16 v[124:127], v[144:147], v[80:87], v3
    v_exp_f32 v23, v23
    v_cvt_pk_bf16_f32 v78, v20, v21
    v_cvt_pk_bf16_f32 v79, v22, v23
    s_waitcnt lgkmcnt(0)
    v_mfma_f32_16x16x32_bf16 v[8:11], v[128:131], v[104:107], v[88:91]
    s_barrier
    v_exp_f32 v24, v24
    v_mfma_f32_16x16x32_bf16 v[12:15], v[132:135], v[104:107], v[88:91]
    v_exp_f32 v25, v25
    v_exp_f32 v26, v26
    v_exp_f32 v27, v27
    v_cvt_pk_bf16_f32 v80, v24, v25
    v_cvt_pk_bf16_f32 v81, v26, v27
    v_mfma_f32_16x16x32_bf16 v[20:23], v[132:135], v[108:111], v[92:95]
    v_exp_f32 v28, v28
    v_mfma_f32_16x16x32_bf16 v[16:19], v[128:131], v[108:111], v[92:95]
    v_exp_f32 v29, v29
    v_exp_f32 v30, v30
    v_exp_f32 v31, v31
    v_cvt_pk_bf16_f32 v82, v28, v29
    v_cvt_pk_bf16_f32 v83, v30, v31
    v_mfma_f32_16x16x32_bf16 v[40:43], v[152:155], v[72:75], v[40:43]
    v_exp_f32 v32, v32
    v_mfma_f32_16x16x32_bf16 v[44:47], v[156:159], v[72:75], v[44:47]
    v_exp_f32 v33, v33
    v_exp_f32 v34, v34
    v_exp_f32 v35, v35
    v_cvt_pk_bf16_f32 v84, v32, v33
    v_cvt_pk_bf16_f32 v85, v34, v35
    v_mfma_f32_16x16x32_bf16 v[52:55], v[156:159], v[76:79], v[52:55]
    v_exp_f32 v36, v36
    v_mfma_f32_16x16x32_bf16 v[48:51], v[152:155], v[76:79], v[48:51]
    v_exp_f32 v37, v37
    v_exp_f32 v38, v38
    v_smfmac_f32_16x16x64_bf16 v[120:123], v[144:147], v[72:79], v3
    v_exp_f32 v39, v39
    v_cvt_pk_bf16_f32 v86, v36, v37
    v_cvt_pk_bf16_f32 v87, v38, v39
    v_mfma_f32_16x16x32_bf16 v[24:27], v[128:131], v[112:115], v[96:99]
    ds_read_b128 v[136:139], v2 offset:8192
    ds_read_b128 v[140:143], v2 offset:9216
    v_exp_f32 v8, v8
    v_mfma_f32_16x16x32_bf16 v[28:31], v[132:135], v[112:115], v[96:99]
    v_exp_f32 v9, v9
    v_exp_f32 v10, v10
    v_exp_f32 v11, v11
    v_cvt_pk_bf16_f32 v72, v8, v9
    v_cvt_pk_bf16_f32 v73, v10, v11
    v_mfma_f32_16x16x32_bf16 v[36:39], v[132:135], v[116:119], v[100:103]
    ds_read_b128 v[160:163], v2 offset:10240
    ds_read_b128 v[164:167], v2 offset:11264
    v_exp_f32 v12, v12
    v_mfma_f32_16x16x32_bf16 v[32:35], v[128:131], v[116:119], v[100:103]
    v_exp_f32 v13, v13
    v_exp_f32 v14, v14
    v_exp_f32 v15, v15
    v_cvt_pk_bf16_f32 v74, v12, v13
    v_cvt_pk_bf16_f32 v75, v14, v15
    v_mfma_f32_16x16x32_bf16 v[56:59], v[152:155], v[80:83], v[56:59]
    v_exp_f32 v16, v16
    v_mfma_f32_16x16x32_bf16 v[60:63], v[156:159], v[80:83], v[60:63]
    v_exp_f32 v17, v17
    v_exp_f32 v18, v18
    v_exp_f32 v19, v19
    v_cvt_pk_bf16_f32 v76, v16, v17
    v_cvt_pk_bf16_f32 v77, v18, v19
    v_mfma_f32_16x16x32_bf16 v[68:71], v[156:159], v[84:87], v[68:71]
    v_exp_f32 v20, v20
    v_mfma_f32_16x16x32_bf16 v[64:67], v[152:155], v[84:87], v[64:67]
    v_exp_f32 v21, v21
    v_exp_f32 v22, v22
    v_smfmac_f32_16x16x64_bf16 v[124:127], v[144:147], v[80:87], v3
    v_exp_f32 v23, v23
    v_cvt_pk_bf16_f32 v78, v20, v21
    v_cvt_pk_bf16_f32 v79, v22, v23
    s_waitcnt lgkmcnt(0)
    v_mfma_f32_16x16x32_bf16 v[8:11], v[136:139], v[104:107], v[88:91]
    v_exp_f32 v24, v24
    v_mfma_f32_16x16x32_bf16 v[12:15], v[140:143], v[104:107], v[88:91]
    v_exp_f32 v25, v25
    v_exp_f32 v26, v26
    v_exp_f32 v27, v27
    v_cvt_pk_bf16_f32 v80, v24, v25
    v_cvt_pk_bf16_f32 v81, v26, v27
    v_mfma_f32_16x16x32_bf16 v[20:23], v[140:143], v[108:111], v[92:95]
    v_exp_f32 v28, v28
    v_mfma_f32_16x16x32_bf16 v[16:19], v[136:139], v[108:111], v[92:95]
    v_exp_f32 v29, v29
    v_exp_f32 v30, v30
    v_exp_f32 v31, v31
    v_cvt_pk_bf16_f32 v82, v28, v29
    v_cvt_pk_bf16_f32 v83, v30, v31
    v_mfma_f32_16x16x32_bf16 v[40:43], v[160:163], v[72:75], v[40:43]
    v_exp_f32 v32, v32
    v_mfma_f32_16x16x32_bf16 v[44:47], v[164:167], v[72:75], v[44:47]
    v_exp_f32 v33, v33
    v_exp_f32 v34, v34
    v_exp_f32 v35, v35
    v_cvt_pk_bf16_f32 v84, v32, v33
    v_cvt_pk_bf16_f32 v85, v34, v35
    v_mfma_f32_16x16x32_bf16 v[52:55], v[164:167], v[76:79], v[52:55]
    v_exp_f32 v36, v36
    v_mfma_f32_16x16x32_bf16 v[48:51], v[160:163], v[76:79], v[48:51]
    v_exp_f32 v37, v37
    v_exp_f32 v38, v38
    v_smfmac_f32_16x16x64_bf16 v[120:123], v[144:147], v[72:79], v3
    v_exp_f32 v39, v39
    v_cvt_pk_bf16_f32 v86, v36, v37
    v_cvt_pk_bf16_f32 v87, v38, v39
    v_mfma_f32_16x16x32_bf16 v[24:27], v[136:139], v[112:115], v[96:99]
    ds_read_b128 v[128:131], v2 offset:12288
    ds_read_b128 v[132:135], v2 offset:13312
    v_exp_f32 v8, v8
    v_mfma_f32_16x16x32_bf16 v[28:31], v[140:143], v[112:115], v[96:99]
    v_exp_f32 v9, v9
    v_exp_f32 v10, v10
    v_exp_f32 v11, v11
    v_cvt_pk_bf16_f32 v72, v8, v9
    v_cvt_pk_bf16_f32 v73, v10, v11
    v_mfma_f32_16x16x32_bf16 v[36:39], v[140:143], v[116:119], v[100:103]
    ds_read_b128 v[152:155], v2 offset:14336
    ds_read_b128 v[156:159], v2 offset:15360
    v_exp_f32 v12, v12
    v_mfma_f32_16x16x32_bf16 v[32:35], v[136:139], v[116:119], v[100:103]
    v_exp_f32 v13, v13
    v_exp_f32 v14, v14
    v_exp_f32 v15, v15
    v_cvt_pk_bf16_f32 v74, v12, v13
    v_cvt_pk_bf16_f32 v75, v14, v15
    v_mfma_f32_16x16x32_bf16 v[56:59], v[160:163], v[80:83], v[56:59]
    v_exp_f32 v16, v16
    v_mfma_f32_16x16x32_bf16 v[60:63], v[164:167], v[80:83], v[60:63]
    v_exp_f32 v17, v17
    v_exp_f32 v18, v18
    v_exp_f32 v19, v19
    v_cvt_pk_bf16_f32 v76, v16, v17
    v_cvt_pk_bf16_f32 v77, v18, v19
    v_mfma_f32_16x16x32_bf16 v[68:71], v[164:167], v[84:87], v[68:71]
    v_exp_f32 v20, v20
    v_mfma_f32_16x16x32_bf16 v[64:67], v[160:163], v[84:87], v[64:67]
    v_exp_f32 v21, v21
    v_exp_f32 v22, v22
    v_smfmac_f32_16x16x64_bf16 v[124:127], v[144:147], v[80:87], v3
    v_exp_f32 v23, v23
    v_cvt_pk_bf16_f32 v78, v20, v21
    v_cvt_pk_bf16_f32 v79, v22, v23
    s_waitcnt lgkmcnt(0)
    v_mfma_f32_16x16x32_bf16 v[8:11], v[128:131], v[104:107], v[88:91]
    s_barrier
    v_exp_f32 v24, v24
    v_mfma_f32_16x16x32_bf16 v[12:15], v[132:135], v[104:107], v[88:91]
    v_exp_f32 v25, v25
    v_exp_f32 v26, v26
    v_exp_f32 v27, v27
    v_cvt_pk_bf16_f32 v80, v24, v25
    v_cvt_pk_bf16_f32 v81, v26, v27
    v_mfma_f32_16x16x32_bf16 v[20:23], v[132:135], v[108:111], v[92:95]
    v_exp_f32 v28, v28
    v_mfma_f32_16x16x32_bf16 v[16:19], v[128:131], v[108:111], v[92:95]
    v_exp_f32 v29, v29
    v_exp_f32 v30, v30
    v_exp_f32 v31, v31
    v_cvt_pk_bf16_f32 v82, v28, v29
    v_cvt_pk_bf16_f32 v83, v30, v31
    v_mfma_f32_16x16x32_bf16 v[40:43], v[152:155], v[72:75], v[40:43]
    v_exp_f32 v32, v32
    v_mfma_f32_16x16x32_bf16 v[44:47], v[156:159], v[72:75], v[44:47]
    v_exp_f32 v33, v33
    v_exp_f32 v34, v34
    v_exp_f32 v35, v35
    v_cvt_pk_bf16_f32 v84, v32, v33
    v_cvt_pk_bf16_f32 v85, v34, v35
    v_mfma_f32_16x16x32_bf16 v[52:55], v[156:159], v[76:79], v[52:55]
    v_exp_f32 v36, v36
    v_mfma_f32_16x16x32_bf16 v[48:51], v[152:155], v[76:79], v[48:51]
    v_exp_f32 v37, v37
    v_exp_f32 v38, v38
    v_smfmac_f32_16x16x64_bf16 v[120:123], v[144:147], v[72:79], v3
    v_exp_f32 v39, v39
    v_cvt_pk_bf16_f32 v86, v36, v37
    v_cvt_pk_bf16_f32 v87, v38, v39
    v_mfma_f32_16x16x32_bf16 v[24:27], v[128:131], v[112:115], v[96:99]
    ds_read_b128 v[136:139], v2 offset:16384
    ds_read_b128 v[140:143], v2 offset:17408
    v_exp_f32 v8, v8
    v_mfma_f32_16x16x32_bf16 v[28:31], v[132:135], v[112:115], v[96:99]
    v_exp_f32 v9, v9
    v_exp_f32 v10, v10
    v_exp_f32 v11, v11
    v_cvt_pk_bf16_f32 v72, v8, v9
    v_cvt_pk_bf16_f32 v73, v10, v11
    v_mfma_f32_16x16x32_bf16 v[36:39], v[132:135], v[116:119], v[100:103]
    ds_read_b128 v[160:163], v2 offset:18432
    ds_read_b128 v[164:167], v2 offset:19456
    v_exp_f32 v12, v12
    v_mfma_f32_16x16x32_bf16 v[32:35], v[128:131], v[116:119], v[100:103]
    v_exp_f32 v13, v13
    v_exp_f32 v14, v14
    v_exp_f32 v15, v15
    v_cvt_pk_bf16_f32 v74, v12, v13
    v_cvt_pk_bf16_f32 v75, v14, v15
    v_mfma_f32_16x16x32_bf16 v[56:59], v[152:155], v[80:83], v[56:59]
    v_exp_f32 v16, v16
    v_mfma_f32_16x16x32_bf16 v[60:63], v[156:159], v[80:83], v[60:63]
    v_exp_f32 v17, v17
    v_exp_f32 v18, v18
    v_exp_f32 v19, v19
    v_cvt_pk_bf16_f32 v76, v16, v17
    v_cvt_pk_bf16_f32 v77, v18, v19
    v_mfma_f32_16x16x32_bf16 v[68:71], v[156:159], v[84:87], v[68:71]
    v_exp_f32 v20, v20
    v_mfma_f32_16x16x32_bf16 v[64:67], v[152:155], v[84:87], v[64:67]
    v_exp_f32 v21, v21
    v_exp_f32 v22, v22
    v_smfmac_f32_16x16x64_bf16 v[124:127], v[144:147], v[80:87], v3
    v_exp_f32 v23, v23
    v_cvt_pk_bf16_f32 v78, v20, v21
    v_cvt_pk_bf16_f32 v79, v22, v23
    s_waitcnt lgkmcnt(0)
    v_mfma_f32_16x16x32_bf16 v[8:11], v[136:139], v[104:107], v[88:91]
    v_exp_f32 v24, v24
    v_mfma_f32_16x16x32_bf16 v[12:15], v[140:143], v[104:107], v[88:91]
    v_exp_f32 v25, v25
    v_exp_f32 v26, v26
    v_exp_f32 v27, v27
    v_cvt_pk_bf16_f32 v80, v24, v25
    v_cvt_pk_bf16_f32 v81, v26, v27
    v_mfma_f32_16x16x32_bf16 v[20:23], v[140:143], v[108:111], v[92:95]
    v_exp_f32 v28, v28
    v_mfma_f32_16x16x32_bf16 v[16:19], v[136:139], v[108:111], v[92:95]
    v_exp_f32 v29, v29
    v_exp_f32 v30, v30
    v_exp_f32 v31, v31
    v_cvt_pk_bf16_f32 v82, v28, v29
    v_cvt_pk_bf16_f32 v83, v30, v31
    v_mfma_f32_16x16x32_bf16 v[40:43], v[160:163], v[72:75], v[40:43]
    v_exp_f32 v32, v32
    v_mfma_f32_16x16x32_bf16 v[44:47], v[164:167], v[72:75], v[44:47]
    v_exp_f32 v33, v33
    v_exp_f32 v34, v34
    v_exp_f32 v35, v35
    v_cvt_pk_bf16_f32 v84, v32, v33
    v_cvt_pk_bf16_f32 v85, v34, v35
    v_mfma_f32_16x16x32_bf16 v[52:55], v[164:167], v[76:79], v[52:55]
    v_exp_f32 v36, v36
    v_mfma_f32_16x16x32_bf16 v[48:51], v[160:163], v[76:79], v[48:51]
    v_exp_f32 v37, v37
    v_exp_f32 v38, v38
    v_smfmac_f32_16x16x64_bf16 v[120:123], v[144:147], v[72:79], v3
    v_exp_f32 v39, v39
    v_cvt_pk_bf16_f32 v86, v36, v37
    v_cvt_pk_bf16_f32 v87, v38, v39
    v_mfma_f32_16x16x32_bf16 v[24:27], v[136:139], v[112:115], v[96:99]
    ds_read_b128 v[128:131], v2 offset:20480
    ds_read_b128 v[132:135], v2 offset:21504
    v_exp_f32 v8, v8
    v_mfma_f32_16x16x32_bf16 v[28:31], v[140:143], v[112:115], v[96:99]
    v_exp_f32 v9, v9
    v_exp_f32 v10, v10
    v_exp_f32 v11, v11
    v_cvt_pk_bf16_f32 v72, v8, v9
    v_cvt_pk_bf16_f32 v73, v10, v11
    v_mfma_f32_16x16x32_bf16 v[36:39], v[140:143], v[116:119], v[100:103]
    ds_read_b128 v[152:155], v2 offset:22528
    ds_read_b128 v[156:159], v2 offset:23552
    v_exp_f32 v12, v12
    v_mfma_f32_16x16x32_bf16 v[32:35], v[136:139], v[116:119], v[100:103]
    v_exp_f32 v13, v13
    v_exp_f32 v14, v14
    v_exp_f32 v15, v15
    v_cvt_pk_bf16_f32 v74, v12, v13
    v_cvt_pk_bf16_f32 v75, v14, v15
    v_mfma_f32_16x16x32_bf16 v[56:59], v[160:163], v[80:83], v[56:59]
    v_exp_f32 v16, v16
    v_mfma_f32_16x16x32_bf16 v[60:63], v[164:167], v[80:83], v[60:63]
    v_exp_f32 v17, v17
    v_exp_f32 v18, v18
    v_exp_f32 v19, v19
    v_cvt_pk_bf16_f32 v76, v16, v17
    v_cvt_pk_bf16_f32 v77, v18, v19
    v_mfma_f32_16x16x32_bf16 v[68:71], v[164:167], v[84:87], v[68:71]
    v_exp_f32 v20, v20
    v_mfma_f32_16x16x32_bf16 v[64:67], v[160:163], v[84:87], v[64:67]
    v_exp_f32 v21, v21
    v_exp_f32 v22, v22
    v_smfmac_f32_16x16x64_bf16 v[124:127], v[144:147], v[80:87], v3
    v_exp_f32 v23, v23
    v_cvt_pk_bf16_f32 v78, v20, v21
    v_cvt_pk_bf16_f32 v79, v22, v23
    s_waitcnt lgkmcnt(0)
    v_mfma_f32_16x16x32_bf16 v[8:11], v[128:131], v[104:107], v[88:91]
    s_barrier
    v_exp_f32 v24, v24
    v_mfma_f32_16x16x32_bf16 v[12:15], v[132:135], v[104:107], v[88:91]
    v_exp_f32 v25, v25
    v_exp_f32 v26, v26
    v_exp_f32 v27, v27
    v_cvt_pk_bf16_f32 v80, v24, v25
    v_cvt_pk_bf16_f32 v81, v26, v27
    v_mfma_f32_16x16x32_bf16 v[20:23], v[132:135], v[108:111], v[92:95]
    v_exp_f32 v28, v28
    v_mfma_f32_16x16x32_bf16 v[16:19], v[128:131], v[108:111], v[92:95]
    v_exp_f32 v29, v29
    v_exp_f32 v30, v30
    v_exp_f32 v31, v31
    v_cvt_pk_bf16_f32 v82, v28, v29
    v_cvt_pk_bf16_f32 v83, v30, v31
    v_mfma_f32_16x16x32_bf16 v[40:43], v[152:155], v[72:75], v[40:43]
    v_exp_f32 v32, v32
    v_mfma_f32_16x16x32_bf16 v[44:47], v[156:159], v[72:75], v[44:47]
    v_exp_f32 v33, v33
    v_exp_f32 v34, v34
    v_exp_f32 v35, v35
    v_cvt_pk_bf16_f32 v84, v32, v33
    v_cvt_pk_bf16_f32 v85, v34, v35
    v_mfma_f32_16x16x32_bf16 v[52:55], v[156:159], v[76:79], v[52:55]
    v_exp_f32 v36, v36
    v_mfma_f32_16x16x32_bf16 v[48:51], v[152:155], v[76:79], v[48:51]
    v_exp_f32 v37, v37
    v_exp_f32 v38, v38
    v_smfmac_f32_16x16x64_bf16 v[120:123], v[144:147], v[72:79], v3
    v_exp_f32 v39, v39
    v_cvt_pk_bf16_f32 v86, v36, v37
    v_cvt_pk_bf16_f32 v87, v38, v39
    v_mfma_f32_16x16x32_bf16 v[24:27], v[128:131], v[112:115], v[96:99]
    ds_read_b128 v[136:139], v2 offset:24576
    ds_read_b128 v[140:143], v2 offset:25600
    v_exp_f32 v8, v8
    v_mfma_f32_16x16x32_bf16 v[28:31], v[132:135], v[112:115], v[96:99]
    v_exp_f32 v9, v9
    v_exp_f32 v10, v10
    v_exp_f32 v11, v11
    v_cvt_pk_bf16_f32 v72, v8, v9
    v_cvt_pk_bf16_f32 v73, v10, v11
    v_mfma_f32_16x16x32_bf16 v[36:39], v[132:135], v[116:119], v[100:103]
    ds_read_b128 v[160:163], v2 offset:26624
    ds_read_b128 v[164:167], v2 offset:27648
    v_exp_f32 v12, v12
    v_mfma_f32_16x16x32_bf16 v[32:35], v[128:131], v[116:119], v[100:103]
    v_exp_f32 v13, v13
    v_exp_f32 v14, v14
    v_exp_f32 v15, v15
    v_cvt_pk_bf16_f32 v74, v12, v13
    v_cvt_pk_bf16_f32 v75, v14, v15
    v_mfma_f32_16x16x32_bf16 v[56:59], v[152:155], v[80:83], v[56:59]
    v_exp_f32 v16, v16
    v_mfma_f32_16x16x32_bf16 v[60:63], v[156:159], v[80:83], v[60:63]
    v_exp_f32 v17, v17
    v_exp_f32 v18, v18
    v_exp_f32 v19, v19
    v_cvt_pk_bf16_f32 v76, v16, v17
    v_cvt_pk_bf16_f32 v77, v18, v19
    v_mfma_f32_16x16x32_bf16 v[68:71], v[156:159], v[84:87], v[68:71]
    v_exp_f32 v20, v20
    v_mfma_f32_16x16x32_bf16 v[64:67], v[152:155], v[84:87], v[64:67]
    v_exp_f32 v21, v21
    v_exp_f32 v22, v22
    v_smfmac_f32_16x16x64_bf16 v[124:127], v[144:147], v[80:87], v3
    v_exp_f32 v23, v23
    v_cvt_pk_bf16_f32 v78, v20, v21
    v_cvt_pk_bf16_f32 v79, v22, v23
    s_waitcnt lgkmcnt(0)
    v_mfma_f32_16x16x32_bf16 v[8:11], v[136:139], v[104:107], v[88:91]
    v_exp_f32 v24, v24
    v_mfma_f32_16x16x32_bf16 v[12:15], v[140:143], v[104:107], v[88:91]
    v_exp_f32 v25, v25
    v_exp_f32 v26, v26
    v_exp_f32 v27, v27
    v_cvt_pk_bf16_f32 v80, v24, v25
    v_cvt_pk_bf16_f32 v81, v26, v27
    v_mfma_f32_16x16x32_bf16 v[20:23], v[140:143], v[108:111], v[92:95]
    s_sub_u32 s47, s47, 1
    v_exp_f32 v28, v28
    v_mfma_f32_16x16x32_bf16 v[16:19], v[136:139], v[108:111], v[92:95]
    v_exp_f32 v29, v29
    v_exp_f32 v30, v30
    v_exp_f32 v31, v31
    v_cvt_pk_bf16_f32 v82, v28, v29
    v_cvt_pk_bf16_f32 v83, v30, v31
    v_mfma_f32_16x16x32_bf16 v[40:43], v[160:163], v[72:75], v[40:43]
    s_cmp_lg_u32 s47, 0
    v_exp_f32 v32, v32
    v_mfma_f32_16x16x32_bf16 v[44:47], v[164:167], v[72:75], v[44:47]
    v_exp_f32 v33, v33
    v_exp_f32 v34, v34
    v_exp_f32 v35, v35
    v_cvt_pk_bf16_f32 v84, v32, v33
    v_cvt_pk_bf16_f32 v85, v34, v35
    v_mfma_f32_16x16x32_bf16 v[52:55], v[164:167], v[76:79], v[52:55]
    v_exp_f32 v36, v36
    v_mfma_f32_16x16x32_bf16 v[48:51], v[160:163], v[76:79], v[48:51]
    v_exp_f32 v37, v37
    v_exp_f32 v38, v38
    v_smfmac_f32_16x16x64_bf16 v[120:123], v[144:147], v[72:79], v3
    v_exp_f32 v39, v39
    v_cvt_pk_bf16_f32 v86, v36, v37
    v_cvt_pk_bf16_f32 v87, v38, v39
    v_mfma_f32_16x16x32_bf16 v[24:27], v[136:139], v[112:115], v[96:99]
    ds_read_b128 v[128:131], v2 offset:28672
    ds_read_b128 v[132:135], v2 offset:29696
    v_exp_f32 v8, v8
    v_mfma_f32_16x16x32_bf16 v[28:31], v[140:143], v[112:115], v[96:99]
    v_exp_f32 v9, v9
    v_exp_f32 v10, v10
    v_exp_f32 v11, v11
    v_cvt_pk_bf16_f32 v72, v8, v9
    v_cvt_pk_bf16_f32 v73, v10, v11
    v_mfma_f32_16x16x32_bf16 v[36:39], v[140:143], v[116:119], v[100:103]
    ds_read_b128 v[152:155], v2 offset:30720
    ds_read_b128 v[156:159], v2 offset:31744
    v_exp_f32 v12, v12
    v_mfma_f32_16x16x32_bf16 v[32:35], v[136:139], v[116:119], v[100:103]
    v_exp_f32 v13, v13
    v_exp_f32 v14, v14
    v_exp_f32 v15, v15
    v_cvt_pk_bf16_f32 v74, v12, v13
    v_cvt_pk_bf16_f32 v75, v14, v15
    v_mfma_f32_16x16x32_bf16 v[56:59], v[160:163], v[80:83], v[56:59]
    v_exp_f32 v16, v16
    v_mfma_f32_16x16x32_bf16 v[60:63], v[164:167], v[80:83], v[60:63]
    v_exp_f32 v17, v17
    v_exp_f32 v18, v18
    v_exp_f32 v19, v19
    v_cvt_pk_bf16_f32 v76, v16, v17
    v_cvt_pk_bf16_f32 v77, v18, v19
    v_mfma_f32_16x16x32_bf16 v[68:71], v[164:167], v[84:87], v[68:71]
    v_exp_f32 v20, v20
    v_mfma_f32_16x16x32_bf16 v[64:67], v[160:163], v[84:87], v[64:67]
    v_exp_f32 v21, v21
    v_exp_f32 v22, v22
    v_smfmac_f32_16x16x64_bf16 v[124:127], v[144:147], v[80:87], v3
    v_exp_f32 v23, v23
    v_cvt_pk_bf16_f32 v78, v20, v21
    v_cvt_pk_bf16_f32 v79, v22, v23
    s_waitcnt lgkmcnt(0)
    v_mfma_f32_16x16x32_bf16 v[8:11], v[128:131], v[104:107], v[88:91]
    s_barrier
    v_exp_f32 v24, v24
    v_mfma_f32_16x16x32_bf16 v[12:15], v[132:135], v[104:107], v[88:91]
    v_exp_f32 v25, v25
    v_exp_f32 v26, v26
    v_exp_f32 v27, v27
    v_cvt_pk_bf16_f32 v80, v24, v25
    v_cvt_pk_bf16_f32 v81, v26, v27
    v_mfma_f32_16x16x32_bf16 v[20:23], v[132:135], v[108:111], v[92:95]
    v_exp_f32 v28, v28
    v_mfma_f32_16x16x32_bf16 v[16:19], v[128:131], v[108:111], v[92:95]
    v_exp_f32 v29, v29
    v_exp_f32 v30, v30
    v_exp_f32 v31, v31
    v_cvt_pk_bf16_f32 v82, v28, v29
    v_cvt_pk_bf16_f32 v83, v30, v31
    v_mfma_f32_16x16x32_bf16 v[40:43], v[152:155], v[72:75], v[40:43]
    v_exp_f32 v32, v32
    v_mfma_f32_16x16x32_bf16 v[44:47], v[156:159], v[72:75], v[44:47]
    v_exp_f32 v33, v33
    v_exp_f32 v34, v34
    v_exp_f32 v35, v35
    v_cvt_pk_bf16_f32 v84, v32, v33
    v_cvt_pk_bf16_f32 v85, v34, v35
    v_mfma_f32_16x16x32_bf16 v[52:55], v[156:159], v[76:79], v[52:55]
    v_exp_f32 v36, v36
    v_mfma_f32_16x16x32_bf16 v[48:51], v[152:155], v[76:79], v[48:51]
    v_exp_f32 v37, v37
    v_exp_f32 v38, v38
    v_smfmac_f32_16x16x64_bf16 v[120:123], v[144:147], v[72:79], v3
    v_exp_f32 v39, v39
    v_cvt_pk_bf16_f32 v86, v36, v37
    v_cvt_pk_bf16_f32 v87, v38, v39
    s_cbranch_scc1 att_loop1
    s_nop 0
    v_smfmac_f32_16x16x64_bf16 v[124:127], v[144:147], v[80:87], v3
    s_nop 1
    v_add_f32 v120, v120, v121
    v_add_f32 v122, v122, v123
    v_mov_b32 v121, v120
    v_mfma_f32_16x16x32_bf16 v[56:59], v[152:155], v[80:83], v[56:59]
    s_lshl_b32 s45, s42, 17
    v_mov_b32 v123, v122
    v_permlane16_swap_b32 v120, v121
    v_mfma_f32_16x16x32_bf16 v[60:63], v[156:159], v[80:83], v[60:63]
    s_lshl_b32 s43, s40, 11
    v_permlane16_swap_b32 v122, v123
    v_mov_b32 v121, v120
    v_mov_b32 v123, v122
    v_mfma_f32_16x16x32_bf16 v[68:71], v[156:159], v[84:87], v[68:71]
    s_add_u32 s45, s45, s43
    v_permlane32_swap_b32 v120, v121
    v_permlane32_swap_b32 v122, v123
    v_mfma_f32_16x16x32_bf16 v[64:67], v[152:155], v[84:87], v[64:67]
    s_add_u32 s45, s45, 12582912
    v_rcp_f32 v121, v120
    v_rcp_f32 v123, v122
    v_add_u32 v1, 0x10000, v0
    v_mul_f32 v40, v121, v40
    v_mul_f32 v41, v121, v41
    v_mul_f32 v42, v121, v42
    v_mul_f32 v43, v121, v43
    v_mul_f32 v44, v121, v44
    v_mul_f32 v45, v121, v45
    v_mul_f32 v46, v121, v46
    v_mul_f32 v47, v121, v47
    v_cvt_pk_bf16_f32 v72, v40, v41
    v_cvt_pk_bf16_f32 v73, v42, v43
    v_cvt_pk_bf16_f32 v74, v44, v45
    v_cvt_pk_bf16_f32 v75, v46, v47
    v_mul_f32 v48, v123, v48
    v_mul_f32 v49, v123, v49
    v_mul_f32 v50, v123, v50
    v_mul_f32 v51, v123, v51
    v_mul_f32 v52, v123, v52
    v_mul_f32 v53, v123, v53
    v_mul_f32 v54, v123, v54
    v_mul_f32 v55, v123, v55
    v_permlane16_swap_b32 v72, v74
    v_permlane16_swap_b32 v73, v75
    v_cvt_pk_bf16_f32 v76, v48, v49
    v_cvt_pk_bf16_f32 v77, v50, v51
    buffer_store_dwordx4 v[72:75], v0, s[36:39], s45 offen sc1
    v_cvt_pk_bf16_f32 v78, v52, v53
    v_cvt_pk_bf16_f32 v79, v54, v55
    s_nop 0
    v_permlane16_swap_b32 v76, v78
    v_permlane16_swap_b32 v77, v79
    buffer_store_dwordx4 v[76:79], v0, s[36:39], s45 offen offset:256 sc1
    v_add_f32 v124, v124, v125
    v_add_f32 v126, v126, v127
    v_mov_b32 v125, v124
    v_mov_b32 v127, v126
    s_nop 0
    v_permlane16_swap_b32 v124, v125
    v_permlane16_swap_b32 v126, v127
    v_mov_b32 v125, v124
    v_mov_b32 v127, v126
    s_nop 0
    v_permlane32_swap_b32 v124, v125
    v_permlane32_swap_b32 v126, v127
    v_rcp_f32 v125, v124
    v_rcp_f32 v127, v126
    v_mul_f32 v56, v125, v56
    v_mul_f32 v57, v125, v57
    v_mul_f32 v58, v125, v58
    v_mul_f32 v59, v125, v59
    v_mul_f32 v60, v125, v60
    v_mul_f32 v61, v125, v61
    v_mul_f32 v62, v125, v62
    v_mul_f32 v63, v125, v63
    v_cvt_pk_bf16_f32 v80, v56, v57
    v_cvt_pk_bf16_f32 v81, v58, v59
    v_cvt_pk_bf16_f32 v82, v60, v61
    v_cvt_pk_bf16_f32 v83, v62, v63
    v_mul_f32 v64, v127, v64
    v_mul_f32 v65, v127, v65
    v_mul_f32 v66, v127, v66
    v_mul_f32 v67, v127, v67
    v_mul_f32 v68, v127, v68
    v_mul_f32 v69, v127, v69
    v_mul_f32 v70, v127, v70
    v_mul_f32 v71, v127, v71
    v_permlane16_swap_b32 v80, v82
    v_permlane16_swap_b32 v81, v83
    v_cvt_pk_bf16_f32 v84, v64, v65
    v_cvt_pk_bf16_f32 v85, v66, v67
    buffer_store_dwordx4 v[80:83], v1, s[36:39], s45 offen sc1
    v_cvt_pk_bf16_f32 v86, v68, v69
    v_cvt_pk_bf16_f32 v87, v70, v71
    s_nop 0
    v_permlane16_swap_b32 v84, v86
    s_barrier
    v_permlane16_swap_b32 v85, v87
    buffer_store_dwordx4 v[84:87], v1, s[36:39], s45 offen offset:256 sc1
    s_setprio 0
    v_max_f32 v8, v120, v122
    v_max3_f32 v8, v8, v124, v126
    v_mul_f32 v9, 0, v120
    v_mul_f32 v13, 0, v124
    v_fmac_f32 v9, 0, v122
    v_fmac_f32 v13, 0, v126
    v_fmac_f32 v9, 0, v40
    v_fmac_f32 v13, 0, v56
    v_fmac_f32 v9, 0, v41
    v_fmac_f32 v13, 0, v57
    v_fmac_f32 v9, 0, v42
    v_fmac_f32 v13, 0, v58
    v_fmac_f32 v9, 0, v43
    v_fmac_f32 v13, 0, v59
    v_fmac_f32 v9, 0, v44
    v_fmac_f32 v13, 0, v60
    v_fmac_f32 v9, 0, v45
    v_fmac_f32 v13, 0, v61
    v_fmac_f32 v9, 0, v46
    v_fmac_f32 v13, 0, v62
    v_fmac_f32 v9, 0, v47
    v_fmac_f32 v13, 0, v63
    v_fmac_f32 v9, 0, v48
    v_fmac_f32 v13, 0, v64
    v_fmac_f32 v9, 0, v49
    v_fmac_f32 v13, 0, v65
    v_fmac_f32 v9, 0, v50
    v_fmac_f32 v13, 0, v66
    v_fmac_f32 v9, 0, v51
    v_fmac_f32 v13, 0, v67
    v_fmac_f32 v9, 0, v52
    v_fmac_f32 v13, 0, v68
    v_fmac_f32 v9, 0, v53
    v_fmac_f32 v13, 0, v69
    v_fmac_f32 v9, 0, v54
    v_fmac_f32 v13, 0, v70
    v_fmac_f32 v9, 0, v55
    v_fmac_f32 v13, 0, v71
    v_add_f32 v8, v8, v9
    v_add_f32 v8, v8, v13
    v_cmp_ngt_f32 vcc, 0x7b800000, v8
    s_cbranch_vccnz att_fallback
att_end:
    s_barrier
    s_waitcnt vmcnt(0)
    buffer_store_dword v6, off, s[36:39], s52 sc1
    s_barrier
    s_barrier
    s_endpgm
att_fallback:
    s_mov_b32 s45, s44
    s_mov_b32 s47, 0
    v_subrev_u32 v2, s41, v2
    v_mov_b32 v88, 0xff800000
    v_mov_b32 v89, 0xff800000
    v_mov_b32 v90, 0xff800000
    v_mov_b32 v91, 0xff800000
att_fb1:
    buffer_load_dwordx4 v[128:131], v2, s[36:39], s45 offen offset:0 sc1
    buffer_load_dwordx4 v[132:135], v2, s[36:39], s45 offen offset:1024 sc1
    s_waitcnt vmcnt(0)
    v_mfma_f32_16x16x32_bf16 v[8:11], v[128:131], v[104:107], 0
    v_mfma_f32_16x16x32_bf16 v[12:15], v[132:135], v[104:107], 0
    v_mfma_f32_16x16x32_bf16 v[20:23], v[132:135], v[108:111], 0
    v_mfma_f32_16x16x32_bf16 v[16:19], v[128:131], v[108:111], 0
    v_mfma_f32_16x16x32_bf16 v[24:27], v[128:131], v[112:115], 0
    v_mfma_f32_16x16x32_bf16 v[28:31], v[132:135], v[112:115], 0
    v_mfma_f32_16x16x32_bf16 v[36:39], v[132:135], v[116:119], 0
    v_mfma_f32_16x16x32_bf16 v[32:35], v[128:131], v[116:119], 0
    s_nop 0
    v_max3_f32 v88, v88, v8, v9
    v_max3_f32 v88, v88, v10, v11
    v_max3_f32 v88, v88, v12, v13
    v_max3_f32 v88, v88, v14, v15
    v_max3_f32 v89, v89, v16, v17
    v_max3_f32 v89, v89, v18, v19
    v_max3_f32 v89, v89, v20, v21
    v_max3_f32 v89, v89, v22, v23
    v_max3_f32 v90, v90, v24, v25
    v_max3_f32 v90, v90, v26, v27
    v_max3_f32 v90, v90, v28, v29
    v_max3_f32 v90, v90, v30, v31
    v_max3_f32 v91, v91, v32, v33
    v_max3_f32 v91, v91, v34, v35
    v_max3_f32 v91, v91, v36, v37
    v_max3_f32 v91, v91, v38, v39
    s_add_u32 s45, s45, 4096
    s_add_u32 s47, s47, 1
    s_cmp_lt_u32 s47, 64
    s_cbranch_scc1 att_fb1
    v_permlane32_swap_b32 v88, v89
    v_permlane32_swap_b32 v90, v91
    v_max_f32 v88, v88, v89
    v_max_f32 v90, v90, v91
    s_nop 1
    v_permlane16_swap_b32 v88, v90
    v_max_f32 v88, v88, v90
    v_mov_b32 v90, v88
    s_nop 1
    v_permlane16_swap_b32 v88, v90
    v_mov_b32 v89, v88
    v_mov_b32 v91, v90
    s_nop 0
    v_permlane32_swap_b32 v88, v89
    v_permlane32_swap_b32 v90, v91
    v_mov_b32 v40, 0
    v_mov_b32 v41, 0
    v_mov_b32 v42, 0
    v_mov_b32 v43, 0
    v_mov_b32 v44, 0
    v_mov_b32 v45, 0
    v_mov_b32 v46, 0
    v_mov_b32 v47, 0
    v_mov_b32 v48, 0
    v_mov_b32 v49, 0
    v_mov_b32 v50, 0
    v_mov_b32 v51, 0
    v_mov_b32 v52, 0
    v_mov_b32 v53, 0
    v_mov_b32 v54, 0
    v_mov_b32 v55, 0
    v_mov_b32 v120, 0
    v_mov_b32 v121, 0
    v_mov_b32 v122, 0
    v_mov_b32 v123, 0
    v_mov_b32 v56, 0
    v_mov_b32 v57, 0
    v_mov_b32 v58, 0
    v_mov_b32 v59, 0
    v_mov_b32 v60, 0
    v_mov_b32 v61, 0
    v_mov_b32 v62, 0
    v_mov_b32 v63, 0
    v_mov_b32 v64, 0
    v_mov_b32 v65, 0
    v_mov_b32 v66, 0
    v_mov_b32 v67, 0
    v_mov_b32 v68, 0
    v_mov_b32 v69, 0
    v_mov_b32 v70, 0
    v_mov_b32 v71, 0
    v_mov_b32 v124, 0
    v_mov_b32 v125, 0
    v_mov_b32 v126, 0
    v_mov_b32 v127, 0
    s_mov_b32 s45, s44
    s_mov_b32 s47, 0
att_fb2:
    buffer_load_dwordx4 v[128:131], v2, s[36:39], s45 offen offset:0 sc1
    buffer_load_dwordx4 v[152:155], v2, s[36:39], s45 offen offset:2048 sc1
    buffer_load_dwordx4 v[132:135], v2, s[36:39], s45 offen offset:1024 sc1
    buffer_load_dwordx4 v[156:159], v2, s[36:39], s45 offen offset:3072 sc1
    s_waitcnt vmcnt(0)
    v_mfma_f32_16x16x32_bf16 v[8:11], v[128:131], v[104:107], 0
    v_mfma_f32_16x16x32_bf16 v[12:15], v[132:135], v[104:107], 0
    v_mfma_f32_16x16x32_bf16 v[20:23], v[132:135], v[108:111], 0
    v_mfma_f32_16x16x32_bf16 v[16:19], v[128:131], v[108:111], 0
    v_mfma_f32_16x16x32_bf16 v[24:27], v[128:131], v[112:115], 0
    v_mfma_f32_16x16x32_bf16 v[28:31], v[132:135], v[112:115], 0
    v_mfma_f32_16x16x32_bf16 v[36:39], v[132:135], v[116:119], 0
    v_mfma_f32_16x16x32_bf16 v[32:35], v[128:131], v[116:119], 0
    s_nop 0
    v_sub_f32 v8, v8, v88
    v_sub_f32 v9, v9, v88
    v_sub_f32 v10, v10, v88
    v_sub_f32 v11, v11, v88
    v_sub_f32 v12, v12, v88
    v_sub_f32 v13, v13, v88
    v_sub_f32 v14, v14, v88
    v_sub_f32 v15, v15, v88
    v_sub_f32 v16, v16, v89
    v_sub_f32 v17, v17, v89
    v_sub_f32 v18, v18, v89
    v_sub_f32 v19, v19, v89
    v_sub_f32 v20, v20, v89
    v_sub_f32 v21, v21, v89
    v_sub_f32 v22, v22, v89
    v_sub_f32 v23, v23, v89
    v_exp_f32 v8, v8
    v_exp_f32 v9, v9
    v_exp_f32 v10, v10
    v_exp_f32 v11, v11
    v_cvt_pk_bf16_f32 v72, v8, v9
    v_cvt_pk_bf16_f32 v73, v10, v11
    v_exp_f32 v12, v12
    v_exp_f32 v13, v13
    v_exp_f32 v14, v14
    v_exp_f32 v15, v15
    v_cvt_pk_bf16_f32 v74, v12, v13
    v_cvt_pk_bf16_f32 v75, v14, v15
    v_exp_f32 v16, v16
    v_exp_f32 v17, v17
    v_exp_f32 v18, v18
    v_exp_f32 v19, v19
    v_cvt_pk_bf16_f32 v76, v16, v17
    v_cvt_pk_bf16_f32 v77, v18, v19
    v_exp_f32 v20, v20
    v_exp_f32 v21, v21
    v_exp_f32 v22, v22
    v_exp_f32 v23, v23
    v_cvt_pk_bf16_f32 v78, v20, v21
    v_cvt_pk_bf16_f32 v79, v22, v23
    v_mfma_f32_16x16x32_bf16 v[40:43], v[152:155], v[72:75], v[40:43]
    v_mfma_f32_16x16x32_bf16 v[44:47], v[156:159], v[72:75], v[44:47]
    v_mfma_f32_16x16x32_bf16 v[52:55], v[156:159], v[76:79], v[52:55]
    v_mfma_f32_16x16x32_bf16 v[48:51], v[152:155], v[76:79], v[48:51]
    v_smfmac_f32_16x16x64_bf16 v[120:123], v[144:147], v[72:79], v3
    v_sub_f32 v24, v24, v90
    v_sub_f32 v25, v25, v90
    v_sub_f32 v26, v26, v90
    v_sub_f32 v27, v27, v90
    v_sub_f32 v28, v28, v90
    v_sub_f32 v29, v29, v90
    v_sub_f32 v30, v30, v90
    v_sub_f32 v31, v31, v90
    v_sub_f32 v32, v32, v91
    v_sub_f32 v33, v33, v91
    v_sub_f32 v34, v34, v91
    v_sub_f32 v35, v35, v91
    v_sub_f32 v36, v36, v91
    v_sub_f32 v37, v37, v91
    v_sub_f32 v38, v38, v91
    v_sub_f32 v39, v39, v91
    v_exp_f32 v24, v24
    v_exp_f32 v25, v25
    v_exp_f32 v26, v26
    v_exp_f32 v27, v27
    v_cvt_pk_bf16_f32 v80, v24, v25
    v_cvt_pk_bf16_f32 v81, v26, v27
    v_exp_f32 v28, v28
    v_exp_f32 v29, v29
    v_exp_f32 v30, v30
    v_exp_f32 v31, v31
    v_cvt_pk_bf16_f32 v82, v28, v29
    v_cvt_pk_bf16_f32 v83, v30, v31
    v_exp_f32 v32, v32
    v_exp_f32 v33, v33
    v_exp_f32 v34, v34
    v_exp_f32 v35, v35
    v_cvt_pk_bf16_f32 v84, v32, v33
    v_cvt_pk_bf16_f32 v85, v34, v35
    v_exp_f32 v36, v36
    v_exp_f32 v37, v37
    v_exp_f32 v38, v38
    v_exp_f32 v39, v39
    v_cvt_pk_bf16_f32 v86, v36, v37
    v_cvt_pk_bf16_f32 v87, v38, v39
    v_mfma_f32_16x16x32_bf16 v[56:59], v[152:155], v[80:83], v[56:59]
    v_mfma_f32_16x16x32_bf16 v[60:63], v[156:159], v[80:83], v[60:63]
    v_mfma_f32_16x16x32_bf16 v[68:71], v[156:159], v[84:87], v[68:71]
    v_mfma_f32_16x16x32_bf16 v[64:67], v[152:155], v[84:87], v[64:67]
    v_smfmac_f32_16x16x64_bf16 v[124:127], v[144:147], v[80:87], v3
    s_add_u32 s45, s45, 4096
    s_add_u32 s47, s47, 1
    s_cmp_lt_u32 s47, 64
    s_cbranch_scc1 att_fb2
    s_lshl_b32 s45, s42, 17
    s_lshl_b32 s43, s40, 11
    s_add_u32 s45, s45, s43
    s_add_u32 s45, s45, 12582912
    v_add_u32 v1, 0x10000, v0
    v_add_f32 v120, v120, v121
    v_add_f32 v122, v122, v123
    v_mov_b32 v121, v120
    v_mov_b32 v123, v122
    s_nop 0
    v_permlane16_swap_b32 v120, v121
    v_permlane16_swap_b32 v122, v123
    v_mov_b32 v121, v120
    v_mov_b32 v123, v122
    s_nop 0
    v_permlane32_swap_b32 v120, v121
    v_permlane32_swap_b32 v122, v123
    v_rcp_f32 v121, v120
    v_rcp_f32 v123, v122
    v_mul_f32 v40, v121, v40
    v_mul_f32 v41, v121, v41
    v_mul_f32 v42, v121, v42
    v_mul_f32 v43, v121, v43
    v_mul_f32 v44, v121, v44
    v_mul_f32 v45, v121, v45
    v_mul_f32 v46, v121, v46
    v_mul_f32 v47, v121, v47
    v_cvt_pk_bf16_f32 v72, v40, v41
    v_cvt_pk_bf16_f32 v73, v42, v43
    v_cvt_pk_bf16_f32 v74, v44, v45
    v_cvt_pk_bf16_f32 v75, v46, v47
    v_mul_f32 v48, v123, v48
    v_mul_f32 v49, v123, v49
    v_mul_f32 v50, v123, v50
    v_mul_f32 v51, v123, v51
    v_mul_f32 v52, v123, v52
    v_mul_f32 v53, v123, v53
    v_mul_f32 v54, v123, v54
    v_mul_f32 v55, v123, v55
    v_permlane16_swap_b32 v72, v74
    v_permlane16_swap_b32 v73, v75
    v_cvt_pk_bf16_f32 v76, v48, v49
    v_cvt_pk_bf16_f32 v77, v50, v51
    buffer_store_dwordx4 v[72:75], v0, s[36:39], s45 offen sc1
    v_cvt_pk_bf16_f32 v78, v52, v53
    v_cvt_pk_bf16_f32 v79, v54, v55
    s_nop 0
    v_permlane16_swap_b32 v76, v78
    v_permlane16_swap_b32 v77, v79
    buffer_store_dwordx4 v[76:79], v0, s[36:39], s45 offen offset:256 sc1
    v_add_f32 v124, v124, v125
    v_add_f32 v126, v126, v127
    v_mov_b32 v125, v124
    v_mov_b32 v127, v126
    s_nop 0
    v_permlane16_swap_b32 v124, v125
    v_permlane16_swap_b32 v126, v127
    v_mov_b32 v125, v124
    v_mov_b32 v127, v126
    s_nop 0
    v_permlane32_swap_b32 v124, v125
    v_permlane32_swap_b32 v126, v127
    v_rcp_f32 v125, v124
    v_rcp_f32 v127, v126
    v_mul_f32 v56, v125, v56
    v_mul_f32 v57, v125, v57
    v_mul_f32 v58, v125, v58
    v_mul_f32 v59, v125, v59
    v_mul_f32 v60, v125, v60
    v_mul_f32 v61, v125, v61
    v_mul_f32 v62, v125, v62
    v_mul_f32 v63, v125, v63
    v_cvt_pk_bf16_f32 v80, v56, v57
    v_cvt_pk_bf16_f32 v81, v58, v59
    v_cvt_pk_bf16_f32 v82, v60, v61
    v_cvt_pk_bf16_f32 v83, v62, v63
    v_mul_f32 v64, v127, v64
    v_mul_f32 v65, v127, v65
    v_mul_f32 v66, v127, v66
    v_mul_f32 v67, v127, v67
    v_mul_f32 v68, v127, v68
    v_mul_f32 v69, v127, v69
    v_mul_f32 v70, v127, v70
    v_mul_f32 v71, v127, v71
    v_permlane16_swap_b32 v80, v82
    v_permlane16_swap_b32 v81, v83
    v_cvt_pk_bf16_f32 v84, v64, v65
    v_cvt_pk_bf16_f32 v85, v66, v67
    buffer_store_dwordx4 v[80:83], v1, s[36:39], s45 offen sc1
    v_cvt_pk_bf16_f32 v86, v68, v69
    v_cvt_pk_bf16_f32 v87, v70, v71
    s_nop 0
    v_permlane16_swap_b32 v84, v86
    v_permlane16_swap_b32 v85, v87
    buffer_store_dwordx4 v[84:87], v1, s[36:39], s45 offen offset:256 sc1
    s_branch att_end
f_kernel_g3:
    s_waitcnt lgkmcnt(0)
    s_bfe_u32 s47, s3, 0x10001
    s_and_b32 s48, s3, 1
    s_lshl4_add_u32 s54, s30, s28
    s_lshl1_add_u32 s54, s54, s47
    s_lshl3_add_u32 s54, s54, s29
    s_lshl1_add_u32 s54, s54, s48
    s_lshl_b32 s54, s54, 2
    s_add_u32 s54, s54, 29364224
    s_lshl3_add_u32 s57, s28, s29
    s_lshl2_add_u32 s57, s57, s3
    s_lshl_b32 s56, s57, 2
    s_add_u32 s56, s56, 29372400
    s_mov_b32 s38, 29380608
    s_mov_b32 s39, 0x00020000
    s_mov_b32 s42, 8388608
    s_mov_b32 s43, 0x00020000
    s_mov_b64 s[36:37], s[26:27]
    s_mov_b64 s[40:41], s[24:25]
    s_lshl_b32 s45, s3, 8
    s_add_u32 s46, s45, 29375488
    s_add_u32 s45, s45, s2
    s_lshl_b32 s45, s45, 2
    s_add_u32 s45, s45, 29372416
    v_lshlrev_b32 v151, 2, v0
    buffer_load_dword v148, v151, s[36:39], s46 offen sc1
    buffer_load_dword v150, off, s[36:39], s45 sc1
    buffer_load_dword v17, off, s[36:39], s54 sc1
    buffer_load_dword v164, off, s[36:39], s56 sc1
    s_barrier
    s_mul_i32 s49, s47, 24576
    v_and_b32 v1, 15, v0
    v_bfe_u32 v2, v0, 1, 3
    v_lshlrev_b32 v1, 7, v1
    v_add_u32 v1, s49, v1
    v_lshrrev_b32 v3, 4, v0
    v_xor_b32 v2, v2, v3
    v_lshl_add_u32 v1, v2, 4, v1
    v_xor_b32 v6, 0, v1
    v_xor_b32 v7, 64, v1
    v_xor_b32 v8, 32, v1
    v_xor_b32 v9, 96, v1
    v_lshrrev_b32 v1, 4, v0
    v_lshlrev_b32 v1, 5, v1
    v_and_or_b32 v1, v0, 15, v1
    v_lshlrev_b32 v1, 4, v1
    v_add_u32 v12, s49, v1
    s_mov_b32 s51, 49152
    v_bfe_u32 v1, v0, 1, 1
    v_bfe_u32 v2, v0, 4, 1
    v_lshl_or_b32 v1, v2, 1, v1
    v_bfe_u32 v2, v0, 3, 1
    v_lshl_or_b32 v1, v2, 2, v1
    s_lshl_b32 s52, s48, 2
    v_xor_b32 v1, s52, v1
    v_lshlrev_b32 v1, 4, v1
    v_bfe_u32 v2, v0, 2, 2
    v_lshl_add_u32 v1, v2, 7, v1
    v_and_b32 v2, 1, v0
    v_lshl_add_u32 v1, v2, 3, v1
    v_lshrrev_b32 v2, 4, v0
    v_lshl_add_u32 v1, v2, 10, v1
    v_add_u32 v10, s51, v1
    v_xor_b32 v11, 32, v10
    s_mul_i32 s51, s48, 24576
    s_add_u32 s51, s51, 49152
    v_bfe_u32 v1, v0, 1, 1
    v_bfe_u32 v2, v0, 4, 1
    v_lshl_or_b32 v1, v2, 1, v1
    v_bfe_u32 v2, v0, 3, 1
    v_lshl_or_b32 v1, v2, 2, v1
    v_lshlrev_b32 v1, 4, v1
    v_bfe_u32 v2, v0, 2, 2
    v_lshl_add_u32 v1, v2, 7, v1
    v_and_b32 v2, 1, v0
    v_lshl_add_u32 v1, v2, 3, v1
    v_lshrrev_b32 v2, 4, v0
    v_lshl_add_u32 v1, v2, 10, v1
    v_add_u32 v13, s51, v1
    v_xor_b32 v14, 32, v13
    v_xor_b32 v15, 64, v13
    v_xor_b32 v16, 96, v13
    s_lshl1_add_u32 s50, s28, s47
    s_lshl_b32 s55, s50, 18
    s_lshl2_add_u32 s50, s50, s30
    s_lshl3_add_u32 s50, s50, s29
    s_lshl3_add_u32 s50, s50, s48
    s_lshl_b32 s50, s50, 10
    s_add_u32 s50, s50, 16777216
    s_add_u32 s52, s50, 4096
    s_lshl3_add_u32 s51, s30, s29
    s_lshl1_add_u32 s51, s51, s48
    s_lshl_b32 s51, s51, 7
    s_add_u32 s55, s55, s51
    v_bfe_u32 v1, v0, 4, 1
    v_lshlrev_b32 v1, 5, v1
    v_lshrrev_b32 v2, 5, v0
    v_lshl_or_b32 v1, v2, 4, v1
    v_and_or_b32 v1, v0, 15, v1
    v_lshlrev_b32 v4, 4, v1
    v_add_u32 v5, 0x20000, v4
    s_barrier
    v_mov_b32 v20, 0
    v_mov_b32 v21, 0
    v_mov_b32 v22, 0
    v_mov_b32 v23, 0
    v_mov_b32 v24, 0
    v_mov_b32 v25, 0
    v_mov_b32 v26, 0
    v_mov_b32 v27, 0
    v_mov_b32 v28, 0
    v_mov_b32 v29, 0
    v_mov_b32 v30, 0
    v_mov_b32 v31, 0
    v_mov_b32 v32, 0
    v_mov_b32 v33, 0
    v_mov_b32 v34, 0
    v_mov_b32 v35, 0
    v_mov_b32 v36, 0
    v_mov_b32 v37, 0
    v_mov_b32 v38, 0
    v_mov_b32 v39, 0
    v_mov_b32 v40, 0
    v_mov_b32 v41, 0
    v_mov_b32 v42, 0
    v_mov_b32 v43, 0
    v_mov_b32 v44, 0
    v_mov_b32 v45, 0
    v_mov_b32 v46, 0
    v_mov_b32 v47, 0
    v_mov_b32 v48, 0
    v_mov_b32 v49, 0
    v_mov_b32 v50, 0
    v_mov_b32 v51, 0
    v_mov_b32 v52, 0
    v_mov_b32 v53, 0
    v_mov_b32 v54, 0
    v_mov_b32 v55, 0
    v_mov_b32 v56, 0
    v_mov_b32 v57, 0
    v_mov_b32 v58, 0
    v_mov_b32 v59, 0
    v_mov_b32 v60, 0
    v_mov_b32 v61, 0
    v_mov_b32 v62, 0
    v_mov_b32 v63, 0
    v_mov_b32 v64, 0
    v_mov_b32 v65, 0
    v_mov_b32 v66, 0
    v_mov_b32 v67, 0
    v_mov_b32 v68, 0
    v_mov_b32 v69, 0
    v_mov_b32 v70, 0
    v_mov_b32 v71, 0
    v_mov_b32 v72, 0
    v_mov_b32 v73, 0
    v_mov_b32 v74, 0
    v_mov_b32 v75, 0
    v_mov_b32 v76, 0
    v_mov_b32 v77, 0
    v_mov_b32 v78, 0
    v_mov_b32 v79, 0
    v_mov_b32 v80, 0
    v_mov_b32 v81, 0
    v_mov_b32 v82, 0
    v_mov_b32 v83, 0
    s_barrier
    s_barrier
    s_waitcnt vmcnt(0)
    s_barrier
    v_add_u32 v150, 1, v150
    buffer_store_dword v150, off, s[36:39], s45 sc1
    s_barrier
    s_barrier
    s_barrier
    s_barrier
    s_barrier
    buffer_load_dword v149, v151, s[36:39], s46 offen sc1
    s_barrier
    s_barrier
    s_barrier
    s_waitcnt vmcnt(0)
    s_mov_b32 s44, 65536
rdv_poll:
    v_cmp_ne_u32 vcc, v148, v149
    s_nop 0
    s_cmp_eq_u64 vcc, -1
    s_cbranch_scc1 rdv_polled
    s_sleep 1
    buffer_load_dword v149, v151, s[36:39], s46 offen sc1
    s_sub_u32 s44, s44, 1
    s_cmp_lg_u32 s44, 0
    s_waitcnt vmcnt(0)
    s_cbranch_scc1 rdv_poll
rdv_polled:
    s_barrier
    v_add_u32 v150, 1, v150
    buffer_store_dword v150, off, s[36:39], s45 sc1
    s_barrier
    s_barrier
    v_add_u32 v17, 1, v17
    v_add_u32 v164, 1, v164
    s_lshl_b32 s57, s57, 13
    s_add_u32 s57, s57, 25133056
    s_add_u32 s58, s57, 4096
    s_barrier
    ds_read_b128 v[84:87], v6 offset:8192
    ds_read_b64_tr_b16 v[116:117], v10 offset:8192
    ds_read_b64_tr_b16 v[118:119], v10 offset:8704
    ds_read_b64_tr_b16 v[120:121], v11 offset:8192
    ds_read_b64_tr_b16 v[122:123], v11 offset:8704
    ds_read_b128 v[88:91], v8 offset:10240
    ds_read_b64_tr_b16 v[124:125], v10 offset:32768
    ds_read_b64_tr_b16 v[126:127], v10 offset:33280
    ds_read_b64_tr_b16 v[128:129], v11 offset:32768
    ds_read_b64_tr_b16 v[130:131], v11 offset:33280
    ds_read_b128 v[92:95], v6 offset:12288
    ds_read_b128 v[96:99], v8 offset:14336
    s_mov_b32 s53, 10
g2_loop:
    s_waitcnt lgkmcnt(0)
    v_mfma_f32_16x16x32_bf16 v[20:23], v[116:119], v[84:87], v[20:23]
    ds_read_b128 v[100:103], v7 offset:8192
    v_mfma_f32_16x16x32_bf16 v[24:27], v[120:123], v[84:87], v[24:27]
    ds_read_b64_tr_b16 v[132:133], v10 offset:12288
    v_mfma_f32_16x16x32_bf16 v[32:35], v[120:123], v[88:91], v[32:35]
    ds_read_b64_tr_b16 v[134:135], v10 offset:12800
    v_mfma_f32_16x16x32_bf16 v[28:31], v[116:119], v[88:91], v[28:31]
    ds_read_b64_tr_b16 v[136:137], v11 offset:12288
    v_mfma_f32_16x16x32_bf16 v[36:39], v[124:127], v[84:87], v[36:39]
    ds_read_b64_tr_b16 v[138:139], v11 offset:12800
    v_mfma_f32_16x16x32_bf16 v[40:43], v[128:131], v[84:87], v[40:43]
    ds_read_b128 v[104:107], v9 offset:10240
    v_mfma_f32_16x16x32_bf16 v[48:51], v[128:131], v[88:91], v[48:51]
    ds_read_b64_tr_b16 v[140:141], v10 offset:36864
    v_mfma_f32_16x16x32_bf16 v[44:47], v[124:127], v[88:91], v[44:47]
    ds_read_b64_tr_b16 v[142:143], v10 offset:37376
    v_mfma_f32_16x16x32_bf16 v[52:55], v[116:119], v[92:95], v[52:55]
    ds_read_b64_tr_b16 v[144:145], v11 offset:36864
    v_mfma_f32_16x16x32_bf16 v[56:59], v[120:123], v[92:95], v[56:59]
    ds_read_b64_tr_b16 v[146:147], v11 offset:37376
    v_mfma_f32_16x16x32_bf16 v[64:67], v[120:123], v[96:99], v[64:67]
    ds_read_b128 v[108:111], v7 offset:12288
    ds_read_b128 v[112:115], v9 offset:14336
    v_mfma_f32_16x16x32_bf16 v[60:63], v[116:119], v[96:99], v[60:63]
    v_mfma_f32_16x16x32_bf16 v[68:71], v[124:127], v[92:95], v[68:71]
    v_mfma_f32_16x16x32_bf16 v[72:75], v[128:131], v[92:95], v[72:75]
    v_mfma_f32_16x16x32_bf16 v[80:83], v[128:131], v[96:99], v[80:83]
    v_mfma_f32_16x16x32_bf16 v[76:79], v[124:127], v[96:99], v[76:79]
    s_waitcnt lgkmcnt(0)
    v_mfma_f32_16x16x32_bf16 v[20:23], v[132:135], v[100:103], v[20:23]
    v_mfma_f32_16x16x32_bf16 v[24:27], v[136:139], v[100:103], v[24:27]
    s_barrier
    v_mfma_f32_16x16x32_bf16 v[32:35], v[136:139], v[104:107], v[32:35]
    ds_read_b128 v[84:87], v6 offset:16384
    v_mfma_f32_16x16x32_bf16 v[28:31], v[132:135], v[104:107], v[28:31]
    ds_read_b64_tr_b16 v[116:117], v10 offset:16384
    v_mfma_f32_16x16x32_bf16 v[36:39], v[140:143], v[100:103], v[36:39]
    ds_read_b64_tr_b16 v[118:119], v10 offset:16896
    ds_read_b64_tr_b16 v[120:121], v11 offset:16384
    v_mfma_f32_16x16x32_bf16 v[40:43], v[144:147], v[100:103], v[40:43]
    ds_read_b64_tr_b16 v[122:123], v11 offset:16896
    v_mfma_f32_16x16x32_bf16 v[48:51], v[144:147], v[104:107], v[48:51]
    ds_read_b128 v[88:91], v8 offset:18432
    v_mfma_f32_16x16x32_bf16 v[44:47], v[140:143], v[104:107], v[44:47]
    ds_read_b64_tr_b16 v[124:125], v10 offset:40960
    ds_read_b64_tr_b16 v[126:127], v10 offset:41472
    v_mfma_f32_16x16x32_bf16 v[52:55], v[132:135], v[108:111], v[52:55]
    ds_read_b64_tr_b16 v[128:129], v11 offset:40960
    v_mfma_f32_16x16x32_bf16 v[56:59], v[136:139], v[108:111], v[56:59]
    ds_read_b64_tr_b16 v[130:131], v11 offset:41472
    v_mfma_f32_16x16x32_bf16 v[64:67], v[136:139], v[112:115], v[64:67]
    ds_read_b128 v[92:95], v6 offset:20480
    ds_read_b128 v[96:99], v8 offset:22528
    v_mfma_f32_16x16x32_bf16 v[60:63], v[132:135], v[112:115], v[60:63]
    v_mfma_f32_16x16x32_bf16 v[68:71], v[140:143], v[108:111], v[68:71]
    v_mfma_f32_16x16x32_bf16 v[72:75], v[144:147], v[108:111], v[72:75]
    v_mfma_f32_16x16x32_bf16 v[80:83], v[144:147], v[112:115], v[80:83]
    v_mfma_f32_16x16x32_bf16 v[76:79], v[140:143], v[112:115], v[76:79]
    s_waitcnt lgkmcnt(0)
    v_mfma_f32_16x16x32_bf16 v[20:23], v[116:119], v[84:87], v[20:23]
    ds_read_b128 v[100:103], v7 offset:16384
    v_mfma_f32_16x16x32_bf16 v[24:27], v[120:123], v[84:87], v[24:27]
    ds_read_b64_tr_b16 v[132:133], v10 offset:20480
    v_mfma_f32_16x16x32_bf16 v[32:35], v[120:123], v[88:91], v[32:35]
    ds_read_b64_tr_b16 v[134:135], v10 offset:20992
    v_mfma_f32_16x16x32_bf16 v[28:31], v[116:119], v[88:91], v[28:31]
    ds_read_b64_tr_b16 v[136:137], v11 offset:20480
    v_mfma_f32_16x16x32_bf16 v[36:39], v[124:127], v[84:87], v[36:39]
    ds_read_b64_tr_b16 v[138:139], v11 offset:20992
    v_mfma_f32_16x16x32_bf16 v[40:43], v[128:131], v[84:87], v[40:43]
    ds_read_b128 v[104:107], v9 offset:18432
    v_mfma_f32_16x16x32_bf16 v[48:51], v[128:131], v[88:91], v[48:51]
    ds_read_b64_tr_b16 v[140:141], v10 offset:45056
    v_mfma_f32_16x16x32_bf16 v[44:47], v[124:127], v[88:91], v[44:47]
    ds_read_b64_tr_b16 v[142:143], v10 offset:45568
    v_mfma_f32_16x16x32_bf16 v[52:55], v[116:119], v[92:95], v[52:55]
    ds_read_b64_tr_b16 v[144:145], v11 offset:45056
    v_mfma_f32_16x16x32_bf16 v[56:59], v[120:123], v[92:95], v[56:59]
    ds_read_b64_tr_b16 v[146:147], v11 offset:45568
    v_mfma_f32_16x16x32_bf16 v[64:67], v[120:123], v[96:99], v[64:67]
    ds_read_b128 v[108:111], v7 offset:20480
    ds_read_b128 v[112:115], v9 offset:22528
    v_mfma_f32_16x16x32_bf16 v[60:63], v[116:119], v[96:99], v[60:63]
    v_mfma_f32_16x16x32_bf16 v[68:71], v[124:127], v[92:95], v[68:71]
    v_mfma_f32_16x16x32_bf16 v[72:75], v[128:131], v[92:95], v[72:75]
    v_mfma_f32_16x16x32_bf16 v[80:83], v[128:131], v[96:99], v[80:83]
    v_mfma_f32_16x16x32_bf16 v[76:79], v[124:127], v[96:99], v[76:79]
    s_waitcnt lgkmcnt(0)
    v_mfma_f32_16x16x32_bf16 v[20:23], v[132:135], v[100:103], v[20:23]
    v_mfma_f32_16x16x32_bf16 v[24:27], v[136:139], v[100:103], v[24:27]
    s_barrier
    v_mfma_f32_16x16x32_bf16 v[32:35], v[136:139], v[104:107], v[32:35]
    ds_read_b128 v[84:87], v6 offset:0
    v_mfma_f32_16x16x32_bf16 v[28:31], v[132:135], v[104:107], v[28:31]
    ds_read_b64_tr_b16 v[116:117], v10 offset:0
    v_mfma_f32_16x16x32_bf16 v[36:39], v[140:143], v[100:103], v[36:39]
    ds_read_b64_tr_b16 v[118:119], v10 offset:512
    ds_read_b64_tr_b16 v[120:121], v11 offset:0
    v_mfma_f32_16x16x32_bf16 v[40:43], v[144:147], v[100:103], v[40:43]
    ds_read_b64_tr_b16 v[122:123], v11 offset:512
    v_mfma_f32_16x16x32_bf16 v[48:51], v[144:147], v[104:107], v[48:51]
    ds_read_b128 v[88:91], v8 offset:2048
    v_mfma_f32_16x16x32_bf16 v[44:47], v[140:143], v[104:107], v[44:47]
    ds_read_b64_tr_b16 v[124:125], v10 offset:24576
    ds_read_b64_tr_b16 v[126:127], v10 offset:25088
    v_mfma_f32_16x16x32_bf16 v[52:55], v[132:135], v[108:111], v[52:55]
    ds_read_b64_tr_b16 v[128:129], v11 offset:24576
    v_mfma_f32_16x16x32_bf16 v[56:59], v[136:139], v[108:111], v[56:59]
    ds_read_b64_tr_b16 v[130:131], v11 offset:25088
    v_mfma_f32_16x16x32_bf16 v[64:67], v[136:139], v[112:115], v[64:67]
    ds_read_b128 v[92:95], v6 offset:4096
    ds_read_b128 v[96:99], v8 offset:6144
    v_mfma_f32_16x16x32_bf16 v[60:63], v[132:135], v[112:115], v[60:63]
    v_mfma_f32_16x16x32_bf16 v[68:71], v[140:143], v[108:111], v[68:71]
    v_mfma_f32_16x16x32_bf16 v[72:75], v[144:147], v[108:111], v[72:75]
    v_mfma_f32_16x16x32_bf16 v[80:83], v[144:147], v[112:115], v[80:83]
    v_mfma_f32_16x16x32_bf16 v[76:79], v[140:143], v[112:115], v[76:79]
    s_waitcnt lgkmcnt(0)
    v_mfma_f32_16x16x32_bf16 v[20:23], v[116:119], v[84:87], v[20:23]
    ds_read_b128 v[100:103], v7 offset:0
    v_mfma_f32_16x16x32_bf16 v[24:27], v[120:123], v[84:87], v[24:27]
    ds_read_b64_tr_b16 v[132:133], v10 offset:4096
    v_mfma_f32_16x16x32_bf16 v[32:35], v[120:123], v[88:91], v[32:35]
    ds_read_b64_tr_b16 v[134:135], v10 offset:4608
    v_mfma_f32_16x16x32_bf16 v[28:31], v[116:119], v[88:91], v[28:31]
    ds_read_b64_tr_b16 v[136:137], v11 offset:4096
    v_mfma_f32_16x16x32_bf16 v[36:39], v[124:127], v[84:87], v[36:39]
    ds_read_b64_tr_b16 v[138:139], v11 offset:4608
    v_mfma_f32_16x16x32_bf16 v[40:43], v[128:131], v[84:87], v[40:43]
    ds_read_b128 v[104:107], v9 offset:2048
    v_mfma_f32_16x16x32_bf16 v[48:51], v[128:131], v[88:91], v[48:51]
    ds_read_b64_tr_b16 v[140:141], v10 offset:28672
    v_mfma_f32_16x16x32_bf16 v[44:47], v[124:127], v[88:91], v[44:47]
    ds_read_b64_tr_b16 v[142:143], v10 offset:29184
    v_mfma_f32_16x16x32_bf16 v[52:55], v[116:119], v[92:95], v[52:55]
    ds_read_b64_tr_b16 v[144:145], v11 offset:28672
    v_mfma_f32_16x16x32_bf16 v[56:59], v[120:123], v[92:95], v[56:59]
    ds_read_b64_tr_b16 v[146:147], v11 offset:29184
    v_mfma_f32_16x16x32_bf16 v[64:67], v[120:123], v[96:99], v[64:67]
    ds_read_b128 v[108:111], v7 offset:4096
    ds_read_b128 v[112:115], v9 offset:6144
    v_mfma_f32_16x16x32_bf16 v[60:63], v[116:119], v[96:99], v[60:63]
    v_mfma_f32_16x16x32_bf16 v[68:71], v[124:127], v[92:95], v[68:71]
    v_mfma_f32_16x16x32_bf16 v[72:75], v[128:131], v[92:95], v[72:75]
    v_mfma_f32_16x16x32_bf16 v[80:83], v[128:131], v[96:99], v[80:83]
    v_mfma_f32_16x16x32_bf16 v[76:79], v[124:127], v[96:99], v[76:79]
    s_waitcnt lgkmcnt(0)
    v_mfma_f32_16x16x32_bf16 v[20:23], v[132:135], v[100:103], v[20:23]
    v_mfma_f32_16x16x32_bf16 v[24:27], v[136:139], v[100:103], v[24:27]
    s_barrier
    v_mfma_f32_16x16x32_bf16 v[32:35], v[136:139], v[104:107], v[32:35]
    ds_read_b128 v[84:87], v6 offset:8192
    v_mfma_f32_16x16x32_bf16 v[28:31], v[132:135], v[104:107], v[28:31]
    ds_read_b64_tr_b16 v[116:117], v10 offset:8192
    v_mfma_f32_16x16x32_bf16 v[36:39], v[140:143], v[100:103], v[36:39]
    ds_read_b64_tr_b16 v[118:119], v10 offset:8704
    ds_read_b64_tr_b16 v[120:121], v11 offset:8192
    v_mfma_f32_16x16x32_bf16 v[40:43], v[144:147], v[100:103], v[40:43]
    ds_read_b64_tr_b16 v[122:123], v11 offset:8704
    v_mfma_f32_16x16x32_bf16 v[48:51], v[144:147], v[104:107], v[48:51]
    ds_read_b128 v[88:91], v8 offset:10240
    v_mfma_f32_16x16x32_bf16 v[44:47], v[140:143], v[104:107], v[44:47]
    ds_read_b64_tr_b16 v[124:125], v10 offset:32768
    ds_read_b64_tr_b16 v[126:127], v10 offset:33280
    v_mfma_f32_16x16x32_bf16 v[52:55], v[132:135], v[108:111], v[52:55]
    ds_read_b64_tr_b16 v[128:129], v11 offset:32768
    v_mfma_f32_16x16x32_bf16 v[56:59], v[136:139], v[108:111], v[56:59]
    ds_read_b64_tr_b16 v[130:131], v11 offset:33280
    v_mfma_f32_16x16x32_bf16 v[64:67], v[136:139], v[112:115], v[64:67]
    ds_read_b128 v[92:95], v6 offset:12288
    ds_read_b128 v[96:99], v8 offset:14336
    v_mfma_f32_16x16x32_bf16 v[60:63], v[132:135], v[112:115], v[60:63]
    v_mfma_f32_16x16x32_bf16 v[68:71], v[140:143], v[108:111], v[68:71]
    v_mfma_f32_16x16x32_bf16 v[72:75], v[144:147], v[108:111], v[72:75]
    v_mfma_f32_16x16x32_bf16 v[80:83], v[144:147], v[112:115], v[80:83]
    v_mfma_f32_16x16x32_bf16 v[76:79], v[140:143], v[112:115], v[76:79]
    s_sub_u32 s53, s53, 1
    s_cmp_lg_u32 s53, 0
    s_cbranch_scc1 g2_loop
    s_waitcnt lgkmcnt(0)
    v_mfma_f32_16x16x32_bf16 v[20:23], v[116:119], v[84:87], v[20:23]
    ds_read_b128 v[100:103], v7 offset:8192
    v_mfma_f32_16x16x32_bf16 v[24:27], v[120:123], v[84:87], v[24:27]
    ds_read_b64_tr_b16 v[132:133], v10 offset:12288
    v_mfma_f32_16x16x32_bf16 v[32:35], v[120:123], v[88:91], v[32:35]
    ds_read_b64_tr_b16 v[134:135], v10 offset:12800
    v_mfma_f32_16x16x32_bf16 v[28:31], v[116:119], v[88:91], v[28:31]
    ds_read_b64_tr_b16 v[136:137], v11 offset:12288
    v_mfma_f32_16x16x32_bf16 v[36:39], v[124:127], v[84:87], v[36:39]
    ds_read_b64_tr_b16 v[138:139], v11 offset:12800
    v_mfma_f32_16x16x32_bf16 v[40:43], v[128:131], v[84:87], v[40:43]
    ds_read_b128 v[104:107], v9 offset:10240
    v_mfma_f32_16x16x32_bf16 v[48:51], v[128:131], v[88:91], v[48:51]
    ds_read_b64_tr_b16 v[140:141], v10 offset:36864
    v_mfma_f32_16x16x32_bf16 v[44:47], v[124:127], v[88:91], v[44:47]
    ds_read_b64_tr_b16 v[142:143], v10 offset:37376
    v_mfma_f32_16x16x32_bf16 v[52:55], v[116:119], v[92:95], v[52:55]
    ds_read_b64_tr_b16 v[144:145], v11 offset:36864
    v_mfma_f32_16x16x32_bf16 v[56:59], v[120:123], v[92:95], v[56:59]
    ds_read_b64_tr_b16 v[146:147], v11 offset:37376
    v_mfma_f32_16x16x32_bf16 v[64:67], v[120:123], v[96:99], v[64:67]
    ds_read_b128 v[108:111], v7 offset:12288
    ds_read_b128 v[112:115], v9 offset:14336
    v_mfma_f32_16x16x32_bf16 v[60:63], v[116:119], v[96:99], v[60:63]
    v_mfma_f32_16x16x32_bf16 v[68:71], v[124:127], v[92:95], v[68:71]
    v_mfma_f32_16x16x32_bf16 v[72:75], v[128:131], v[92:95], v[72:75]
    v_mfma_f32_16x16x32_bf16 v[80:83], v[128:131], v[96:99], v[80:83]
    v_mfma_f32_16x16x32_bf16 v[76:79], v[124:127], v[96:99], v[76:79]
    s_waitcnt lgkmcnt(0)
    v_mfma_f32_16x16x32_bf16 v[20:23], v[132:135], v[100:103], v[20:23]
    v_mfma_f32_16x16x32_bf16 v[24:27], v[136:139], v[100:103], v[24:27]
    s_barrier
    v_mfma_f32_16x16x32_bf16 v[32:35], v[136:139], v[104:107], v[32:35]
    ds_read_b128 v[84:87], v6 offset:16384
    v_mfma_f32_16x16x32_bf16 v[28:31], v[132:135], v[104:107], v[28:31]
    ds_read_b64_tr_b16 v[116:117], v10 offset:16384
    v_mfma_f32_16x16x32_bf16 v[36:39], v[140:143], v[100:103], v[36:39]
    ds_read_b64_tr_b16 v[118:119], v10 offset:16896
    ds_read_b64_tr_b16 v[120:121], v11 offset:16384
    v_mfma_f32_16x16x32_bf16 v[40:43], v[144:147], v[100:103], v[40:43]
    ds_read_b64_tr_b16 v[122:123], v11 offset:16896
    v_mfma_f32_16x16x32_bf16 v[48:51], v[144:147], v[104:107], v[48:51]
    ds_read_b128 v[88:91], v8 offset:18432
    v_mfma_f32_16x16x32_bf16 v[44:47], v[140:143], v[104:107], v[44:47]
    ds_read_b64_tr_b16 v[124:125], v10 offset:40960
    ds_read_b64_tr_b16 v[126:127], v10 offset:41472
    v_mfma_f32_16x16x32_bf16 v[52:55], v[132:135], v[108:111], v[52:55]
    ds_read_b64_tr_b16 v[128:129], v11 offset:40960
    v_mfma_f32_16x16x32_bf16 v[56:59], v[136:139], v[108:111], v[56:59]
    ds_read_b64_tr_b16 v[130:131], v11 offset:41472
    v_mfma_f32_16x16x32_bf16 v[64:67], v[136:139], v[112:115], v[64:67]
    ds_read_b128 v[92:95], v6 offset:20480
    ds_read_b128 v[96:99], v8 offset:22528
    v_mfma_f32_16x16x32_bf16 v[60:63], v[132:135], v[112:115], v[60:63]
    v_mfma_f32_16x16x32_bf16 v[68:71], v[140:143], v[108:111], v[68:71]
    v_mfma_f32_16x16x32_bf16 v[72:75], v[144:147], v[108:111], v[72:75]
    v_mfma_f32_16x16x32_bf16 v[80:83], v[144:147], v[112:115], v[80:83]
    v_mfma_f32_16x16x32_bf16 v[76:79], v[140:143], v[112:115], v[76:79]
    s_setprio 3
    s_cmp_eq_u32 s30, 1
    s_cbranch_scc1 g2_neg
    s_waitcnt lgkmcnt(0)
    v_mfma_f32_16x16x32_bf16 v[20:23], v[116:119], v[84:87], v[20:23]
    ds_read_b128 v[100:103], v7 offset:16384
    ds_read_b64_tr_b16 v[132:133], v10 offset:20480
    v_mfma_f32_16x16x32_bf16 v[24:27], v[120:123], v[84:87], v[24:27]
    ds_read_b64_tr_b16 v[134:135], v10 offset:20992
    ds_read_b64_tr_b16 v[136:137], v11 offset:20480
    v_mfma_f32_16x16x32_bf16 v[32:35], v[120:123], v[88:91], v[32:35]
    ds_read_b64_tr_b16 v[138:139], v11 offset:20992
    ds_read_b128 v[104:107], v9 offset:18432
    ds_read_b64_tr_b16 v[140:141], v10 offset:45056
    v_mfma_f32_16x16x32_bf16 v[28:31], v[116:119], v[88:91], v[28:31]
    ds_read_b64_tr_b16 v[142:143], v10 offset:45568
    ds_read_b64_tr_b16 v[144:145], v11 offset:45056
    v_mfma_f32_16x16x32_bf16 v[36:39], v[124:127], v[84:87], v[36:39]
    ds_read_b64_tr_b16 v[146:147], v11 offset:45568
    ds_read_b128 v[108:111], v7 offset:20480
    ds_read_b128 v[112:115], v9 offset:22528
    v_mfma_f32_16x16x32_bf16 v[40:43], v[128:131], v[84:87], v[40:43]
    v_mfma_f32_16x16x32_bf16 v[48:51], v[128:131], v[88:91], v[48:51]
    v_mfma_f32_16x16x32_bf16 v[44:47], v[124:127], v[88:91], v[44:47]
    s_waitcnt lgkmcnt(0)
    v_mfma_f32_16x16x32_bf16 v[20:23], v[132:135], v[100:103], v[20:23]
    v_mfma_f32_16x16x32_bf16 v[24:27], v[136:139], v[100:103], v[24:27]
    v_mfma_f32_16x16x32_bf16 v[32:35], v[136:139], v[104:107], v[32:35]
    v_mfma_f32_16x16x32_bf16 v[28:31], v[132:135], v[104:107], v[28:31]
    v_mfma_f32_16x16x32_bf16 v[36:39], v[140:143], v[100:103], v[36:39]
    v_mfma_f32_16x16x32_bf16 v[40:43], v[144:147], v[100:103], v[40:43]
    v_mfma_f32_16x16x32_bf16 v[48:51], v[144:147], v[104:107], v[48:51]
    s_nop 1
    v_cvt_pk_bf16_f32 v20, v20, v21
    v_cvt_pk_bf16_f32 v21, v22, v23
    v_cvt_pk_bf16_f32 v22, v24, v25
    v_mfma_f32_16x16x32_bf16 v[44:47], v[140:143], v[104:107], v[44:47]
    v_cvt_pk_bf16_f32 v23, v26, v27
    v_cvt_pk_bf16_f32 v24, v28, v29
    v_cvt_pk_bf16_f32 v25, v30, v31
    v_mfma_f32_16x16x32_bf16 v[52:55], v[116:119], v[92:95], v[52:55]
    s_barrier
    v_cvt_pk_bf16_f32 v26, v32, v33
    v_cvt_pk_bf16_f32 v27, v34, v35
    v_permlane16_swap_b32 v20, v22
    v_mfma_f32_16x16x32_bf16 v[56:59], v[120:123], v[92:95], v[56:59]
    v_permlane16_swap_b32 v21, v23
    v_permlane16_swap_b32 v24, v26
    v_permlane16_swap_b32 v25, v27
    v_mfma_f32_16x16x32_bf16 v[64:67], v[120:123], v[96:99], v[64:67]
    buffer_store_dwordx4 v[20:23], v4, s[36:39], s50 offen offset:0 sc1
    buffer_store_dwordx4 v[24:27], v4, s[36:39], s50 offen offset:2048 sc1
    v_cvt_pk_bf16_f32 v36, v36, v37
    v_mfma_f32_16x16x32_bf16 v[60:63], v[116:119], v[96:99], v[60:63]
    v_cvt_pk_bf16_f32 v37, v38, v39
    v_cvt_pk_bf16_f32 v38, v40, v41
    v_cvt_pk_bf16_f32 v39, v42, v43
    v_mfma_f32_16x16x32_bf16 v[52:55], v[132:135], v[108:111], v[52:55]
    v_cvt_pk_bf16_f32 v40, v44, v45
    v_cvt_pk_bf16_f32 v41, v46, v47
    v_cvt_pk_bf16_f32 v42, v48, v49
    v_mfma_f32_16x16x32_bf16 v[56:59], v[136:139], v[108:111], v[56:59]
    v_cvt_pk_bf16_f32 v43, v50, v51
    v_permlane16_swap_b32 v36, v38
    v_permlane16_swap_b32 v37, v39
    v_mfma_f32_16x16x32_bf16 v[64:67], v[136:139], v[112:115], v[64:67]
    v_permlane16_swap_b32 v40, v42
    v_permlane16_swap_b32 v41, v43
    buffer_store_dwordx4 v[36:39], v4, s[36:39], s52 offen offset:0 sc1
    v_mfma_f32_16x16x32_bf16 v[60:63], v[132:135], v[112:115], v[60:63]
    buffer_store_dwordx4 v[40:43], v4, s[36:39], s52 offen offset:2048 sc1
    v_mfma_f32_16x16x32_bf16 v[68:71], v[124:127], v[92:95], v[68:71]
    v_mfma_f32_16x16x32_bf16 v[72:75], v[128:131], v[92:95], v[72:75]
    v_mfma_f32_16x16x32_bf16 v[80:83], v[128:131], v[96:99], v[80:83]
    v_cvt_pk_bf16_f32 v52, v52, v53
    v_cvt_pk_bf16_f32 v53, v54, v55
    v_cvt_pk_bf16_f32 v54, v56, v57
    v_mfma_f32_16x16x32_bf16 v[76:79], v[124:127], v[96:99], v[76:79]
    v_cvt_pk_bf16_f32 v55, v58, v59
    v_cvt_pk_bf16_f32 v56, v60, v61
    v_cvt_pk_bf16_f32 v57, v62, v63
    v_mfma_f32_16x16x32_bf16 v[68:71], v[140:143], v[108:111], v[68:71]
    v_cvt_pk_bf16_f32 v58, v64, v65
    v_cvt_pk_bf16_f32 v59, v66, v67
    v_permlane16_swap_b32 v52, v54
    v_mfma_f32_16x16x32_bf16 v[72:75], v[144:147], v[108:111], v[72:75]
    v_permlane16_swap_b32 v53, v55
    v_permlane16_swap_b32 v56, v58
    v_permlane16_swap_b32 v57, v59
    v_mfma_f32_16x16x32_bf16 v[80:83], v[144:147], v[112:115], v[80:83]
    buffer_store_dwordx4 v[52:55], v5, s[36:39], s50 offen offset:0 sc1
    buffer_store_dwordx4 v[56:59], v5, s[36:39], s50 offen offset:2048 sc1
    v_mfma_f32_16x16x32_bf16 v[76:79], v[140:143], v[112:115], v[76:79]
    v_cvt_pk_bf16_f32 v68, v68, v69
    v_cvt_pk_bf16_f32 v69, v70, v71
    v_cvt_pk_bf16_f32 v70, v72, v73
    v_cvt_pk_bf16_f32 v71, v74, v75
    s_nop 3
    v_cvt_pk_bf16_f32 v72, v76, v77
    v_cvt_pk_bf16_f32 v73, v78, v79
    v_cvt_pk_bf16_f32 v74, v80, v81
    v_cvt_pk_bf16_f32 v75, v82, v83
    v_permlane16_swap_b32 v68, v70
    v_permlane16_swap_b32 v69, v71
    v_permlane16_swap_b32 v72, v74
    v_permlane16_swap_b32 v73, v75
    buffer_store_dwordx4 v[68:71], v5, s[36:39], s52 offen offset:0 sc1
    buffer_store_dwordx4 v[72:75], v5, s[36:39], s52 offen offset:2048 sc1
    s_branch g2_done
g2_neg:
    s_waitcnt lgkmcnt(0)
    v_mfma_f32_16x16x32_bf16 v[20:23], v[116:119], v[84:87], v[20:23]
    ds_read_b128 v[100:103], v7 offset:16384
    ds_read_b64_tr_b16 v[132:133], v10 offset:20480
    v_mfma_f32_16x16x32_bf16 v[24:27], v[120:123], v[84:87], v[24:27]
    ds_read_b64_tr_b16 v[134:135], v10 offset:20992
    ds_read_b64_tr_b16 v[136:137], v11 offset:20480
    v_mfma_f32_16x16x32_bf16 v[32:35], v[120:123], v[88:91], v[32:35]
    ds_read_b64_tr_b16 v[138:139], v11 offset:20992
    ds_read_b128 v[104:107], v9 offset:18432
    ds_read_b64_tr_b16 v[140:141], v10 offset:45056
    v_mfma_f32_16x16x32_bf16 v[28:31], v[116:119], v[88:91], v[28:31]
    ds_read_b64_tr_b16 v[142:143], v10 offset:45568
    ds_read_b64_tr_b16 v[144:145], v11 offset:45056
    v_mfma_f32_16x16x32_bf16 v[36:39], v[124:127], v[84:87], v[36:39]
    ds_read_b64_tr_b16 v[146:147], v11 offset:45568
    ds_read_b128 v[108:111], v7 offset:20480
    ds_read_b128 v[112:115], v9 offset:22528
    v_mfma_f32_16x16x32_bf16 v[40:43], v[128:131], v[84:87], v[40:43]
    v_mfma_f32_16x16x32_bf16 v[48:51], v[128:131], v[88:91], v[48:51]
    v_mfma_f32_16x16x32_bf16 v[44:47], v[124:127], v[88:91], v[44:47]
    s_waitcnt lgkmcnt(0)
    v_mfma_f32_16x16x32_bf16 v[20:23], v[132:135], v[100:103], v[20:23]
    v_mfma_f32_16x16x32_bf16 v[24:27], v[136:139], v[100:103], v[24:27]
    v_mfma_f32_16x16x32_bf16 v[32:35], v[136:139], v[104:107], v[32:35]
    v_mfma_f32_16x16x32_bf16 v[28:31], v[132:135], v[104:107], v[28:31]
    v_mfma_f32_16x16x32_bf16 v[36:39], v[140:143], v[100:103], v[36:39]
    v_mfma_f32_16x16x32_bf16 v[40:43], v[144:147], v[100:103], v[40:43]
    v_mfma_f32_16x16x32_bf16 v[48:51], v[144:147], v[104:107], v[48:51]
    s_nop 1
    v_cvt_pk_bf16_f32 v20, -v20, -v21
    v_cvt_pk_bf16_f32 v21, -v22, -v23
    v_cvt_pk_bf16_f32 v22, -v24, -v25
    v_mfma_f32_16x16x32_bf16 v[44:47], v[140:143], v[104:107], v[44:47]
    v_cvt_pk_bf16_f32 v23, -v26, -v27
    v_cvt_pk_bf16_f32 v24, -v28, -v29
    v_cvt_pk_bf16_f32 v25, -v30, -v31
    v_mfma_f32_16x16x32_bf16 v[52:55], v[116:119], v[92:95], v[52:55]
    s_barrier
    v_cvt_pk_bf16_f32 v26, -v32, -v33
    v_cvt_pk_bf16_f32 v27, -v34, -v35
    v_permlane16_swap_b32 v20, v22
    v_mfma_f32_16x16x32_bf16 v[56:59], v[120:123], v[92:95], v[56:59]
    v_permlane16_swap_b32 v21, v23
    v_permlane16_swap_b32 v24, v26
    v_permlane16_swap_b32 v25, v27
    v_mfma_f32_16x16x32_bf16 v[64:67], v[120:123], v[96:99], v[64:67]
    buffer_store_dwordx4 v[20:23], v4, s[36:39], s50 offen offset:0 sc1
    buffer_store_dwordx4 v[24:27], v4, s[36:39], s50 offen offset:2048 sc1
    v_cvt_pk_bf16_f32 v36, -v36, -v37
    v_mfma_f32_16x16x32_bf16 v[60:63], v[116:119], v[96:99], v[60:63]
    v_cvt_pk_bf16_f32 v37, -v38, -v39
    v_cvt_pk_bf16_f32 v38, -v40, -v41
    v_cvt_pk_bf16_f32 v39, -v42, -v43
    v_mfma_f32_16x16x32_bf16 v[52:55], v[132:135], v[108:111], v[52:55]
    v_cvt_pk_bf16_f32 v40, -v44, -v45
    v_cvt_pk_bf16_f32 v41, -v46, -v47
    v_cvt_pk_bf16_f32 v42, -v48, -v49
    v_mfma_f32_16x16x32_bf16 v[56:59], v[136:139], v[108:111], v[56:59]
    v_cvt_pk_bf16_f32 v43, -v50, -v51
    v_permlane16_swap_b32 v36, v38
    v_permlane16_swap_b32 v37, v39
    v_mfma_f32_16x16x32_bf16 v[64:67], v[136:139], v[112:115], v[64:67]
    v_permlane16_swap_b32 v40, v42
    v_permlane16_swap_b32 v41, v43
    buffer_store_dwordx4 v[36:39], v4, s[36:39], s52 offen offset:0 sc1
    v_mfma_f32_16x16x32_bf16 v[60:63], v[132:135], v[112:115], v[60:63]
    buffer_store_dwordx4 v[40:43], v4, s[36:39], s52 offen offset:2048 sc1
    v_mfma_f32_16x16x32_bf16 v[68:71], v[124:127], v[92:95], v[68:71]
    v_mfma_f32_16x16x32_bf16 v[72:75], v[128:131], v[92:95], v[72:75]
    v_mfma_f32_16x16x32_bf16 v[80:83], v[128:131], v[96:99], v[80:83]
    v_cvt_pk_bf16_f32 v52, -v52, -v53
    v_cvt_pk_bf16_f32 v53, -v54, -v55
    v_cvt_pk_bf16_f32 v54, -v56, -v57
    v_mfma_f32_16x16x32_bf16 v[76:79], v[124:127], v[96:99], v[76:79]
    v_cvt_pk_bf16_f32 v55, -v58, -v59
    v_cvt_pk_bf16_f32 v56, -v60, -v61
    v_cvt_pk_bf16_f32 v57, -v62, -v63
    v_mfma_f32_16x16x32_bf16 v[68:71], v[140:143], v[108:111], v[68:71]
    v_cvt_pk_bf16_f32 v58, -v64, -v65
    v_cvt_pk_bf16_f32 v59, -v66, -v67
    v_permlane16_swap_b32 v52, v54
    v_mfma_f32_16x16x32_bf16 v[72:75], v[144:147], v[108:111], v[72:75]
    v_permlane16_swap_b32 v53, v55
    v_permlane16_swap_b32 v56, v58
    v_permlane16_swap_b32 v57, v59
    v_mfma_f32_16x16x32_bf16 v[80:83], v[144:147], v[112:115], v[80:83]
    buffer_store_dwordx4 v[52:55], v5, s[36:39], s50 offen offset:0 sc1
    buffer_store_dwordx4 v[56:59], v5, s[36:39], s50 offen offset:2048 sc1
    v_mfma_f32_16x16x32_bf16 v[76:79], v[140:143], v[112:115], v[76:79]
    v_cvt_pk_bf16_f32 v68, -v68, -v69
    v_cvt_pk_bf16_f32 v69, -v70, -v71
    v_cvt_pk_bf16_f32 v70, -v72, -v73
    v_cvt_pk_bf16_f32 v71, -v74, -v75
    s_nop 3
    v_cvt_pk_bf16_f32 v72, -v76, -v77
    v_cvt_pk_bf16_f32 v73, -v78, -v79
    v_cvt_pk_bf16_f32 v74, -v80, -v81
    v_cvt_pk_bf16_f32 v75, -v82, -v83
    v_permlane16_swap_b32 v68, v70
    v_permlane16_swap_b32 v69, v71
    v_permlane16_swap_b32 v72, v74
    v_permlane16_swap_b32 v73, v75
    buffer_store_dwordx4 v[68:71], v5, s[36:39], s52 offen offset:0 sc1
    buffer_store_dwordx4 v[72:75], v5, s[36:39], s52 offen offset:2048 sc1
g2_done:
    s_setprio 0
    v_lshlrev_b32 v1, 4, v0
    v_add_u32 v10, s49, v1
    s_mul_i32 s51, s48, 24576
    s_add_u32 s51, s51, 49152
    v_and_b32 v1, 15, v0
    v_bfe_u32 v2, v0, 1, 3
    v_lshlrev_b32 v1, 7, v1
    v_add_u32 v1, s51, v1
    v_lshrrev_b32 v3, 4, v0
    v_xor_b32 v2, v2, v3
    v_lshl_add_u32 v1, v2, 4, v1
    v_xor_b32 v6, 0, v1
    v_xor_b32 v7, 64, v1
    v_xor_b32 v8, 32, v1
    v_xor_b32 v9, 96, v1
    s_barrier
    s_barrier
    s_waitcnt vmcnt(0)
    buffer_store_dword v17, off, s[36:39], s54 sc1
    s_sub_u32 s52, s3, 4
    s_mul_i32 s51, s52, 24576
    s_lshl_b32 s52, s52, 13
    s_cselect_b32 s52, s52, 4294950912
    s_add_u32 s52, s52, 131072
    v_bfe_u32 v1, v0, 4, 1
    v_lshrrev_b32 v2, 5, v0
    v_lshl_or_b32 v2, v1, 1, v2
    v_xor_b32 v2, v2, v0
    v_and_b32 v2, 7, v2
    v_lshlrev_b32 v2, 4, v2
    v_and_b32 v1, 15, v0
    v_lshl_add_u32 v1, v1, 7, v2
    v_add_u32 v4, s51, v1
    v_xor_b32 v5, 64, v4
    v_lshrrev_b32 v1, 3, v0
    v_xor_b32 v2, v1, v0
    v_and_b32 v2, 7, v2
    v_lshl_add_u32 v18, v0, 4, s51
    v_lshlrev_b32 v3, 4, v0
    v_lshlrev_b32 v19, 12, v1
    v_lshl_add_u32 v19, v2, 4, v19
    v_add_u32 v11, 106496, v10
    v_mov_b32 v20, 0
    v_mov_b32 v21, 0
    v_mov_b32 v22, 0
    v_mov_b32 v23, 0
    v_mov_b32 v24, 0
    v_mov_b32 v25, 0
    v_mov_b32 v26, 0
    v_mov_b32 v27, 0
    v_mov_b32 v28, 0
    v_mov_b32 v29, 0
    v_mov_b32 v30, 0
    v_mov_b32 v31, 0
    v_mov_b32 v32, 0
    v_mov_b32 v33, 0
    v_mov_b32 v34, 0
    v_mov_b32 v35, 0
    v_mov_b32 v36, 0
    v_mov_b32 v37, 0
    v_mov_b32 v38, 0
    v_mov_b32 v39, 0
    v_mov_b32 v40, 0
    v_mov_b32 v41, 0
    v_mov_b32 v42, 0
    v_mov_b32 v43, 0
    v_mov_b32 v44, 0
    v_mov_b32 v45, 0
    v_mov_b32 v46, 0
    v_mov_b32 v47, 0
    v_mov_b32 v48, 0
    v_mov_b32 v49, 0
    v_mov_b32 v50, 0
    v_mov_b32 v51, 0
    v_mov_b32 v52, 0
    v_mov_b32 v53, 0
    v_mov_b32 v54, 0
    v_mov_b32 v55, 0
    v_mov_b32 v56, 0
    v_mov_b32 v57, 0
    v_mov_b32 v58, 0
    v_mov_b32 v59, 0
    v_mov_b32 v60, 0
    v_mov_b32 v61, 0
    v_mov_b32 v62, 0
    v_mov_b32 v63, 0
    v_mov_b32 v64, 0
    v_mov_b32 v65, 0
    v_mov_b32 v66, 0
    v_mov_b32 v67, 0
    v_mov_b32 v68, 0
    v_mov_b32 v69, 0
    v_mov_b32 v70, 0
    v_mov_b32 v71, 0
    v_mov_b32 v72, 0
    v_mov_b32 v73, 0
    v_mov_b32 v74, 0
    v_mov_b32 v75, 0
    v_mov_b32 v76, 0
    v_mov_b32 v77, 0
    v_mov_b32 v78, 0
    v_mov_b32 v79, 0
    v_mov_b32 v80, 0
    v_mov_b32 v81, 0
    v_mov_b32 v82, 0
    v_mov_b32 v83, 0
    v_add_u32 v17, 106496, v12
    s_mov_b32 s53, 2
    s_cmp_eq_u32 s30, 1
    s_cbranch_scc1 gz_go
    s_mov_b32 s53, 6
    v_add_u32 v3, s52, v3
    v_bfe_u32 v1, v0, 2, 2
    v_lshrrev_b32 v2, 4, v0
    v_cmp_eq_u32 vcc, v1, v2
    v_lshlrev_b32 v1, 4, v0
    v_mov_b32 v2, 0x3f80
    v_lshlrev_b32 v1, v1, v2
    v_cndmask_b32 v1, 0, v1, vcc
    v_bfe_i32 v2, v0, 1, 1
    v_and_b32 v15, v1, v2
    v_xor_b32 v14, v1, v15
    v_mov_b32 v12, 0
    v_mov_b32 v13, 0
    v_mov_b32 v16, 0
    v_mov_b32 v17, 0
gz_go:
    s_barrier
    s_barrier
    s_barrier
    s_barrier
    s_barrier
    s_barrier
    ds_read_b128 v[84:87], v10 offset:0
    ds_read_b128 v[116:119], v6 offset:0
    ds_read_b128 v[120:123], v8 offset:2048
    ds_read_b128 v[88:91], v10 offset:2048
    ds_read_b128 v[124:127], v6 offset:4096
    ds_read_b128 v[128:131], v8 offset:6144
    ds_read_b128 v[92:95], v10 offset:4096
    ds_read_b128 v[96:99], v10 offset:6144
gy_loop:
    s_waitcnt lgkmcnt(0)
    v_mfma_f32_16x16x32_bf16 v[20:23], v[116:119], v[84:87], v[20:23]
    v_mfma_f32_16x16x32_bf16 v[24:27], v[120:123], v[84:87], v[24:27]
    ds_read_b128 v[100:103], v10 offset:1024
    v_mfma_f32_16x16x32_bf16 v[32:35], v[120:123], v[88:91], v[32:35]
    ds_read_b128 v[132:135], v7 offset:0
    v_mfma_f32_16x16x32_bf16 v[28:31], v[116:119], v[88:91], v[28:31]
    v_mfma_f32_16x16x32_bf16 v[36:39], v[124:127], v[84:87], v[36:39]
    ds_read_b128 v[136:139], v9 offset:2048
    v_mfma_f32_16x16x32_bf16 v[40:43], v[128:131], v[84:87], v[40:43]
    ds_read_b128 v[104:107], v10 offset:3072
    v_mfma_f32_16x16x32_bf16 v[48:51], v[128:131], v[88:91], v[48:51]
    ds_read_b128 v[140:143], v7 offset:4096
    v_mfma_f32_16x16x32_bf16 v[44:47], v[124:127], v[88:91], v[44:47]
    v_mfma_f32_16x16x32_bf16 v[52:55], v[116:119], v[92:95], v[52:55]
    ds_read_b128 v[144:147], v9 offset:6144
    v_mfma_f32_16x16x32_bf16 v[56:59], v[120:123], v[92:95], v[56:59]
    ds_read_b128 v[108:111], v10 offset:5120
    v_mfma_f32_16x16x32_bf16 v[64:67], v[120:123], v[96:99], v[64:67]
    ds_read_b128 v[112:115], v10 offset:7168
    v_mfma_f32_16x16x32_bf16 v[60:63], v[116:119], v[96:99], v[60:63]
    v_mfma_f32_16x16x32_bf16 v[68:71], v[124:127], v[92:95], v[68:71]
    v_mfma_f32_16x16x32_bf16 v[72:75], v[128:131], v[92:95], v[72:75]
    v_mfma_f32_16x16x32_bf16 v[80:83], v[128:131], v[96:99], v[80:83]
    v_mfma_f32_16x16x32_bf16 v[76:79], v[124:127], v[96:99], v[76:79]
    s_waitcnt lgkmcnt(0)
    v_mfma_f32_16x16x32_bf16 v[20:23], v[132:135], v[100:103], v[20:23]
    v_mfma_f32_16x16x32_bf16 v[24:27], v[136:139], v[100:103], v[24:27]
    s_barrier
    v_mfma_f32_16x16x32_bf16 v[32:35], v[136:139], v[104:107], v[32:35]
    v_mfma_f32_16x16x32_bf16 v[28:31], v[132:135], v[104:107], v[28:31]
    ds_read_b128 v[84:87], v10 offset:8192
    v_mfma_f32_16x16x32_bf16 v[36:39], v[140:143], v[100:103], v[36:39]
    ds_read_b128 v[116:119], v6 offset:8192
    v_mfma_f32_16x16x32_bf16 v[40:43], v[144:147], v[100:103], v[40:43]
    ds_read_b128 v[120:123], v8 offset:10240
    v_mfma_f32_16x16x32_bf16 v[48:51], v[144:147], v[104:107], v[48:51]
    ds_read_b128 v[88:91], v10 offset:10240
    v_mfma_f32_16x16x32_bf16 v[44:47], v[140:143], v[104:107], v[44:47]
    ds_read_b128 v[124:127], v6 offset:12288
    v_mfma_f32_16x16x32_bf16 v[52:55], v[132:135], v[108:111], v[52:55]
    ds_read_b128 v[128:131], v8 offset:14336
    v_mfma_f32_16x16x32_bf16 v[56:59], v[136:139], v[108:111], v[56:59]
    ds_read_b128 v[92:95], v10 offset:12288
    v_mfma_f32_16x16x32_bf16 v[64:67], v[136:139], v[112:115], v[64:67]
    ds_read_b128 v[96:99], v10 offset:14336
    v_mfma_f32_16x16x32_bf16 v[60:63], v[132:135], v[112:115], v[60:63]
    v_mfma_f32_16x16x32_bf16 v[68:71], v[140:143], v[108:111], v[68:71]
    v_mfma_f32_16x16x32_bf16 v[72:75], v[144:147], v[108:111], v[72:75]
    v_mfma_f32_16x16x32_bf16 v[80:83], v[144:147], v[112:115], v[80:83]
    v_mfma_f32_16x16x32_bf16 v[76:79], v[140:143], v[112:115], v[76:79]
    s_waitcnt lgkmcnt(0)
    v_mfma_f32_16x16x32_bf16 v[20:23], v[116:119], v[84:87], v[20:23]
    v_mfma_f32_16x16x32_bf16 v[24:27], v[120:123], v[84:87], v[24:27]
    ds_read_b128 v[100:103], v10 offset:9216
    v_mfma_f32_16x16x32_bf16 v[32:35], v[120:123], v[88:91], v[32:35]
    ds_read_b128 v[132:135], v7 offset:8192
    v_mfma_f32_16x16x32_bf16 v[28:31], v[116:119], v[88:91], v[28:31]
    v_mfma_f32_16x16x32_bf16 v[36:39], v[124:127], v[84:87], v[36:39]
    ds_read_b128 v[136:139], v9 offset:10240
    v_mfma_f32_16x16x32_bf16 v[40:43], v[128:131], v[84:87], v[40:43]
    ds_read_b128 v[104:107], v10 offset:11264
    v_mfma_f32_16x16x32_bf16 v[48:51], v[128:131], v[88:91], v[48:51]
    ds_read_b128 v[140:143], v7 offset:12288
    v_mfma_f32_16x16x32_bf16 v[44:47], v[124:127], v[88:91], v[44:47]
    v_mfma_f32_16x16x32_bf16 v[52:55], v[116:119], v[92:95], v[52:55]
    ds_read_b128 v[144:147], v9 offset:14336
    v_mfma_f32_16x16x32_bf16 v[56:59], v[120:123], v[92:95], v[56:59]
    ds_read_b128 v[108:111], v10 offset:13312
    v_mfma_f32_16x16x32_bf16 v[64:67], v[120:123], v[96:99], v[64:67]
    ds_read_b128 v[112:115], v10 offset:15360
    v_mfma_f32_16x16x32_bf16 v[60:63], v[116:119], v[96:99], v[60:63]
    v_mfma_f32_16x16x32_bf16 v[68:71], v[124:127], v[92:95], v[68:71]
    v_mfma_f32_16x16x32_bf16 v[72:75], v[128:131], v[92:95], v[72:75]
    v_mfma_f32_16x16x32_bf16 v[80:83], v[128:131], v[96:99], v[80:83]
    v_mfma_f32_16x16x32_bf16 v[76:79], v[124:127], v[96:99], v[76:79]
    s_waitcnt lgkmcnt(0)
    v_mfma_f32_16x16x32_bf16 v[20:23], v[132:135], v[100:103], v[20:23]
    v_mfma_f32_16x16x32_bf16 v[24:27], v[136:139], v[100:103], v[24:27]
    s_barrier
    v_mfma_f32_16x16x32_bf16 v[32:35], v[136:139], v[104:107], v[32:35]
    v_mfma_f32_16x16x32_bf16 v[28:31], v[132:135], v[104:107], v[28:31]
    ds_read_b128 v[84:87], v10 offset:16384
    v_mfma_f32_16x16x32_bf16 v[36:39], v[140:143], v[100:103], v[36:39]
    ds_read_b128 v[116:119], v6 offset:16384
    v_mfma_f32_16x16x32_bf16 v[40:43], v[144:147], v[100:103], v[40:43]
    ds_read_b128 v[120:123], v8 offset:18432
    v_mfma_f32_16x16x32_bf16 v[48:51], v[144:147], v[104:107], v[48:51]
    ds_read_b128 v[88:91], v10 offset:18432
    v_mfma_f32_16x16x32_bf16 v[44:47], v[140:143], v[104:107], v[44:47]
    ds_read_b128 v[124:127], v6 offset:20480
    v_mfma_f32_16x16x32_bf16 v[52:55], v[132:135], v[108:111], v[52:55]
    ds_read_b128 v[128:131], v8 offset:22528
    v_mfma_f32_16x16x32_bf16 v[56:59], v[136:139], v[108:111], v[56:59]
    ds_read_b128 v[92:95], v10 offset:20480
    v_mfma_f32_16x16x32_bf16 v[64:67], v[136:139], v[112:115], v[64:67]
    ds_read_b128 v[96:99], v10 offset:22528
    v_mfma_f32_16x16x32_bf16 v[60:63], v[132:135], v[112:115], v[60:63]
    v_mfma_f32_16x16x32_bf16 v[68:71], v[140:143], v[108:111], v[68:71]
    v_mfma_f32_16x16x32_bf16 v[72:75], v[144:147], v[108:111], v[72:75]
    v_mfma_f32_16x16x32_bf16 v[80:83], v[144:147], v[112:115], v[80:83]
    v_mfma_f32_16x16x32_bf16 v[76:79], v[140:143], v[112:115], v[76:79]
    s_waitcnt lgkmcnt(0)
    v_mfma_f32_16x16x32_bf16 v[20:23], v[116:119], v[84:87], v[20:23]
    v_mfma_f32_16x16x32_bf16 v[24:27], v[120:123], v[84:87], v[24:27]
    ds_read_b128 v[100:103], v10 offset:17408
    v_mfma_f32_16x16x32_bf16 v[32:35], v[120:123], v[88:91], v[32:35]
    ds_read_b128 v[132:135], v7 offset:16384
    v_mfma_f32_16x16x32_bf16 v[28:31], v[116:119], v[88:91], v[28:31]
    v_mfma_f32_16x16x32_bf16 v[36:39], v[124:127], v[84:87], v[36:39]
    ds_read_b128 v[136:139], v9 offset:18432
    v_mfma_f32_16x16x32_bf16 v[40:43], v[128:131], v[84:87], v[40:43]
    ds_read_b128 v[104:107], v10 offset:19456
    v_mfma_f32_16x16x32_bf16 v[48:51], v[128:131], v[88:91], v[48:51]
    ds_read_b128 v[140:143], v7 offset:20480
    v_mfma_f32_16x16x32_bf16 v[44:47], v[124:127], v[88:91], v[44:47]
    v_mfma_f32_16x16x32_bf16 v[52:55], v[116:119], v[92:95], v[52:55]
    ds_read_b128 v[144:147], v9 offset:22528
    v_mfma_f32_16x16x32_bf16 v[56:59], v[120:123], v[92:95], v[56:59]
    ds_read_b128 v[108:111], v10 offset:21504
    v_mfma_f32_16x16x32_bf16 v[64:67], v[120:123], v[96:99], v[64:67]
    ds_read_b128 v[112:115], v10 offset:23552
    v_mfma_f32_16x16x32_bf16 v[60:63], v[116:119], v[96:99], v[60:63]
    v_mfma_f32_16x16x32_bf16 v[68:71], v[124:127], v[92:95], v[68:71]
    v_mfma_f32_16x16x32_bf16 v[72:75], v[128:131], v[92:95], v[72:75]
    v_mfma_f32_16x16x32_bf16 v[80:83], v[128:131], v[96:99], v[80:83]
    v_mfma_f32_16x16x32_bf16 v[76:79], v[124:127], v[96:99], v[76:79]
    s_waitcnt lgkmcnt(0)
    v_mfma_f32_16x16x32_bf16 v[20:23], v[132:135], v[100:103], v[20:23]
    v_mfma_f32_16x16x32_bf16 v[24:27], v[136:139], v[100:103], v[24:27]
    s_barrier
    v_mfma_f32_16x16x32_bf16 v[32:35], v[136:139], v[104:107], v[32:35]
    v_mfma_f32_16x16x32_bf16 v[28:31], v[132:135], v[104:107], v[28:31]
    ds_read_b128 v[84:87], v11 offset:0
    v_mfma_f32_16x16x32_bf16 v[36:39], v[140:143], v[100:103], v[36:39]
    ds_read_b128 v[116:119], v6 offset:49152
    v_mfma_f32_16x16x32_bf16 v[40:43], v[144:147], v[100:103], v[40:43]
    ds_read_b128 v[120:123], v8 offset:51200
    v_mfma_f32_16x16x32_bf16 v[48:51], v[144:147], v[104:107], v[48:51]
    ds_read_b128 v[88:91], v11 offset:2048
    v_mfma_f32_16x16x32_bf16 v[44:47], v[140:143], v[104:107], v[44:47]
    ds_read_b128 v[124:127], v6 offset:53248
    v_mfma_f32_16x16x32_bf16 v[52:55], v[132:135], v[108:111], v[52:55]
    ds_read_b128 v[128:131], v8 offset:55296
    v_mfma_f32_16x16x32_bf16 v[56:59], v[136:139], v[108:111], v[56:59]
    ds_read_b128 v[92:95], v11 offset:4096
    v_mfma_f32_16x16x32_bf16 v[64:67], v[136:139], v[112:115], v[64:67]
    ds_read_b128 v[96:99], v11 offset:6144
    v_mfma_f32_16x16x32_bf16 v[60:63], v[132:135], v[112:115], v[60:63]
    v_mfma_f32_16x16x32_bf16 v[68:71], v[140:143], v[108:111], v[68:71]
    v_mfma_f32_16x16x32_bf16 v[72:75], v[144:147], v[108:111], v[72:75]
    v_mfma_f32_16x16x32_bf16 v[80:83], v[144:147], v[112:115], v[80:83]
    v_mfma_f32_16x16x32_bf16 v[76:79], v[140:143], v[112:115], v[76:79]
    s_sub_u32 s53, s53, 1
    s_cmp_lg_u32 s53, 0
    s_cbranch_scc0 gy_loop_out
    s_waitcnt lgkmcnt(0)
    v_mfma_f32_16x16x32_bf16 v[20:23], v[116:119], v[84:87], v[20:23]
    v_mfma_f32_16x16x32_bf16 v[24:27], v[120:123], v[84:87], v[24:27]
    ds_read_b128 v[100:103], v11 offset:1024
    v_mfma_f32_16x16x32_bf16 v[32:35], v[120:123], v[88:91], v[32:35]
    ds_read_b128 v[132:135], v7 offset:49152
    v_mfma_f32_16x16x32_bf16 v[28:31], v[116:119], v[88:91], v[28:31]
    v_mfma_f32_16x16x32_bf16 v[36:39], v[124:127], v[84:87], v[36:39]
    ds_read_b128 v[136:139], v9 offset:51200
    v_mfma_f32_16x16x32_bf16 v[40:43], v[128:131], v[84:87], v[40:43]
    ds_read_b128 v[104:107], v11 offset:3072
    v_mfma_f32_16x16x32_bf16 v[48:51], v[128:131], v[88:91], v[48:51]
    ds_read_b128 v[140:143], v7 offset:53248
    v_mfma_f32_16x16x32_bf16 v[44:47], v[124:127], v[88:91], v[44:47]
    v_mfma_f32_16x16x32_bf16 v[52:55], v[116:119], v[92:95], v[52:55]
    ds_read_b128 v[144:147], v9 offset:55296
    v_mfma_f32_16x16x32_bf16 v[56:59], v[120:123], v[92:95], v[56:59]
    ds_read_b128 v[108:111], v11 offset:5120
    v_mfma_f32_16x16x32_bf16 v[64:67], v[120:123], v[96:99], v[64:67]
    ds_read_b128 v[112:115], v11 offset:7168
    v_mfma_f32_16x16x32_bf16 v[60:63], v[116:119], v[96:99], v[60:63]
    v_mfma_f32_16x16x32_bf16 v[68:71], v[124:127], v[92:95], v[68:71]
    v_mfma_f32_16x16x32_bf16 v[72:75], v[128:131], v[92:95], v[72:75]
    v_mfma_f32_16x16x32_bf16 v[80:83], v[128:131], v[96:99], v[80:83]
    v_mfma_f32_16x16x32_bf16 v[76:79], v[124:127], v[96:99], v[76:79]
    s_waitcnt lgkmcnt(0)
    v_mfma_f32_16x16x32_bf16 v[20:23], v[132:135], v[100:103], v[20:23]
    v_mfma_f32_16x16x32_bf16 v[24:27], v[136:139], v[100:103], v[24:27]
    s_barrier
    v_mfma_f32_16x16x32_bf16 v[32:35], v[136:139], v[104:107], v[32:35]
    v_mfma_f32_16x16x32_bf16 v[28:31], v[132:135], v[104:107], v[28:31]
    ds_read_b128 v[84:87], v10 offset:0
    v_mfma_f32_16x16x32_bf16 v[36:39], v[140:143], v[100:103], v[36:39]
    ds_read_b128 v[116:119], v6 offset:0
    v_mfma_f32_16x16x32_bf16 v[40:43], v[144:147], v[100:103], v[40:43]
    ds_read_b128 v[120:123], v8 offset:2048
    v_mfma_f32_16x16x32_bf16 v[48:51], v[144:147], v[104:107], v[48:51]
    ds_read_b128 v[88:91], v10 offset:2048
    v_mfma_f32_16x16x32_bf16 v[44:47], v[140:143], v[104:107], v[44:47]
    ds_read_b128 v[124:127], v6 offset:4096
    v_mfma_f32_16x16x32_bf16 v[52:55], v[132:135], v[108:111], v[52:55]
    ds_read_b128 v[128:131], v8 offset:6144
    v_mfma_f32_16x16x32_bf16 v[56:59], v[136:139], v[108:111], v[56:59]
    ds_read_b128 v[92:95], v10 offset:4096
    v_mfma_f32_16x16x32_bf16 v[64:67], v[136:139], v[112:115], v[64:67]
    ds_read_b128 v[96:99], v10 offset:6144
    v_mfma_f32_16x16x32_bf16 v[60:63], v[132:135], v[112:115], v[60:63]
    v_mfma_f32_16x16x32_bf16 v[68:71], v[140:143], v[108:111], v[68:71]
    v_mfma_f32_16x16x32_bf16 v[72:75], v[144:147], v[108:111], v[72:75]
    v_mfma_f32_16x16x32_bf16 v[80:83], v[144:147], v[112:115], v[80:83]
    v_mfma_f32_16x16x32_bf16 v[76:79], v[140:143], v[112:115], v[76:79]
    s_branch gy_loop
gy_loop_out:
    s_cmp_eq_u32 s30, 1
    s_cbranch_scc1 gz_b
    s_waitcnt lgkmcnt(0)
    v_mfma_f32_16x16x32_bf16 v[20:23], v[116:119], v[84:87], v[20:23]
    ds_read_b128 v[100:103], v11 offset:1024
    v_mfma_f32_16x16x32_bf16 v[24:27], v[120:123], v[84:87], v[24:27]
    ds_read_b128 v[132:135], v7 offset:49152
    ds_read_b128 v[136:139], v9 offset:51200
    v_mfma_f32_16x16x32_bf16 v[32:35], v[120:123], v[88:91], v[32:35]
    ds_read_b128 v[104:107], v11 offset:3072
    v_mfma_f32_16x16x32_bf16 v[28:31], v[116:119], v[88:91], v[28:31]
    ds_read_b128 v[140:143], v7 offset:53248
    ds_read_b128 v[144:147], v9 offset:55296
    v_mfma_f32_16x16x32_bf16 v[36:39], v[124:127], v[84:87], v[36:39]
    ds_read_b128 v[108:111], v11 offset:5120
    ds_read_b128 v[112:115], v11 offset:7168
    v_mfma_f32_16x16x32_bf16 v[40:43], v[128:131], v[84:87], v[40:43]
    v_mfma_f32_16x16x32_bf16 v[48:51], v[128:131], v[88:91], v[48:51]
    v_mfma_f32_16x16x32_bf16 v[44:47], v[124:127], v[88:91], v[44:47]
    s_waitcnt lgkmcnt(0)
    v_mfma_f32_16x16x32_bf16 v[20:23], v[132:135], v[100:103], v[20:23]
    v_mfma_f32_16x16x32_bf16 v[24:27], v[136:139], v[100:103], v[24:27]
    s_barrier
    ds_read_b128 v[148:151], v3 offset:0
    ds_read_b128 v[152:155], v3 offset:1024
    v_mfma_f32_16x16x32_bf16 v[32:35], v[136:139], v[104:107], v[32:35]
    ds_read_b128 v[156:159], v3 offset:2048
    v_mfma_f32_16x16x32_bf16 v[28:31], v[132:135], v[104:107], v[28:31]
    ds_read_b128 v[160:163], v3 offset:3072
    v_mfma_f32_16x16x32_bf16 v[36:39], v[140:143], v[100:103], v[36:39]
    ds_read_b128 v[84:87], v3 offset:4096
    ds_read_b128 v[88:91], v3 offset:5120
    v_mfma_f32_16x16x32_bf16 v[40:43], v[144:147], v[100:103], v[40:43]
    v_mfma_f32_16x16x32_bf16 v[48:51], v[144:147], v[104:107], v[48:51]
    v_mfma_f32_16x16x32_bf16 v[44:47], v[140:143], v[104:107], v[44:47]
    ds_read_b128 v[100:103], v3 offset:6144
    ds_read_b128 v[104:107], v3 offset:7168
    s_waitcnt lgkmcnt(7)
    v_mfma_f32_16x16x32_bf16 v[20:23], v[14:17], v[148:151], v[20:23]
    v_mfma_f32_16x16x32_bf16 v[24:27], v[12:15], v[148:151], v[24:27]
    s_waitcnt lgkmcnt(6)
    v_mfma_f32_16x16x32_bf16 v[32:35], v[12:15], v[152:155], v[32:35]
    v_mfma_f32_16x16x32_bf16 v[28:31], v[14:17], v[152:155], v[28:31]
    s_waitcnt lgkmcnt(5)
    v_mfma_f32_16x16x32_bf16 v[36:39], v[14:17], v[156:159], v[36:39]
    v_mfma_f32_16x16x32_bf16 v[40:43], v[12:15], v[156:159], v[40:43]
    s_waitcnt lgkmcnt(4)
    v_mfma_f32_16x16x32_bf16 v[48:51], v[12:15], v[160:163], v[48:51]
    v_cvt_pk_bf16_f32 v20, v20, v21
    v_cvt_pk_bf16_f32 v21, v22, v23
    v_cvt_pk_bf16_f32 v22, v24, v25
    v_mfma_f32_16x16x32_bf16 v[44:47], v[14:17], v[160:163], v[44:47]
    v_cvt_pk_bf16_f32 v23, v26, v27
    v_cvt_pk_bf16_f32 v24, v28, v29
    v_cvt_pk_bf16_f32 v25, v30, v31
    v_mfma_f32_16x16x32_bf16 v[52:55], v[116:119], v[92:95], v[52:55]
    v_cvt_pk_bf16_f32 v26, v32, v33
    v_cvt_pk_bf16_f32 v27, v34, v35
    v_permlane16_swap_b32 v20, v22
    v_mfma_f32_16x16x32_bf16 v[56:59], v[120:123], v[92:95], v[56:59]
    v_permlane16_swap_b32 v21, v23
    v_permlane16_swap_b32 v24, v26
    v_permlane16_swap_b32 v25, v27
    v_mfma_f32_16x16x32_bf16 v[64:67], v[120:123], v[96:99], v[64:67]
    ds_write_b128 v4, v[20:23] offset:0
    ds_write_b128 v4, v[24:27] offset:2048
    v_cvt_pk_bf16_f32 v36, v36, v37
    v_mfma_f32_16x16x32_bf16 v[60:63], v[116:119], v[96:99], v[60:63]
    v_cvt_pk_bf16_f32 v37, v38, v39
    v_cvt_pk_bf16_f32 v38, v40, v41
    v_cvt_pk_bf16_f32 v39, v42, v43
    v_mfma_f32_16x16x32_bf16 v[52:55], v[132:135], v[108:111], v[52:55]
    v_cvt_pk_bf16_f32 v40, v44, v45
    v_cvt_pk_bf16_f32 v41, v46, v47
    v_cvt_pk_bf16_f32 v42, v48, v49
    v_mfma_f32_16x16x32_bf16 v[56:59], v[136:139], v[108:111], v[56:59]
    v_cvt_pk_bf16_f32 v43, v50, v51
    v_permlane16_swap_b32 v36, v38
    v_permlane16_swap_b32 v37, v39
    v_mfma_f32_16x16x32_bf16 v[64:67], v[136:139], v[112:115], v[64:67]
    v_permlane16_swap_b32 v40, v42
    v_permlane16_swap_b32 v41, v43
    ds_write_b128 v5, v[36:39] offset:0
    v_mfma_f32_16x16x32_bf16 v[60:63], v[132:135], v[112:115], v[60:63]
    ds_write_b128 v5, v[40:43] offset:2048
    ds_read_b128 v[148:151], v18 offset:0
    ds_read_b128 v[152:155], v18 offset:1024
    s_waitcnt lgkmcnt(9)
    v_mfma_f32_16x16x32_bf16 v[52:55], v[14:17], v[84:87], v[52:55]
    ds_read_b128 v[156:159], v18 offset:2048
    ds_read_b128 v[160:163], v18 offset:3072
    v_mfma_f32_16x16x32_bf16 v[56:59], v[12:15], v[84:87], v[56:59]
    s_waitcnt lgkmcnt(10)
    v_mfma_f32_16x16x32_bf16 v[64:67], v[12:15], v[88:91], v[64:67]
    v_mfma_f32_16x16x32_bf16 v[60:63], v[14:17], v[88:91], v[60:63]
    v_mfma_f32_16x16x32_bf16 v[68:71], v[124:127], v[92:95], v[68:71]
    v_mfma_f32_16x16x32_bf16 v[72:75], v[128:131], v[92:95], v[72:75]
    v_mfma_f32_16x16x32_bf16 v[80:83], v[128:131], v[96:99], v[80:83]
    s_waitcnt lgkmcnt(3)
    buffer_store_dwordx4 v[148:151], v19, s[40:43], s55 offen sc1 nt
    s_add_u32 s55, s55, 32768
    s_waitcnt lgkmcnt(2)
    buffer_store_dwordx4 v[152:155], v19, s[40:43], s55 offen sc1 nt
    v_mfma_f32_16x16x32_bf16 v[76:79], v[124:127], v[96:99], v[76:79]
    s_add_u32 s55, s55, 32768
    s_waitcnt lgkmcnt(1)
    buffer_store_dwordx4 v[156:159], v19, s[40:43], s55 offen sc1 nt
    s_add_u32 s55, s55, 32768
    v_mfma_f32_16x16x32_bf16 v[68:71], v[140:143], v[108:111], v[68:71]
    s_waitcnt lgkmcnt(0)
    buffer_store_dwordx4 v[160:163], v19, s[40:43], s55 offen sc1 nt
    s_add_u32 s55, s55, 32768
    v_cvt_pk_bf16_f32 v52, v52, v53
    v_mfma_f32_16x16x32_bf16 v[72:75], v[144:147], v[108:111], v[72:75]
    v_cvt_pk_bf16_f32 v53, v54, v55
    v_cvt_pk_bf16_f32 v54, v56, v57
    v_cvt_pk_bf16_f32 v55, v58, v59
    v_mfma_f32_16x16x32_bf16 v[80:83], v[144:147], v[112:115], v[80:83]
    v_cvt_pk_bf16_f32 v56, v60, v61
    v_cvt_pk_bf16_f32 v57, v62, v63
    v_cvt_pk_bf16_f32 v58, v64, v65
    v_mfma_f32_16x16x32_bf16 v[76:79], v[140:143], v[112:115], v[76:79]
    v_cvt_pk_bf16_f32 v59, v66, v67
    v_permlane16_swap_b32 v52, v54
    v_permlane16_swap_b32 v53, v55
    v_mfma_f32_16x16x32_bf16 v[68:71], v[14:17], v[100:103], v[68:71]
    v_permlane16_swap_b32 v56, v58
    v_permlane16_swap_b32 v57, v59
    ds_write_b128 v4, v[52:55] offset:4096
    v_mfma_f32_16x16x32_bf16 v[72:75], v[12:15], v[100:103], v[72:75]
    ds_write_b128 v4, v[56:59] offset:6144
    v_mfma_f32_16x16x32_bf16 v[80:83], v[12:15], v[104:107], v[80:83]
    v_mfma_f32_16x16x32_bf16 v[76:79], v[14:17], v[104:107], v[76:79]
    s_nop 0
    v_cvt_pk_bf16_f32 v68, v68, v69
    v_cvt_pk_bf16_f32 v69, v70, v71
    s_nop 1
    v_cvt_pk_bf16_f32 v70, v72, v73
    v_cvt_pk_bf16_f32 v71, v74, v75
    s_nop 0
    v_cvt_pk_bf16_f32 v72, v76, v77
    v_cvt_pk_bf16_f32 v73, v78, v79
    v_cvt_pk_bf16_f32 v74, v80, v81
    v_cvt_pk_bf16_f32 v75, v82, v83
    v_permlane16_swap_b32 v68, v70
    v_permlane16_swap_b32 v69, v71
    v_permlane16_swap_b32 v72, v74
    v_permlane16_swap_b32 v73, v75
    ds_write_b128 v5, v[68:71] offset:4096
    ds_write_b128 v5, v[72:75] offset:6144
    ds_read_b128 v[20:23], v18 offset:4096
    ds_read_b128 v[24:27], v18 offset:5120
    ds_read_b128 v[28:31], v18 offset:6144
    ds_read_b128 v[32:35], v18 offset:7168
    s_waitcnt lgkmcnt(3)
    buffer_store_dwordx4 v[20:23], v19, s[40:43], s55 offen sc1 nt
    s_add_u32 s55, s55, 32768
    s_waitcnt lgkmcnt(2)
    buffer_store_dwordx4 v[24:27], v19, s[40:43], s55 offen sc1 nt
    s_add_u32 s55, s55, 32768
    s_waitcnt lgkmcnt(1)
    buffer_store_dwordx4 v[28:31], v19, s[40:43], s55 offen sc1 nt
    s_add_u32 s55, s55, 32768
    s_waitcnt lgkmcnt(0)
    buffer_store_dwordx4 v[32:35], v19, s[40:43], s55 offen sc1 nt
    s_endpgm
gz_b:
    s_waitcnt lgkmcnt(0)
    v_mfma_f32_16x16x32_bf16 v[20:23], v[116:119], v[84:87], v[20:23]
    v_mfma_f32_16x16x32_bf16 v[24:27], v[120:123], v[84:87], v[24:27]
    ds_read_b128 v[100:103], v11 offset:1024
    v_mfma_f32_16x16x32_bf16 v[32:35], v[120:123], v[88:91], v[32:35]
    ds_read_b128 v[132:135], v7 offset:49152
    v_mfma_f32_16x16x32_bf16 v[28:31], v[116:119], v[88:91], v[28:31]
    v_mfma_f32_16x16x32_bf16 v[36:39], v[124:127], v[84:87], v[36:39]
    ds_read_b128 v[136:139], v9 offset:51200
    v_mfma_f32_16x16x32_bf16 v[40:43], v[128:131], v[84:87], v[40:43]
    ds_read_b128 v[104:107], v11 offset:3072
    v_mfma_f32_16x16x32_bf16 v[48:51], v[128:131], v[88:91], v[48:51]
    ds_read_b128 v[140:143], v7 offset:53248
    v_mfma_f32_16x16x32_bf16 v[44:47], v[124:127], v[88:91], v[44:47]
    v_mfma_f32_16x16x32_bf16 v[52:55], v[116:119], v[92:95], v[52:55]
    ds_read_b128 v[144:147], v9 offset:55296
    v_mfma_f32_16x16x32_bf16 v[56:59], v[120:123], v[92:95], v[56:59]
    ds_read_b128 v[108:111], v11 offset:5120
    v_mfma_f32_16x16x32_bf16 v[64:67], v[120:123], v[96:99], v[64:67]
    ds_read_b128 v[112:115], v11 offset:7168
    v_mfma_f32_16x16x32_bf16 v[60:63], v[116:119], v[96:99], v[60:63]
    v_mfma_f32_16x16x32_bf16 v[68:71], v[124:127], v[92:95], v[68:71]
    v_mfma_f32_16x16x32_bf16 v[72:75], v[128:131], v[92:95], v[72:75]
    v_mfma_f32_16x16x32_bf16 v[80:83], v[128:131], v[96:99], v[80:83]
    v_mfma_f32_16x16x32_bf16 v[76:79], v[124:127], v[96:99], v[76:79]
    s_waitcnt lgkmcnt(0)
    v_mfma_f32_16x16x32_bf16 v[20:23], v[132:135], v[100:103], v[20:23]
    v_mfma_f32_16x16x32_bf16 v[24:27], v[136:139], v[100:103], v[24:27]
    s_barrier
    v_mfma_f32_16x16x32_bf16 v[32:35], v[136:139], v[104:107], v[32:35]
    v_mfma_f32_16x16x32_bf16 v[28:31], v[132:135], v[104:107], v[28:31]
    v_mfma_f32_16x16x32_bf16 v[36:39], v[140:143], v[100:103], v[36:39]
    v_mfma_f32_16x16x32_bf16 v[40:43], v[144:147], v[100:103], v[40:43]
    v_mfma_f32_16x16x32_bf16 v[48:51], v[144:147], v[104:107], v[48:51]
    s_nop 0
    v_cvt_pk_bf16_f32 v20, v20, v21
    v_cvt_pk_bf16_f32 v21, v22, v23
    v_cvt_pk_bf16_f32 v22, v24, v25
    v_mfma_f32_16x16x32_bf16 v[44:47], v[140:143], v[104:107], v[44:47]
    v_cvt_pk_bf16_f32 v23, v26, v27
    v_cvt_pk_bf16_f32 v24, v28, v29
    v_cvt_pk_bf16_f32 v25, v30, v31
    v_mfma_f32_16x16x32_bf16 v[52:55], v[132:135], v[108:111], v[52:55]
    v_cvt_pk_bf16_f32 v26, v32, v33
    v_cvt_pk_bf16_f32 v27, v34, v35
    buffer_store_dwordx4 v[20:23], v3, s[36:39], s57 offen offset:0 sc1
    v_mfma_f32_16x16x32_bf16 v[56:59], v[136:139], v[108:111], v[56:59]
    buffer_store_dwordx4 v[24:27], v3, s[36:39], s57 offen offset:1024 sc1
    v_mfma_f32_16x16x32_bf16 v[64:67], v[136:139], v[112:115], v[64:67]
    v_cvt_pk_bf16_f32 v36, v36, v37
    v_cvt_pk_bf16_f32 v37, v38, v39
    v_cvt_pk_bf16_f32 v38, v40, v41
    v_mfma_f32_16x16x32_bf16 v[60:63], v[132:135], v[112:115], v[60:63]
    v_cvt_pk_bf16_f32 v39, v42, v43
    v_cvt_pk_bf16_f32 v40, v44, v45
    v_cvt_pk_bf16_f32 v41, v46, v47
    v_mfma_f32_16x16x32_bf16 v[68:71], v[140:143], v[108:111], v[68:71]
    v_cvt_pk_bf16_f32 v42, v48, v49
    v_cvt_pk_bf16_f32 v43, v50, v51
    buffer_store_dwordx4 v[36:39], v3, s[36:39], s57 offen offset:2048 sc1
    v_mfma_f32_16x16x32_bf16 v[72:75], v[144:147], v[108:111], v[72:75]
    buffer_store_dwordx4 v[40:43], v3, s[36:39], s57 offen offset:3072 sc1
    v_mfma_f32_16x16x32_bf16 v[80:83], v[144:147], v[112:115], v[80:83]
    v_cvt_pk_bf16_f32 v52, v52, v53
    v_cvt_pk_bf16_f32 v53, v54, v55
    v_cvt_pk_bf16_f32 v54, v56, v57
    v_mfma_f32_16x16x32_bf16 v[76:79], v[140:143], v[112:115], v[76:79]
    v_cvt_pk_bf16_f32 v55, v58, v59
    v_cvt_pk_bf16_f32 v56, v60, v61
    v_cvt_pk_bf16_f32 v57, v62, v63
    v_cvt_pk_bf16_f32 v58, v64, v65
    v_cvt_pk_bf16_f32 v59, v66, v67
    buffer_store_dwordx4 v[52:55], v3, s[36:39], s58 offen offset:0 sc1
    buffer_store_dwordx4 v[56:59], v3, s[36:39], s58 offen offset:1024 sc1
    v_cvt_pk_bf16_f32 v68, v68, v69
    v_cvt_pk_bf16_f32 v69, v70, v71
    v_cvt_pk_bf16_f32 v70, v72, v73
    v_cvt_pk_bf16_f32 v71, v74, v75
    v_cvt_pk_bf16_f32 v72, v76, v77
    v_cvt_pk_bf16_f32 v73, v78, v79
    v_cvt_pk_bf16_f32 v74, v80, v81
    v_cvt_pk_bf16_f32 v75, v82, v83
    buffer_store_dwordx4 v[68:71], v3, s[36:39], s58 offen offset:2048 sc1
    buffer_store_dwordx4 v[72:75], v3, s[36:39], s58 offen offset:3072 sc1
    s_barrier
    ds_read_b128 v[84:87], v12 offset:0
    ds_read_b64_tr_b16 v[116:117], v13 offset:0
    ds_read_b64_tr_b16 v[118:119], v13 offset:512
    ds_read_b64_tr_b16 v[120:121], v14 offset:0
    ds_read_b64_tr_b16 v[122:123], v14 offset:512
    ds_read_b128 v[88:91], v12 offset:256
    ds_read_b64_tr_b16 v[124:125], v15 offset:0
    ds_read_b64_tr_b16 v[126:127], v15 offset:512
    ds_read_b64_tr_b16 v[128:129], v16 offset:0
    ds_read_b64_tr_b16 v[130:131], v16 offset:512
    ds_read_b128 v[92:95], v12 offset:4096
    ds_read_b128 v[96:99], v12 offset:4352
    s_waitcnt lgkmcnt(0)
    v_mfma_f32_16x16x32_bf16 v[20:23], v[116:119], v[84:87], 0
    ds_read_b128 v[100:103], v12 offset:2048
    v_mfma_f32_16x16x32_bf16 v[24:27], v[120:123], v[84:87], 0
    ds_read_b64_tr_b16 v[132:133], v13 offset:4096
    v_mfma_f32_16x16x32_bf16 v[32:35], v[120:123], v[88:91], 0
    ds_read_b64_tr_b16 v[134:135], v13 offset:4608
    v_mfma_f32_16x16x32_bf16 v[28:31], v[116:119], v[88:91], 0
    ds_read_b64_tr_b16 v[136:137], v14 offset:4096
    v_mfma_f32_16x16x32_bf16 v[36:39], v[124:127], v[84:87], 0
    ds_read_b64_tr_b16 v[138:139], v14 offset:4608
    v_mfma_f32_16x16x32_bf16 v[40:43], v[128:131], v[84:87], 0
    ds_read_b128 v[104:107], v12 offset:2304
    v_mfma_f32_16x16x32_bf16 v[48:51], v[128:131], v[88:91], 0
    ds_read_b64_tr_b16 v[140:141], v15 offset:4096
    v_mfma_f32_16x16x32_bf16 v[44:47], v[124:127], v[88:91], 0
    ds_read_b64_tr_b16 v[142:143], v15 offset:4608
    v_mfma_f32_16x16x32_bf16 v[52:55], v[116:119], v[92:95], 0
    ds_read_b64_tr_b16 v[144:145], v16 offset:4096
    v_mfma_f32_16x16x32_bf16 v[56:59], v[120:123], v[92:95], 0
    ds_read_b64_tr_b16 v[146:147], v16 offset:4608
    v_mfma_f32_16x16x32_bf16 v[64:67], v[120:123], v[96:99], 0
    ds_read_b128 v[108:111], v12 offset:6144
    ds_read_b128 v[112:115], v12 offset:6400
    v_mfma_f32_16x16x32_bf16 v[60:63], v[116:119], v[96:99], 0
    v_mfma_f32_16x16x32_bf16 v[68:71], v[124:127], v[92:95], 0
    v_mfma_f32_16x16x32_bf16 v[72:75], v[128:131], v[92:95], 0
    v_mfma_f32_16x16x32_bf16 v[80:83], v[128:131], v[96:99], 0
    v_mfma_f32_16x16x32_bf16 v[76:79], v[124:127], v[96:99], 0
    s_waitcnt lgkmcnt(0)
    v_mfma_f32_16x16x32_bf16 v[20:23], v[132:135], v[100:103], v[20:23]
    v_mfma_f32_16x16x32_bf16 v[24:27], v[136:139], v[100:103], v[24:27]
    s_barrier
    v_mfma_f32_16x16x32_bf16 v[32:35], v[136:139], v[104:107], v[32:35]
    ds_read_b128 v[84:87], v12 offset:8192
    v_mfma_f32_16x16x32_bf16 v[28:31], v[132:135], v[104:107], v[28:31]
    ds_read_b64_tr_b16 v[116:117], v13 offset:8192
    v_mfma_f32_16x16x32_bf16 v[36:39], v[140:143], v[100:103], v[36:39]
    ds_read_b64_tr_b16 v[118:119], v13 offset:8704
    ds_read_b64_tr_b16 v[120:121], v14 offset:8192
    v_mfma_f32_16x16x32_bf16 v[40:43], v[144:147], v[100:103], v[40:43]
    ds_read_b64_tr_b16 v[122:123], v14 offset:8704
    v_mfma_f32_16x16x32_bf16 v[48:51], v[144:147], v[104:107], v[48:51]
    ds_read_b128 v[88:91], v12 offset:8448
    v_mfma_f32_16x16x32_bf16 v[44:47], v[140:143], v[104:107], v[44:47]
    ds_read_b64_tr_b16 v[124:125], v15 offset:8192
    ds_read_b64_tr_b16 v[126:127], v15 offset:8704
    v_mfma_f32_16x16x32_bf16 v[52:55], v[132:135], v[108:111], v[52:55]
    ds_read_b64_tr_b16 v[128:129], v16 offset:8192
    v_mfma_f32_16x16x32_bf16 v[56:59], v[136:139], v[108:111], v[56:59]
    ds_read_b64_tr_b16 v[130:131], v16 offset:8704
    v_mfma_f32_16x16x32_bf16 v[64:67], v[136:139], v[112:115], v[64:67]
    ds_read_b128 v[92:95], v12 offset:12288
    ds_read_b128 v[96:99], v12 offset:12544
    v_mfma_f32_16x16x32_bf16 v[60:63], v[132:135], v[112:115], v[60:63]
    v_mfma_f32_16x16x32_bf16 v[68:71], v[140:143], v[108:111], v[68:71]
    v_mfma_f32_16x16x32_bf16 v[72:75], v[144:147], v[108:111], v[72:75]
    v_mfma_f32_16x16x32_bf16 v[80:83], v[144:147], v[112:115], v[80:83]
    v_mfma_f32_16x16x32_bf16 v[76:79], v[140:143], v[112:115], v[76:79]
    s_mov_b32 s53, 4
go_loop:
    s_waitcnt lgkmcnt(0)
    v_mfma_f32_16x16x32_bf16 v[20:23], v[116:119], v[84:87], v[20:23]
    ds_read_b128 v[100:103], v12 offset:10240
    v_mfma_f32_16x16x32_bf16 v[24:27], v[120:123], v[84:87], v[24:27]
    ds_read_b64_tr_b16 v[132:133], v13 offset:12288
    v_mfma_f32_16x16x32_bf16 v[32:35], v[120:123], v[88:91], v[32:35]
    ds_read_b64_tr_b16 v[134:135], v13 offset:12800
    v_mfma_f32_16x16x32_bf16 v[28:31], v[116:119], v[88:91], v[28:31]
    ds_read_b64_tr_b16 v[136:137], v14 offset:12288
    v_mfma_f32_16x16x32_bf16 v[36:39], v[124:127], v[84:87], v[36:39]
    ds_read_b64_tr_b16 v[138:139], v14 offset:12800
    v_mfma_f32_16x16x32_bf16 v[40:43], v[128:131], v[84:87], v[40:43]
    ds_read_b128 v[104:107], v12 offset:10496
    v_mfma_f32_16x16x32_bf16 v[48:51], v[128:131], v[88:91], v[48:51]
    ds_read_b64_tr_b16 v[140:141], v15 offset:12288
    v_mfma_f32_16x16x32_bf16 v[44:47], v[124:127], v[88:91], v[44:47]
    ds_read_b64_tr_b16 v[142:143], v15 offset:12800
    v_mfma_f32_16x16x32_bf16 v[52:55], v[116:119], v[92:95], v[52:55]
    ds_read_b64_tr_b16 v[144:145], v16 offset:12288
    v_mfma_f32_16x16x32_bf16 v[56:59], v[120:123], v[92:95], v[56:59]
    ds_read_b64_tr_b16 v[146:147], v16 offset:12800
    v_mfma_f32_16x16x32_bf16 v[64:67], v[120:123], v[96:99], v[64:67]
    ds_read_b128 v[108:111], v12 offset:14336
    ds_read_b128 v[112:115], v12 offset:14592
    v_mfma_f32_16x16x32_bf16 v[60:63], v[116:119], v[96:99], v[60:63]
    v_mfma_f32_16x16x32_bf16 v[68:71], v[124:127], v[92:95], v[68:71]
    v_mfma_f32_16x16x32_bf16 v[72:75], v[128:131], v[92:95], v[72:75]
    v_mfma_f32_16x16x32_bf16 v[80:83], v[128:131], v[96:99], v[80:83]
    v_mfma_f32_16x16x32_bf16 v[76:79], v[124:127], v[96:99], v[76:79]
    s_waitcnt lgkmcnt(0)
    v_mfma_f32_16x16x32_bf16 v[20:23], v[132:135], v[100:103], v[20:23]
    v_mfma_f32_16x16x32_bf16 v[24:27], v[136:139], v[100:103], v[24:27]
    s_barrier
    v_mfma_f32_16x16x32_bf16 v[32:35], v[136:139], v[104:107], v[32:35]
    ds_read_b128 v[84:87], v12 offset:16384
    v_mfma_f32_16x16x32_bf16 v[28:31], v[132:135], v[104:107], v[28:31]
    ds_read_b64_tr_b16 v[116:117], v13 offset:16384
    v_mfma_f32_16x16x32_bf16 v[36:39], v[140:143], v[100:103], v[36:39]
    ds_read_b64_tr_b16 v[118:119], v13 offset:16896
    ds_read_b64_tr_b16 v[120:121], v14 offset:16384
    v_mfma_f32_16x16x32_bf16 v[40:43], v[144:147], v[100:103], v[40:43]
    ds_read_b64_tr_b16 v[122:123], v14 offset:16896
    v_mfma_f32_16x16x32_bf16 v[48:51], v[144:147], v[104:107], v[48:51]
    ds_read_b128 v[88:91], v12 offset:16640
    v_mfma_f32_16x16x32_bf16 v[44:47], v[140:143], v[104:107], v[44:47]
    ds_read_b64_tr_b16 v[124:125], v15 offset:16384
    ds_read_b64_tr_b16 v[126:127], v15 offset:16896
    v_mfma_f32_16x16x32_bf16 v[52:55], v[132:135], v[108:111], v[52:55]
    ds_read_b64_tr_b16 v[128:129], v16 offset:16384
    v_mfma_f32_16x16x32_bf16 v[56:59], v[136:139], v[108:111], v[56:59]
    ds_read_b64_tr_b16 v[130:131], v16 offset:16896
    v_mfma_f32_16x16x32_bf16 v[64:67], v[136:139], v[112:115], v[64:67]
    ds_read_b128 v[92:95], v12 offset:20480
    ds_read_b128 v[96:99], v12 offset:20736
    v_mfma_f32_16x16x32_bf16 v[60:63], v[132:135], v[112:115], v[60:63]
    v_mfma_f32_16x16x32_bf16 v[68:71], v[140:143], v[108:111], v[68:71]
    v_mfma_f32_16x16x32_bf16 v[72:75], v[144:147], v[108:111], v[72:75]
    v_mfma_f32_16x16x32_bf16 v[80:83], v[144:147], v[112:115], v[80:83]
    v_mfma_f32_16x16x32_bf16 v[76:79], v[140:143], v[112:115], v[76:79]
    s_waitcnt lgkmcnt(0)
    v_mfma_f32_16x16x32_bf16 v[20:23], v[116:119], v[84:87], v[20:23]
    ds_read_b128 v[100:103], v12 offset:18432
    v_mfma_f32_16x16x32_bf16 v[24:27], v[120:123], v[84:87], v[24:27]
    ds_read_b64_tr_b16 v[132:133], v13 offset:20480
    v_mfma_f32_16x16x32_bf16 v[32:35], v[120:123], v[88:91], v[32:35]
    ds_read_b64_tr_b16 v[134:135], v13 offset:20992
    v_mfma_f32_16x16x32_bf16 v[28:31], v[116:119], v[88:91], v[28:31]
    ds_read_b64_tr_b16 v[136:137], v14 offset:20480
    v_mfma_f32_16x16x32_bf16 v[36:39], v[124:127], v[84:87], v[36:39]
    ds_read_b64_tr_b16 v[138:139], v14 offset:20992
    v_mfma_f32_16x16x32_bf16 v[40:43], v[128:131], v[84:87], v[40:43]
    ds_read_b128 v[104:107], v12 offset:18688
    v_mfma_f32_16x16x32_bf16 v[48:51], v[128:131], v[88:91], v[48:51]
    ds_read_b64_tr_b16 v[140:141], v15 offset:20480
    v_mfma_f32_16x16x32_bf16 v[44:47], v[124:127], v[88:91], v[44:47]
    ds_read_b64_tr_b16 v[142:143], v15 offset:20992
    v_mfma_f32_16x16x32_bf16 v[52:55], v[116:119], v[92:95], v[52:55]
    ds_read_b64_tr_b16 v[144:145], v16 offset:20480
    v_mfma_f32_16x16x32_bf16 v[56:59], v[120:123], v[92:95], v[56:59]
    ds_read_b64_tr_b16 v[146:147], v16 offset:20992
    v_mfma_f32_16x16x32_bf16 v[64:67], v[120:123], v[96:99], v[64:67]
    ds_read_b128 v[108:111], v12 offset:22528
    ds_read_b128 v[112:115], v12 offset:22784
    v_mfma_f32_16x16x32_bf16 v[60:63], v[116:119], v[96:99], v[60:63]
    v_mfma_f32_16x16x32_bf16 v[68:71], v[124:127], v[92:95], v[68:71]
    v_mfma_f32_16x16x32_bf16 v[72:75], v[128:131], v[92:95], v[72:75]
    v_mfma_f32_16x16x32_bf16 v[80:83], v[128:131], v[96:99], v[80:83]
    v_mfma_f32_16x16x32_bf16 v[76:79], v[124:127], v[96:99], v[76:79]
    s_waitcnt lgkmcnt(0)
    v_mfma_f32_16x16x32_bf16 v[20:23], v[132:135], v[100:103], v[20:23]
    v_mfma_f32_16x16x32_bf16 v[24:27], v[136:139], v[100:103], v[24:27]
    s_barrier
    v_mfma_f32_16x16x32_bf16 v[32:35], v[136:139], v[104:107], v[32:35]
    ds_read_b128 v[84:87], v17 offset:0
    v_mfma_f32_16x16x32_bf16 v[28:31], v[132:135], v[104:107], v[28:31]
    ds_read_b64_tr_b16 v[116:117], v13 offset:49152
    v_mfma_f32_16x16x32_bf16 v[36:39], v[140:143], v[100:103], v[36:39]
    ds_read_b64_tr_b16 v[118:119], v13 offset:49664
    ds_read_b64_tr_b16 v[120:121], v14 offset:49152
    v_mfma_f32_16x16x32_bf16 v[40:43], v[144:147], v[100:103], v[40:43]
    ds_read_b64_tr_b16 v[122:123], v14 offset:49664
    v_mfma_f32_16x16x32_bf16 v[48:51], v[144:147], v[104:107], v[48:51]
    ds_read_b128 v[88:91], v17 offset:256
    v_mfma_f32_16x16x32_bf16 v[44:47], v[140:143], v[104:107], v[44:47]
    ds_read_b64_tr_b16 v[124:125], v15 offset:49152
    ds_read_b64_tr_b16 v[126:127], v15 offset:49664
    v_mfma_f32_16x16x32_bf16 v[52:55], v[132:135], v[108:111], v[52:55]
    ds_read_b64_tr_b16 v[128:129], v16 offset:49152
    v_mfma_f32_16x16x32_bf16 v[56:59], v[136:139], v[108:111], v[56:59]
    ds_read_b64_tr_b16 v[130:131], v16 offset:49664
    v_mfma_f32_16x16x32_bf16 v[64:67], v[136:139], v[112:115], v[64:67]
    ds_read_b128 v[92:95], v17 offset:4096
    ds_read_b128 v[96:99], v17 offset:4352
    v_mfma_f32_16x16x32_bf16 v[60:63], v[132:135], v[112:115], v[60:63]
    v_mfma_f32_16x16x32_bf16 v[68:71], v[140:143], v[108:111], v[68:71]
    v_mfma_f32_16x16x32_bf16 v[72:75], v[144:147], v[108:111], v[72:75]
    v_mfma_f32_16x16x32_bf16 v[80:83], v[144:147], v[112:115], v[80:83]
    v_mfma_f32_16x16x32_bf16 v[76:79], v[140:143], v[112:115], v[76:79]
    s_sub_u32 s53, s53, 1
    s_cmp_lg_u32 s53, 0
    s_cbranch_scc0 go_loop_out
    s_waitcnt lgkmcnt(0)
    v_mfma_f32_16x16x32_bf16 v[20:23], v[116:119], v[84:87], v[20:23]
    ds_read_b128 v[100:103], v17 offset:2048
    v_mfma_f32_16x16x32_bf16 v[24:27], v[120:123], v[84:87], v[24:27]
    ds_read_b64_tr_b16 v[132:133], v13 offset:53248
    v_mfma_f32_16x16x32_bf16 v[32:35], v[120:123], v[88:91], v[32:35]
    ds_read_b64_tr_b16 v[134:135], v13 offset:53760
    v_mfma_f32_16x16x32_bf16 v[28:31], v[116:119], v[88:91], v[28:31]
    ds_read_b64_tr_b16 v[136:137], v14 offset:53248
    v_mfma_f32_16x16x32_bf16 v[36:39], v[124:127], v[84:87], v[36:39]
    ds_read_b64_tr_b16 v[138:139], v14 offset:53760
    v_mfma_f32_16x16x32_bf16 v[40:43], v[128:131], v[84:87], v[40:43]
    ds_read_b128 v[104:107], v17 offset:2304
    v_mfma_f32_16x16x32_bf16 v[48:51], v[128:131], v[88:91], v[48:51]
    ds_read_b64_tr_b16 v[140:141], v15 offset:53248
    v_mfma_f32_16x16x32_bf16 v[44:47], v[124:127], v[88:91], v[44:47]
    ds_read_b64_tr_b16 v[142:143], v15 offset:53760
    v_mfma_f32_16x16x32_bf16 v[52:55], v[116:119], v[92:95], v[52:55]
    ds_read_b64_tr_b16 v[144:145], v16 offset:53248
    v_mfma_f32_16x16x32_bf16 v[56:59], v[120:123], v[92:95], v[56:59]
    ds_read_b64_tr_b16 v[146:147], v16 offset:53760
    v_mfma_f32_16x16x32_bf16 v[64:67], v[120:123], v[96:99], v[64:67]
    ds_read_b128 v[108:111], v17 offset:6144
    ds_read_b128 v[112:115], v17 offset:6400
    v_mfma_f32_16x16x32_bf16 v[60:63], v[116:119], v[96:99], v[60:63]
    v_mfma_f32_16x16x32_bf16 v[68:71], v[124:127], v[92:95], v[68:71]
    v_mfma_f32_16x16x32_bf16 v[72:75], v[128:131], v[92:95], v[72:75]
    v_mfma_f32_16x16x32_bf16 v[80:83], v[128:131], v[96:99], v[80:83]
    v_mfma_f32_16x16x32_bf16 v[76:79], v[124:127], v[96:99], v[76:79]
    s_waitcnt lgkmcnt(0)
    v_mfma_f32_16x16x32_bf16 v[20:23], v[132:135], v[100:103], v[20:23]
    v_mfma_f32_16x16x32_bf16 v[24:27], v[136:139], v[100:103], v[24:27]
    s_barrier
    v_mfma_f32_16x16x32_bf16 v[32:35], v[136:139], v[104:107], v[32:35]
    ds_read_b128 v[84:87], v12 offset:0
    v_mfma_f32_16x16x32_bf16 v[28:31], v[132:135], v[104:107], v[28:31]
    ds_read_b64_tr_b16 v[116:117], v13 offset:0
    v_mfma_f32_16x16x32_bf16 v[36:39], v[140:143], v[100:103], v[36:39]
    ds_read_b64_tr_b16 v[118:119], v13 offset:512
    ds_read_b64_tr_b16 v[120:121], v14 offset:0
    v_mfma_f32_16x16x32_bf16 v[40:43], v[144:147], v[100:103], v[40:43]
    ds_read_b64_tr_b16 v[122:123], v14 offset:512
    v_mfma_f32_16x16x32_bf16 v[48:51], v[144:147], v[104:107], v[48:51]
    ds_read_b128 v[88:91], v12 offset:256
    v_mfma_f32_16x16x32_bf16 v[44:47], v[140:143], v[104:107], v[44:47]
    ds_read_b64_tr_b16 v[124:125], v15 offset:0
    ds_read_b64_tr_b16 v[126:127], v15 offset:512
    v_mfma_f32_16x16x32_bf16 v[52:55], v[132:135], v[108:111], v[52:55]
    ds_read_b64_tr_b16 v[128:129], v16 offset:0
    v_mfma_f32_16x16x32_bf16 v[56:59], v[136:139], v[108:111], v[56:59]
    ds_read_b64_tr_b16 v[130:131], v16 offset:512
    v_mfma_f32_16x16x32_bf16 v[64:67], v[136:139], v[112:115], v[64:67]
    ds_read_b128 v[92:95], v12 offset:4096
    ds_read_b128 v[96:99], v12 offset:4352
    v_mfma_f32_16x16x32_bf16 v[60:63], v[132:135], v[112:115], v[60:63]
    v_mfma_f32_16x16x32_bf16 v[68:71], v[140:143], v[108:111], v[68:71]
    v_mfma_f32_16x16x32_bf16 v[72:75], v[144:147], v[108:111], v[72:75]
    v_mfma_f32_16x16x32_bf16 v[80:83], v[144:147], v[112:115], v[80:83]
    v_mfma_f32_16x16x32_bf16 v[76:79], v[140:143], v[112:115], v[76:79]
    s_cmp_lg_u32 s53, 3
    s_cbranch_scc1 go_loop_on
    s_waitcnt vmcnt(0)
    buffer_store_dword v164, off, s[36:39], s56 sc1
go_loop_on:
    s_waitcnt lgkmcnt(0)
    v_mfma_f32_16x16x32_bf16 v[20:23], v[116:119], v[84:87], v[20:23]
    ds_read_b128 v[100:103], v12 offset:2048
    v_mfma_f32_16x16x32_bf16 v[24:27], v[120:123], v[84:87], v[24:27]
    ds_read_b64_tr_b16 v[132:133], v13 offset:4096
    v_mfma_f32_16x16x32_bf16 v[32:35], v[120:123], v[88:91], v[32:35]
    ds_read_b64_tr_b16 v[134:135], v13 offset:4608
    v_mfma_f32_16x16x32_bf16 v[28:31], v[116:119], v[88:91], v[28:31]
    ds_read_b64_tr_b16 v[136:137], v14 offset:4096
    v_mfma_f32_16x16x32_bf16 v[36:39], v[124:127], v[84:87], v[36:39]
    ds_read_b64_tr_b16 v[138:139], v14 offset:4608
    v_mfma_f32_16x16x32_bf16 v[40:43], v[128:131], v[84:87], v[40:43]
    ds_read_b128 v[104:107], v12 offset:2304
    v_mfma_f32_16x16x32_bf16 v[48:51], v[128:131], v[88:91], v[48:51]
    ds_read_b64_tr_b16 v[140:141], v15 offset:4096
    v_mfma_f32_16x16x32_bf16 v[44:47], v[124:127], v[88:91], v[44:47]
    ds_read_b64_tr_b16 v[142:143], v15 offset:4608
    v_mfma_f32_16x16x32_bf16 v[52:55], v[116:119], v[92:95], v[52:55]
    ds_read_b64_tr_b16 v[144:145], v16 offset:4096
    v_mfma_f32_16x16x32_bf16 v[56:59], v[120:123], v[92:95], v[56:59]
    ds_read_b64_tr_b16 v[146:147], v16 offset:4608
    v_mfma_f32_16x16x32_bf16 v[64:67], v[120:123], v[96:99], v[64:67]
    ds_read_b128 v[108:111], v12 offset:6144
    ds_read_b128 v[112:115], v12 offset:6400
    v_mfma_f32_16x16x32_bf16 v[60:63], v[116:119], v[96:99], v[60:63]
    v_mfma_f32_16x16x32_bf16 v[68:71], v[124:127], v[92:95], v[68:71]
    v_mfma_f32_16x16x32_bf16 v[72:75], v[128:131], v[92:95], v[72:75]
    v_mfma_f32_16x16x32_bf16 v[80:83], v[128:131], v[96:99], v[80:83]
    v_mfma_f32_16x16x32_bf16 v[76:79], v[124:127], v[96:99], v[76:79]
    s_waitcnt lgkmcnt(0)
    v_mfma_f32_16x16x32_bf16 v[20:23], v[132:135], v[100:103], v[20:23]
    v_mfma_f32_16x16x32_bf16 v[24:27], v[136:139], v[100:103], v[24:27]
    s_barrier
    v_mfma_f32_16x16x32_bf16 v[32:35], v[136:139], v[104:107], v[32:35]
    ds_read_b128 v[84:87], v12 offset:8192
    v_mfma_f32_16x16x32_bf16 v[28:31], v[132:135], v[104:107], v[28:31]
    ds_read_b64_tr_b16 v[116:117], v13 offset:8192
    v_mfma_f32_16x16x32_bf16 v[36:39], v[140:143], v[100:103], v[36:39]
    ds_read_b64_tr_b16 v[118:119], v13 offset:8704
    ds_read_b64_tr_b16 v[120:121], v14 offset:8192
    v_mfma_f32_16x16x32_bf16 v[40:43], v[144:147], v[100:103], v[40:43]
    ds_read_b64_tr_b16 v[122:123], v14 offset:8704
    v_mfma_f32_16x16x32_bf16 v[48:51], v[144:147], v[104:107], v[48:51]
    ds_read_b128 v[88:91], v12 offset:8448
    v_mfma_f32_16x16x32_bf16 v[44:47], v[140:143], v[104:107], v[44:47]
    ds_read_b64_tr_b16 v[124:125], v15 offset:8192
    ds_read_b64_tr_b16 v[126:127], v15 offset:8704
    v_mfma_f32_16x16x32_bf16 v[52:55], v[132:135], v[108:111], v[52:55]
    ds_read_b64_tr_b16 v[128:129], v16 offset:8192
    v_mfma_f32_16x16x32_bf16 v[56:59], v[136:139], v[108:111], v[56:59]
    ds_read_b64_tr_b16 v[130:131], v16 offset:8704
    v_mfma_f32_16x16x32_bf16 v[64:67], v[136:139], v[112:115], v[64:67]
    ds_read_b128 v[92:95], v12 offset:12288
    ds_read_b128 v[96:99], v12 offset:12544
    v_mfma_f32_16x16x32_bf16 v[60:63], v[132:135], v[112:115], v[60:63]
    v_mfma_f32_16x16x32_bf16 v[68:71], v[140:143], v[108:111], v[68:71]
    v_mfma_f32_16x16x32_bf16 v[72:75], v[144:147], v[108:111], v[72:75]
    v_mfma_f32_16x16x32_bf16 v[80:83], v[144:147], v[112:115], v[80:83]
    v_mfma_f32_16x16x32_bf16 v[76:79], v[140:143], v[112:115], v[76:79]
    s_branch go_loop
go_loop_out:
    s_waitcnt lgkmcnt(0)
    v_mfma_f32_16x16x32_bf16 v[20:23], v[116:119], v[84:87], v[20:23]
    ds_read_b128 v[100:103], v17 offset:2048
    ds_read_b64_tr_b16 v[132:133], v13 offset:53248
    v_mfma_f32_16x16x32_bf16 v[24:27], v[120:123], v[84:87], v[24:27]
    ds_read_b64_tr_b16 v[134:135], v13 offset:53760
    ds_read_b64_tr_b16 v[136:137], v14 offset:53248
    v_mfma_f32_16x16x32_bf16 v[32:35], v[120:123], v[88:91], v[32:35]
    ds_read_b64_tr_b16 v[138:139], v14 offset:53760
    ds_read_b128 v[104:107], v17 offset:2304
    ds_read_b64_tr_b16 v[140:141], v15 offset:53248
    v_mfma_f32_16x16x32_bf16 v[28:31], v[116:119], v[88:91], v[28:31]
    ds_read_b64_tr_b16 v[142:143], v15 offset:53760
    ds_read_b64_tr_b16 v[144:145], v16 offset:53248
    v_mfma_f32_16x16x32_bf16 v[36:39], v[124:127], v[84:87], v[36:39]
    ds_read_b64_tr_b16 v[146:147], v16 offset:53760
    ds_read_b128 v[108:111], v17 offset:6144
    ds_read_b128 v[112:115], v17 offset:6400
    v_mfma_f32_16x16x32_bf16 v[40:43], v[128:131], v[84:87], v[40:43]
    v_mfma_f32_16x16x32_bf16 v[48:51], v[128:131], v[88:91], v[48:51]
    v_mfma_f32_16x16x32_bf16 v[44:47], v[124:127], v[88:91], v[44:47]
    s_waitcnt lgkmcnt(0)
    v_mfma_f32_16x16x32_bf16 v[20:23], v[132:135], v[100:103], v[20:23]
    v_mfma_f32_16x16x32_bf16 v[24:27], v[136:139], v[100:103], v[24:27]
    v_mfma_f32_16x16x32_bf16 v[32:35], v[136:139], v[104:107], v[32:35]
    v_mfma_f32_16x16x32_bf16 v[28:31], v[132:135], v[104:107], v[28:31]
    v_mfma_f32_16x16x32_bf16 v[36:39], v[140:143], v[100:103], v[36:39]
    v_mfma_f32_16x16x32_bf16 v[40:43], v[144:147], v[100:103], v[40:43]
    v_mfma_f32_16x16x32_bf16 v[48:51], v[144:147], v[104:107], v[48:51]
    s_nop 1
    v_cvt_pk_bf16_f32 v20, v20, v21
    v_cvt_pk_bf16_f32 v21, v22, v23
    v_cvt_pk_bf16_f32 v22, v24, v25
    v_mfma_f32_16x16x32_bf16 v[44:47], v[140:143], v[104:107], v[44:47]
    v_cvt_pk_bf16_f32 v23, v26, v27
    v_cvt_pk_bf16_f32 v24, v28, v29
    v_cvt_pk_bf16_f32 v25, v30, v31
    v_mfma_f32_16x16x32_bf16 v[52:55], v[116:119], v[92:95], v[52:55]
    v_cvt_pk_bf16_f32 v26, v32, v33
    v_cvt_pk_bf16_f32 v27, v34, v35
    v_permlane16_swap_b32 v20, v22
    v_mfma_f32_16x16x32_bf16 v[56:59], v[120:123], v[92:95], v[56:59]
    v_permlane16_swap_b32 v21, v23
    v_permlane16_swap_b32 v24, v26
    v_permlane16_swap_b32 v25, v27
    v_mfma_f32_16x16x32_bf16 v[64:67], v[120:123], v[96:99], v[64:67]
    ds_write_b128 v4, v[20:23] offset:0
    ds_write_b128 v4, v[24:27] offset:2048
    v_cvt_pk_bf16_f32 v36, v36, v37
    v_mfma_f32_16x16x32_bf16 v[60:63], v[116:119], v[96:99], v[60:63]
    v_cvt_pk_bf16_f32 v37, v38, v39
    v_cvt_pk_bf16_f32 v38, v40, v41
    v_cvt_pk_bf16_f32 v39, v42, v43
    v_mfma_f32_16x16x32_bf16 v[52:55], v[132:135], v[108:111], v[52:55]
    v_cvt_pk_bf16_f32 v40, v44, v45
    v_cvt_pk_bf16_f32 v41, v46, v47
    v_cvt_pk_bf16_f32 v42, v48, v49
    v_mfma_f32_16x16x32_bf16 v[56:59], v[136:139], v[108:111], v[56:59]
    v_cvt_pk_bf16_f32 v43, v50, v51
    v_permlane16_swap_b32 v36, v38
    v_permlane16_swap_b32 v37, v39
    v_mfma_f32_16x16x32_bf16 v[64:67], v[136:139], v[112:115], v[64:67]
    v_permlane16_swap_b32 v40, v42
    v_permlane16_swap_b32 v41, v43
    ds_write_b128 v5, v[36:39] offset:0
    v_mfma_f32_16x16x32_bf16 v[60:63], v[132:135], v[112:115], v[60:63]
    ds_write_b128 v5, v[40:43] offset:2048
    ds_read_b128 v[148:151], v18 offset:0
    ds_read_b128 v[152:155], v18 offset:1024
    v_mfma_f32_16x16x32_bf16 v[68:71], v[124:127], v[92:95], v[68:71]
    ds_read_b128 v[156:159], v18 offset:2048
    ds_read_b128 v[160:163], v18 offset:3072
    v_mfma_f32_16x16x32_bf16 v[72:75], v[128:131], v[92:95], v[72:75]
    v_mfma_f32_16x16x32_bf16 v[80:83], v[128:131], v[96:99], v[80:83]
    s_waitcnt lgkmcnt(3)
    buffer_store_dwordx4 v[148:151], v19, s[40:43], s55 offen sc1 nt
    s_add_u32 s55, s55, 32768
    s_waitcnt lgkmcnt(2)
    buffer_store_dwordx4 v[152:155], v19, s[40:43], s55 offen sc1 nt
    v_mfma_f32_16x16x32_bf16 v[76:79], v[124:127], v[96:99], v[76:79]
    s_add_u32 s55, s55, 32768
    s_waitcnt lgkmcnt(1)
    buffer_store_dwordx4 v[156:159], v19, s[40:43], s55 offen sc1 nt
    s_add_u32 s55, s55, 32768
    v_mfma_f32_16x16x32_bf16 v[68:71], v[140:143], v[108:111], v[68:71]
    s_waitcnt lgkmcnt(0)
    buffer_store_dwordx4 v[160:163], v19, s[40:43], s55 offen sc1 nt
    s_add_u32 s55, s55, 32768
    v_cvt_pk_bf16_f32 v52, v52, v53
    v_mfma_f32_16x16x32_bf16 v[72:75], v[144:147], v[108:111], v[72:75]
    v_cvt_pk_bf16_f32 v53, v54, v55
    v_cvt_pk_bf16_f32 v54, v56, v57
    v_cvt_pk_bf16_f32 v55, v58, v59
    v_mfma_f32_16x16x32_bf16 v[80:83], v[144:147], v[112:115], v[80:83]
    v_cvt_pk_bf16_f32 v56, v60, v61
    v_cvt_pk_bf16_f32 v57, v62, v63
    v_cvt_pk_bf16_f32 v58, v64, v65
    v_mfma_f32_16x16x32_bf16 v[76:79], v[140:143], v[112:115], v[76:79]
    v_cvt_pk_bf16_f32 v59, v66, v67
    v_permlane16_swap_b32 v52, v54
    v_permlane16_swap_b32 v53, v55
    v_permlane16_swap_b32 v56, v58
    v_permlane16_swap_b32 v57, v59
    ds_write_b128 v4, v[52:55] offset:4096
    ds_write_b128 v4, v[56:59] offset:6144
    v_cvt_pk_bf16_f32 v68, v68, v69
    v_cvt_pk_bf16_f32 v69, v70, v71
    v_cvt_pk_bf16_f32 v70, v72, v73
    v_cvt_pk_bf16_f32 v71, v74, v75
    v_cvt_pk_bf16_f32 v72, v76, v77
    v_cvt_pk_bf16_f32 v73, v78, v79
    v_cvt_pk_bf16_f32 v74, v80, v81
    v_cvt_pk_bf16_f32 v75, v82, v83
    v_permlane16_swap_b32 v68, v70
    v_permlane16_swap_b32 v69, v71
    v_permlane16_swap_b32 v72, v74
    v_permlane16_swap_b32 v73, v75
    ds_write_b128 v5, v[68:71] offset:4096
    ds_write_b128 v5, v[72:75] offset:6144
    ds_read_b128 v[20:23], v18 offset:4096
    ds_read_b128 v[24:27], v18 offset:5120
    ds_read_b128 v[28:31], v18 offset:6144
    ds_read_b128 v[32:35], v18 offset:7168
    s_waitcnt lgkmcnt(3)
    buffer_store_dwordx4 v[20:23], v19, s[40:43], s55 offen sc1 nt
    s_add_u32 s55, s55, 32768
    s_waitcnt lgkmcnt(2)
    buffer_store_dwordx4 v[24:27], v19, s[40:43], s55 offen sc1 nt
    s_add_u32 s55, s55, 32768
    s_waitcnt lgkmcnt(1)
    buffer_store_dwordx4 v[28:31], v19, s[40:43], s55 offen sc1 nt
    s_add_u32 s55, s55, 32768
    s_waitcnt lgkmcnt(0)
    buffer_store_dwordx4 v[32:35], v19, s[40:43], s55 offen sc1 nt
    s_endpgm
f_kernel_end:
    s_endpgm
.section .rodata,"a"
.p2align 6
.amdhsa_kernel f_kernel
  .amdhsa_next_free_vgpr 168
  .amdhsa_next_free_sgpr 80
  .amdhsa_accum_offset 168
  .amdhsa_group_segment_fixed_size 0
  .amdhsa_kernarg_size 88
  .amdhsa_user_sgpr_count 2
  .amdhsa_user_sgpr_kernarg_segment_ptr 1
  .amdhsa_system_sgpr_workgroup_id_x 1
.end_amdhsa_kernel
```
